```python
import torch

def _softmax(x, axis=-1):
    return torch.softmax(x, dim=axis)
def _gelu(x):
    return torch.nn.functional.gelu(x, approximate="tanh")
def _silu(x):
    return torch.nn.functional.silu(x)
def _sigmoid(x):
    return torch.sigmoid(x)
def _layernorm(x, axis=-1, eps=1e-5):
    m = x.mean(dim=axis, keepdim=True)
    v = x.var(dim=axis, keepdim=True, unbiased=False)
    return (x - m) / torch.sqrt(v + eps)
def _scatter_add(tgt, idx, src, axis=0):
    return tgt.clone().index_add_(axis, idx, src)
def _segment_sum(src, seg, n):
    out = torch.zeros((n,) + src.shape[1:], dtype=src.dtype)
    return out.index_add_(0, seg, src)
def _pad(x, pw):
    flat = tuple(v for pair in reversed(pw) for v in pair)
    return torch.nn.functional.pad(x, flat)

kernel_name = 'interleave_layers__softmax_full_mha__glu_gated_glu__prompt'

def setup_inputs():

    _w = (lambda a: (lambda t: t.to(torch.bfloat16) if t.is_floating_point() else t)(torch.as_tensor(a)))
    def _A_setup():
        B, S, D = 1, 2048, 448
        return {
            "x": _w((lambda *s: torch.randn(*s, dtype=torch.bfloat16) * 0.05)(B, S, D)),
            "wqkv": _w((lambda *s: torch.randn(*s, dtype=torch.bfloat16) * 0.05)(D, 3 * D)),
            "wo": _w((lambda *s: torch.randn(*s, dtype=torch.bfloat16) * 0.05)(D, D)),
        }
    _A_in = _A_setup()

    def _B_setup():
        B, S, D, F = 1, 2048, 448, 1792
        return {
            "x": _w((lambda *s: torch.randn(*s, dtype=torch.bfloat16) * 0.05)(B, S, D)),
            "w_gate": _w((lambda *s: torch.randn(*s, dtype=torch.bfloat16) * 0.05)(D, F)),
            "w_up": _w((lambda *s: torch.randn(*s, dtype=torch.bfloat16) * 0.05)(D, F)),
            "w_down": _w((lambda *s: torch.randn(*s, dtype=torch.bfloat16) * 0.05)(F, D)),
        }
    _B_in = _B_setup()

    return {
        "A_x": _A_in["x"],
        "A_wqkv": _A_in["wqkv"],
        "A_wo": _A_in["wo"],
        "B_x": _B_in["x"],
        "B_w_gate": _B_in["w_gate"],
        "B_w_up": _B_in["w_up"],
        "B_w_down": _B_in["w_down"],
    }

def reference(A_x, A_wqkv, A_wo, B_x, B_w_gate, B_w_up, B_w_down):
    def _A_ref(x, wqkv, wo):
        B, S, D = x.shape
        H = 16; Dh = D // H
        qkv = (lambda x, *d: x.permute(*d))((x @ wqkv).reshape(B, S, 3, H, Dh), 2, 0, 3, 1, 4)
        q, k, v = qkv[0], qkv[1], qkv[2]
        scale = Dh ** -0.5
        scores = torch.einsum("bhqd,bhkd->bhqk", q, k) * scale
        p = _softmax(scores, axis=-1)
        o = torch.einsum("bhqk,bhkd->bhqd", p, v)
        return (lambda x, *d: x.permute(*d))(o, 0, 2, 1, 3).reshape(B, S, D) @ wo

    def _B_ref(x, w_gate, w_up, w_down):
        g = torch.einsum("bsd,df->bsf", x, w_gate)
        u = torch.einsum("bsd,df->bsf", x, w_up)
        h = _sigmoid(g) * u
        return torch.einsum("bsf,fd->bsd", h, w_down)

    x = A_x
    x = x + _A_ref(_layernorm(x, axis=-1), A_wqkv, A_wo)
    x = x + _B_ref(_layernorm(x, axis=-1), B_w_gate, B_w_up, B_w_down)
    x = x + _A_ref(_layernorm(x, axis=-1), A_wqkv, A_wo)
    x = x + _B_ref(_layernorm(x, axis=-1), B_w_gate, B_w_up, B_w_down)
    return x
```

```asm
; @launch kernel=main_kernel grid=(256,1,1) block=(256,1,1) lds=163840
.amdgcn_target "amdgcn-amd-amdhsa--gfx950"
.text
.globl main_kernel
.p2align 8
.type main_kernel,@function
main_kernel:
s_cmp_ge_u32 s2, 256
s_cbranch_scc1 main_kernel_end
s_load_dwordx2 s[4:5], s[0:1], 72
v_lshrrev_b32 v2, 6, v0
v_and_b32 v0, 63, v0
v_lshlrev_b32 v1, 4, v0
v_readfirstlane_b32 s3, v2
s_load_dwordx2 s[6:7], s[0:1], 56
s_load_dwordx4 s[40:43], s[0:1], 0
s_load_dwordx2 s[44:45], s[0:1], 16
s_load_dwordx4 s[48:51], s[0:1], 32
s_load_dwordx2 s[52:53], s[0:1], 48
s_load_dwordx2 s[54:55], s[0:1], 64
v_and_b32 v2, 31, v0
v_lshrrev_b32 v3, 5, v0
v_bfe_u32 v4, v0, 2, 2
v_and_b32 v5, 1, v0
v_lshlrev_b32 v5, 1, v5
v_bfe_u32 v6, v0, 1, 1
v_or_b32 v5, v5, v6
s_mul_i32 s24, s3, 8704
s_add_u32 s24, s24, 114688
v_add_u32 v20, s24, v1
v_bfe_u32 v21, v0, 4, 1
s_mov_b32 s34, 0x3f803f80
v_mov_b32 v16, 0
v_lshlrev_b32 v17, 2, v2
s_waitcnt lgkmcnt(0)
s_mov_b32 s8, s4
s_mov_b32 s9, s5
s_mov_b32 s10, 63963136
s_mov_b32 s11, 0x00020000
s_cmp_lg_u32 s2, 0
s_cbranch_scc1 p_nz
s_lshl_b32 s13, s3, 13
s_add_u32 s13, s13, 30015488
v_lshlrev_b32 v17, 7, v0
buffer_store_dword v16, v17, s[8:11], s13 offen sc1
p_nz:
s_sub_u32 s63, s2, 48
s_cmp_lt_u32 s2, 192
s_cselect_b32 s63, 255, s63
s_cmp_lt_u32 s2, 144
s_cselect_b32 s63, s2, s63
v_lshrrev_b32 v6, 2, v0
v_mul_u32_u24 v6, 896, v6
v_and_b32 v23, 3, v0
v_lshl_add_u32 v204, v23, 4, v6
s_cmp_lt_u32 s63, 112
s_cbranch_scc1 p_gu
s_cmp_lt_u32 s63, 168
s_cbranch_scc1 p_wd
s_mov_b32 s36, s44
s_mov_b32 s37, s45
s_mov_b32 s38, 401408
s_mov_b32 s39, 0x00020000
s_cmp_lt_u32 s63, 182
s_cselect_b32 s38, s38, 0
s_sub_u32 s15, s63, 168
s_mul_i32 s35, s3, 100352
s_lshl_b32 s18, s15, 6
s_add_u32 s35, s35, s18
s_mov_b32 s26, 14336
s_mov_b32 s27, 10752
s_branch p_cp
p_wd:
s_mov_b32 s36, s52
s_mov_b32 s37, s53
s_mov_b32 s38, 1605632
s_mov_b32 s39, 0x00020000
s_sub_u32 s14, s63, 112
s_and_b32 s15, s14, 7
s_mul_i32 s15, s15, 7
s_lshr_b32 s14, s14, 3
s_add_u32 s14, s14, s15
s_mul_hi_u32 s16, s14, 306783379
s_mul_i32 s17, s16, 14
s_sub_u32 s15, s14, s17
s_mul_i32 s17, s16, 28
s_mul_i32 s18, s3, 7
s_add_u32 s17, s17, s18
s_mul_i32 s35, s17, 14336
s_lshl_b32 s18, s15, 6
s_add_u32 s35, s35, s18
s_mov_b32 s26, 14336
s_mov_b32 s27, 14336
p_cp:
s_mov_b64 s[56:57], s[36:37]
s_mov_b64 s[58:59], s[38:39]
s_branch p_end
p_gu:
s_mov_b32 s36, s48
s_mov_b32 s37, s49
s_mov_b32 s38, 1605632
s_mov_b32 s39, 0x00020000
s_mov_b32 s56, s50
s_mov_b32 s57, s51
s_mov_b32 s58, 1605632
s_mov_b32 s59, 0x00020000
s_and_b32 s14, s2, 7
s_mul_i32 s14, s14, 14
s_lshr_b32 s15, s2, 3
s_add_u32 s14, s14, s15
s_mul_hi_u32 s15, s14, 613566757
s_mul_i32 s17, s15, 7
s_sub_u32 s16, s14, s17
s_mul_i32 s35, s3, 401408
s_lshl_b32 s18, s14, 5
s_add_u32 s35, s35, s18
s_mov_b32 s26, 0
s_mov_b32 s27, 114688
v_lshrrev_b32 v6, 1, v0
v_mul_u32_u24 v6, 3584, v6
v_and_b32 v23, 1, v0
v_lshl_add_u32 v204, v23, 4, v6
p_end:
s_mov_b32 s44, s54
s_mov_b32 s45, s55
s_mov_b32 s46, 256
s_mov_b32 s47, 0x00020000
s_cmp_ge_u32 s2, 192
s_cbranch_scc1 p_x
s_cmp_ge_u32 s2, 144
s_cbranch_scc1 p_qkv
buffer_load_dwordx4 v[208:211], v204, s[36:39], s35 offen
s_add_u32 s35, s35, s26
buffer_load_dwordx4 v[212:215], v204, s[56:59], s35 offen
s_add_u32 s35, s35, s27
buffer_load_dwordx4 v[216:219], v204, s[36:39], s35 offen
s_add_u32 s35, s35, s26
buffer_load_dwordx4 v[220:223], v204, s[56:59], s35 offen
s_add_u32 s35, s35, s27
buffer_load_dwordx4 v[224:227], v204, s[36:39], s35 offen
s_add_u32 s35, s35, s26
buffer_load_dwordx4 v[228:231], v204, s[56:59], s35 offen
s_add_u32 s35, s35, s27
buffer_load_dwordx4 v[232:235], v204, s[36:39], s35 offen
s_add_u32 s35, s35, s26
buffer_load_dwordx4 v[236:239], v204, s[56:59], s35 offen
s_add_u32 s35, s35, s27
s_cmp_lg_u32 s2, 0
s_cbranch_scc1 p_def
s_mov_b32 s13, 0
s_waitcnt vmcnt(8)
s_barrier
s_cmp_lg_u32 s3, 0
s_cbranch_scc1 main_kernel_sg1
v_mov_b32 v4, 1
v_mov_b32 v5, 0
s_mov_b64 exec, 1
buffer_atomic_add v4, v5, s[44:47], s13 offen sc1
s_mov_b64 exec, -1
main_kernel_sg1:
s_branch p_def
p_x:
s_mov_b32 s28, s40
s_mov_b32 s29, s41
s_mov_b32 s30, 1835008
s_mov_b32 s31, 0x00020000
s_sub_u32 s14, s2, 192
v_mul_u32_u24 v6, 896, v2
v_lshl_add_u32 v6, v3, 4, v6
s_mul_i32 s25, s14, 28672
s_lshl_b32 s15, s3, 6
s_add_u32 s25, s25, s15
buffer_load_dwordx4 v[24:27], v6, s[28:31], s25 offen offset:0
buffer_load_dwordx4 v[28:31], v6, s[28:31], s25 offen offset:32
buffer_load_dwordx4 v[32:35], v6, s[28:31], s25 offen offset:256
buffer_load_dwordx4 v[36:39], v6, s[28:31], s25 offen offset:288
buffer_load_dwordx4 v[40:43], v6, s[28:31], s25 offen offset:512
buffer_load_dwordx4 v[44:47], v6, s[28:31], s25 offen offset:544
buffer_load_dwordx4 v[48:51], v6, s[28:31], s25 offen offset:768
buffer_load_dwordx4 v[52:55], v6, s[28:31], s25 offen offset:800
s_mul_i32 s20, s14, 28
s_lshl_b32 s15, s3, 1
s_add_u32 s20, s20, s15
s_lshl_b32 s20, s20, 10
s_add_u32 s20, s20, 0
s_mul_i32 s21, s14, 3584
s_lshl_b32 s15, s3, 8
s_add_u32 s21, s21, s15
s_add_u32 s21, s21, 29491200
v_lshlrev_b32 v7, 3, v2
v_lshl_add_u32 v7, v3, 2, v7
s_waitcnt vmcnt(6)
buffer_store_dwordx4 v[24:27], v1, s[8:11], s20 offen offset:0 sc1
buffer_store_dwordx4 v[28:31], v1, s[8:11], s20 offen offset:1024 sc1
v_mov_b32 v8, 0
v_mov_b32 v9, 0
v_dot2_f32_bf16 v8, v24, s34, v8
v_dot2_f32_bf16 v9, v24, v24, v9
v_dot2_f32_bf16 v8, v25, s34, v8
v_dot2_f32_bf16 v9, v25, v25, v9
v_dot2_f32_bf16 v8, v26, s34, v8
v_dot2_f32_bf16 v9, v26, v26, v9
v_dot2_f32_bf16 v8, v27, s34, v8
v_dot2_f32_bf16 v9, v27, v27, v9
v_dot2_f32_bf16 v8, v28, s34, v8
v_dot2_f32_bf16 v9, v28, v28, v9
v_dot2_f32_bf16 v8, v29, s34, v8
v_dot2_f32_bf16 v9, v29, v29, v9
v_dot2_f32_bf16 v8, v30, s34, v8
v_dot2_f32_bf16 v9, v30, v30, v9
v_dot2_f32_bf16 v8, v31, s34, v8
v_dot2_f32_bf16 v9, v31, v31, v9
s_nop 3
v_permlane32_swap_b32 v8, v9
s_nop 1
v_add_f32 v8, v8, v9
buffer_store_dword v8, v7, s[8:11], s21 offen sc1
s_add_u32 s20, s20, 8192
s_add_u32 s21, s21, 1024
s_waitcnt vmcnt(7)
buffer_store_dwordx4 v[32:35], v1, s[8:11], s20 offen offset:0 sc1
buffer_store_dwordx4 v[36:39], v1, s[8:11], s20 offen offset:1024 sc1
v_mov_b32 v10, 0
v_mov_b32 v11, 0
v_dot2_f32_bf16 v10, v32, s34, v10
v_dot2_f32_bf16 v11, v32, v32, v11
v_dot2_f32_bf16 v10, v33, s34, v10
v_dot2_f32_bf16 v11, v33, v33, v11
v_dot2_f32_bf16 v10, v34, s34, v10
v_dot2_f32_bf16 v11, v34, v34, v11
v_dot2_f32_bf16 v10, v35, s34, v10
v_dot2_f32_bf16 v11, v35, v35, v11
v_dot2_f32_bf16 v10, v36, s34, v10
v_dot2_f32_bf16 v11, v36, v36, v11
v_dot2_f32_bf16 v10, v37, s34, v10
v_dot2_f32_bf16 v11, v37, v37, v11
v_dot2_f32_bf16 v10, v38, s34, v10
v_dot2_f32_bf16 v11, v38, v38, v11
v_dot2_f32_bf16 v10, v39, s34, v10
v_dot2_f32_bf16 v11, v39, v39, v11
s_nop 3
v_permlane32_swap_b32 v10, v11
s_nop 1
v_add_f32 v10, v10, v11
buffer_store_dword v10, v7, s[8:11], s21 offen sc1
s_add_u32 s20, s20, 8192
s_add_u32 s21, s21, 1024
s_waitcnt vmcnt(8)
buffer_store_dwordx4 v[40:43], v1, s[8:11], s20 offen offset:0 sc1
buffer_store_dwordx4 v[44:47], v1, s[8:11], s20 offen offset:1024 sc1
v_mov_b32 v12, 0
v_mov_b32 v13, 0
v_dot2_f32_bf16 v12, v40, s34, v12
v_dot2_f32_bf16 v13, v40, v40, v13
v_dot2_f32_bf16 v12, v41, s34, v12
v_dot2_f32_bf16 v13, v41, v41, v13
v_dot2_f32_bf16 v12, v42, s34, v12
v_dot2_f32_bf16 v13, v42, v42, v13
v_dot2_f32_bf16 v12, v43, s34, v12
v_dot2_f32_bf16 v13, v43, v43, v13
v_dot2_f32_bf16 v12, v44, s34, v12
v_dot2_f32_bf16 v13, v44, v44, v13
v_dot2_f32_bf16 v12, v45, s34, v12
v_dot2_f32_bf16 v13, v45, v45, v13
v_dot2_f32_bf16 v12, v46, s34, v12
v_dot2_f32_bf16 v13, v46, v46, v13
v_dot2_f32_bf16 v12, v47, s34, v12
v_dot2_f32_bf16 v13, v47, v47, v13
s_nop 3
v_permlane32_swap_b32 v12, v13
s_nop 1
v_add_f32 v12, v12, v13
buffer_store_dword v12, v7, s[8:11], s21 offen sc1
s_add_u32 s20, s20, 8192
s_add_u32 s21, s21, 1024
s_cmp_lt_u32 s3, 2
s_cselect_b32 s15, 0, 0x70000000
s_add_u32 s20, s20, s15
s_add_u32 s21, s21, s15
s_waitcnt vmcnt(9)
buffer_store_dwordx4 v[48:51], v1, s[8:11], s20 offen offset:0 sc1
buffer_store_dwordx4 v[52:55], v1, s[8:11], s20 offen offset:1024 sc1
v_mov_b32 v14, 0
v_mov_b32 v15, 0
v_dot2_f32_bf16 v14, v48, s34, v14
v_dot2_f32_bf16 v15, v48, v48, v15
v_dot2_f32_bf16 v14, v49, s34, v14
v_dot2_f32_bf16 v15, v49, v49, v15
v_dot2_f32_bf16 v14, v50, s34, v14
v_dot2_f32_bf16 v15, v50, v50, v15
v_dot2_f32_bf16 v14, v51, s34, v14
v_dot2_f32_bf16 v15, v51, v51, v15
v_dot2_f32_bf16 v14, v52, s34, v14
v_dot2_f32_bf16 v15, v52, v52, v15
v_dot2_f32_bf16 v14, v53, s34, v14
v_dot2_f32_bf16 v15, v53, v53, v15
v_dot2_f32_bf16 v14, v54, s34, v14
v_dot2_f32_bf16 v15, v54, v54, v15
v_dot2_f32_bf16 v14, v55, s34, v14
v_dot2_f32_bf16 v15, v55, v55, v15
s_nop 3
v_permlane32_swap_b32 v14, v15
s_nop 1
v_add_f32 v14, v14, v15
buffer_store_dword v14, v7, s[8:11], s21 offen sc1
s_add_u32 s20, s20, 8192
s_add_u32 s21, s21, 1024
s_lshr_b32 s13, s14, 2
s_lshl_b32 s13, s13, 7
s_add_u32 s13, s13, 30036480
s_branch p_sig
p_qkv:
s_mov_b32 s28, s42
s_mov_b32 s29, s43
s_mov_b32 s30, 1204224
s_mov_b32 s31, 0x00020000
s_sub_u32 s14, s2, 144
s_and_b32 s15, s14, 7
s_lshl_b32 s15, s15, 1
s_bfe_u32 s16, s14, 0x10003
s_add_u32 s15, s15, s16
s_lshr_b32 s16, s14, 4
s_mul_i32 s25, s3, 301056
s_mul_i32 s18, s16, 896
s_add_u32 s25, s25, s18
s_mul_i32 s18, s15, 56
s_add_u32 s25, s25, s18
v_lshrrev_b32 v6, 2, v0
v_mul_u32_u24 v6, 2688, v6
v_and_b32 v23, 3, v0
v_lshlrev_b32 v23, 4, v23
v_min_u32 v23, 40, v23
v_add_u32 v6, v6, v23
buffer_load_dwordx4 v[24:27], v6, s[28:31], s25 offen offset:0
s_add_u32 s25, s25, 43008
buffer_load_dwordx4 v[28:31], v6, s[28:31], s25 offen offset:0
s_add_u32 s25, s25, 43008
buffer_load_dwordx4 v[32:35], v6, s[28:31], s25 offen offset:0
s_add_u32 s25, s25, 43008
buffer_load_dwordx4 v[36:39], v6, s[28:31], s25 offen offset:0
s_add_u32 s25, s25, 43008
buffer_load_dwordx4 v[40:43], v6, s[28:31], s25 offen offset:0
s_add_u32 s25, s25, 43008
buffer_load_dwordx4 v[44:47], v6, s[28:31], s25 offen offset:0
s_add_u32 s25, s25, 43008
buffer_load_dwordx4 v[48:51], v6, s[28:31], s25 offen offset:0
s_add_u32 s25, s25, 43008
s_mul_i32 s21, s15, 3
s_add_u32 s21, s21, s16
s_lshl_b32 s21, s21, 7
s_add_u32 s21, s21, 29360128
s_cmp_lt_u32 s16, 2
s_cselect_b64 s[30:31], -1, 0
s_mul_i32 s20, s15, 84
s_mul_i32 s17, s3, 21
s_add_u32 s20, s20, s17
s_add_u32 s20, s20, s16
s_lshl_b32 s20, s20, 10
s_add_u32 s20, s20, 4194304
v_lshl_add_u32 v22, v3, 3, v4
v_lshlrev_b32 v22, 6, v22
v_lshl_add_u32 v23, v21, 2, v5
v_cmp_eq_u32 vcc, 6, v23
v_cndmask_b32 v23, v23, 7, vcc
v_lshl_add_u32 v22, v23, 3, v22
v_add_u32 v22, s24, v22
s_waitcnt vmcnt(6)
ds_write_b128 v20, v[24:27] offset:0
s_waitcnt vmcnt(5)
ds_write_b128 v20, v[28:31] offset:1024
s_waitcnt vmcnt(4)
ds_write_b128 v20, v[32:35] offset:2048
s_waitcnt vmcnt(3)
ds_write_b128 v20, v[36:39] offset:3072
s_waitcnt vmcnt(2)
ds_write_b128 v20, v[40:43] offset:4096
s_waitcnt vmcnt(1)
ds_write_b128 v20, v[44:47] offset:5120
s_waitcnt vmcnt(0)
ds_write_b128 v20, v[48:51] offset:6144
s_waitcnt lgkmcnt(0)
ds_read_b64_tr_b16 v[64:65], v22 offset:0
ds_read_b64_tr_b16 v[66:67], v22 offset:256
ds_read_b64_tr_b16 v[68:69], v22 offset:1024
ds_read_b64_tr_b16 v[70:71], v22 offset:1280
ds_read_b64_tr_b16 v[72:73], v22 offset:2048
ds_read_b64_tr_b16 v[74:75], v22 offset:2304
ds_read_b64_tr_b16 v[76:77], v22 offset:3072
ds_read_b64_tr_b16 v[78:79], v22 offset:3328
ds_read_b64_tr_b16 v[80:81], v22 offset:4096
ds_read_b64_tr_b16 v[82:83], v22 offset:4352
ds_read_b64_tr_b16 v[84:85], v22 offset:5120
ds_read_b64_tr_b16 v[86:87], v22 offset:5376
ds_read_b64_tr_b16 v[88:89], v22 offset:6144
ds_read_b64_tr_b16 v[90:91], v22 offset:6400
s_waitcnt lgkmcnt(0)
s_mov_b32 s32, 0x0fffffff
s_mov_b32 s33, 0x0fffffff
v_cndmask_b32 v64, 0, v64, s[32:33]
v_cndmask_b32 v65, 0, v65, s[32:33]
v_cndmask_b32 v66, 0, v66, s[32:33]
v_cndmask_b32 v67, 0, v67, s[32:33]
v_cndmask_b32 v68, 0, v68, s[32:33]
v_cndmask_b32 v69, 0, v69, s[32:33]
v_cndmask_b32 v70, 0, v70, s[32:33]
v_cndmask_b32 v71, 0, v71, s[32:33]
v_cndmask_b32 v72, 0, v72, s[32:33]
v_cndmask_b32 v73, 0, v73, s[32:33]
v_cndmask_b32 v74, 0, v74, s[32:33]
v_cndmask_b32 v75, 0, v75, s[32:33]
v_cndmask_b32 v76, 0, v76, s[32:33]
v_cndmask_b32 v77, 0, v77, s[32:33]
v_cndmask_b32 v78, 0, v78, s[32:33]
v_cndmask_b32 v79, 0, v79, s[32:33]
v_cndmask_b32 v80, 0, v80, s[32:33]
v_cndmask_b32 v81, 0, v81, s[32:33]
v_cndmask_b32 v82, 0, v82, s[32:33]
v_cndmask_b32 v83, 0, v83, s[32:33]
v_cndmask_b32 v84, 0, v84, s[32:33]
v_cndmask_b32 v85, 0, v85, s[32:33]
v_cndmask_b32 v86, 0, v86, s[32:33]
v_cndmask_b32 v87, 0, v87, s[32:33]
v_cndmask_b32 v88, 0, v88, s[32:33]
v_cndmask_b32 v89, 0, v89, s[32:33]
v_cndmask_b32 v90, 0, v90, s[32:33]
v_cndmask_b32 v91, 0, v91, s[32:33]
buffer_store_dwordx4 v[64:67], v1, s[8:11], s20 offen sc1
s_add_u32 s20, s20, 3072
buffer_store_dwordx4 v[68:71], v1, s[8:11], s20 offen sc1
s_add_u32 s20, s20, 3072
buffer_store_dwordx4 v[72:75], v1, s[8:11], s20 offen sc1
s_add_u32 s20, s20, 3072
buffer_store_dwordx4 v[76:79], v1, s[8:11], s20 offen sc1
s_add_u32 s20, s20, 3072
buffer_store_dwordx4 v[80:83], v1, s[8:11], s20 offen sc1
s_add_u32 s20, s20, 3072
buffer_store_dwordx4 v[84:87], v1, s[8:11], s20 offen sc1
s_add_u32 s20, s20, 3072
buffer_store_dwordx4 v[88:91], v1, s[8:11], s20 offen sc1
s_add_u32 s20, s20, 3072
v_mov_b32 v16, 0
v_mov_b32 v17, 0
v_dot2_f32_bf16 v16, v64, s34, v16
v_dot2_f32_bf16 v17, v65, s34, v17
v_dot2_f32_bf16 v16, v66, s34, v16
v_dot2_f32_bf16 v17, v67, s34, v17
v_dot2_f32_bf16 v16, v68, s34, v16
v_dot2_f32_bf16 v17, v69, s34, v17
v_dot2_f32_bf16 v16, v70, s34, v16
v_dot2_f32_bf16 v17, v71, s34, v17
v_dot2_f32_bf16 v16, v72, s34, v16
v_dot2_f32_bf16 v17, v73, s34, v17
v_dot2_f32_bf16 v16, v74, s34, v16
v_dot2_f32_bf16 v17, v75, s34, v17
v_dot2_f32_bf16 v16, v76, s34, v16
v_dot2_f32_bf16 v17, v77, s34, v17
v_dot2_f32_bf16 v16, v78, s34, v16
v_dot2_f32_bf16 v17, v79, s34, v17
v_dot2_f32_bf16 v16, v80, s34, v16
v_dot2_f32_bf16 v17, v81, s34, v17
v_dot2_f32_bf16 v16, v82, s34, v16
v_dot2_f32_bf16 v17, v83, s34, v17
v_dot2_f32_bf16 v16, v84, s34, v16
v_dot2_f32_bf16 v17, v85, s34, v17
v_dot2_f32_bf16 v16, v86, s34, v16
v_dot2_f32_bf16 v17, v87, s34, v17
v_dot2_f32_bf16 v16, v88, s34, v16
v_dot2_f32_bf16 v17, v89, s34, v17
v_dot2_f32_bf16 v16, v90, s34, v16
v_dot2_f32_bf16 v17, v91, s34, v17
s_lshl_b32 s22, s3, 8
s_add_u32 s22, s22, 149504
v_lshl_add_u32 v18, v0, 2, s22
s_nop 2
v_add_f32 v16, v16, v17
ds_write_b32 v18, v16
s_waitcnt lgkmcnt(0)
s_barrier
v_lshlrev_b32 v17, 2, v2
v_add_u32 v17, 149504, v17
ds_read_b32 v24, v17 offset:0
ds_read_b32 v25, v17 offset:128
ds_read_b32 v26, v17 offset:256
ds_read_b32 v27, v17 offset:384
ds_read_b32 v28, v17 offset:512
ds_read_b32 v29, v17 offset:640
ds_read_b32 v30, v17 offset:768
ds_read_b32 v31, v17 offset:896
v_and_b32 v18, 3, v2
v_lshrrev_b32 v19, 3, v2
v_lshl_add_u32 v18, v19, 2, v18
v_bfe_u32 v19, v2, 2, 1
v_lshl_add_u32 v18, v19, 4, v18
v_cndmask_b32 v18, v2, v18, s[30:31]
v_lshlrev_b32 v18, 2, v18
s_waitcnt lgkmcnt(0)
v_add_f32 v24, v24, v25
v_add_f32 v24, v24, v26
v_add_f32 v24, v24, v27
v_add_f32 v24, v24, v28
v_add_f32 v24, v24, v29
v_add_f32 v24, v24, v30
v_add_f32 v24, v24, v31
buffer_store_dword v24, v18, s[8:11], s21 offen sc1
s_lshl_b32 s13, s15, 7
s_add_u32 s13, s13, 30038528
p_sig:
s_mov_b32 s28, s54
s_mov_b32 s29, s55
s_mov_b32 s30, 256
s_mov_b32 s31, 0x00020000
v_mov_b32 v5, 0
buffer_load_dword v4, v5, s[28:31], 0 offen sc1
buffer_load_dwordx4 v[208:211], v204, s[36:39], s35 offen
s_add_u32 s35, s35, s26
buffer_load_dwordx4 v[212:215], v204, s[56:59], s35 offen
s_add_u32 s35, s35, s27
buffer_load_dwordx4 v[216:219], v204, s[36:39], s35 offen
s_add_u32 s35, s35, s26
buffer_load_dwordx4 v[220:223], v204, s[56:59], s35 offen
s_add_u32 s35, s35, s27
buffer_load_dwordx4 v[224:227], v204, s[36:39], s35 offen
s_add_u32 s35, s35, s26
buffer_load_dwordx4 v[228:231], v204, s[56:59], s35 offen
s_add_u32 s35, s35, s27
buffer_load_dwordx4 v[232:235], v204, s[36:39], s35 offen
s_add_u32 s35, s35, s26
buffer_load_dwordx4 v[236:239], v204, s[56:59], s35 offen
s_add_u32 s35, s35, s27
s_waitcnt vmcnt(8)
s_barrier
s_cmp_lg_u32 s3, 0
s_cbranch_scc1 p_def
s_mov_b32 s60, 0
p_g1:
v_readfirstlane_b32 s61, v4
s_cmp_lg_u32 s61, 0
s_cbranch_scc1 p_g1x
s_add_u32 s60, s60, 1
s_cmp_gt_u32 s60, 40000
s_cbranch_scc1 main_kernel_end
s_sleep 2
buffer_load_dword v4, v5, s[28:31], 0 offen sc1
s_waitcnt vmcnt(0)
s_branch p_g1
p_g1x:
v_mov_b32 v4, 1
s_mov_b64 exec, 1
buffer_atomic_add v4, v5, s[8:11], s13 offen sc1
s_mov_b64 exec, -1
p_def:
v_add_u32 v2, 65536, v1
v_add_u32 v3, 65536, v2
s_and_b32 s40, s2, 3
s_lshl_b32 s40, s40, 2
s_bfe_u32 s13, s2, 0x20003
s_add_u32 s40, s40, s13
s_lshl_b32 s40, s40, 2
s_add_u32 s40, s40, s3
s_bfe_u32 s41, s2, 0x10002
s_lshl_b32 s41, s41, 3
s_lshr_b32 s14, s2, 5
s_add_u32 s41, s41, s14
s_mul_i32 s50, s3, 3072
s_mul_i32 s51, s41, 86016
s_add_u32 s51, s51, s50
s_add_u32 s51, s51, 4194304
s_mul_i32 s21, s40, 28672
s_add_u32 s21, s21, 0
s_mul_i32 s27, s40, 3584
s_add_u32 s27, s27, 29491200
s_mul_i32 s28, s41, 384
s_add_u32 s28, s28, 29360128
v_lshrrev_b32 v6, 5, v0
v_lshlrev_b32 v6, 6, v6
v_and_b32 v7, 31, v0
v_lshlrev_b32 v7, 2, v7
s_cmp_lg_u32 s3, 0
s_cbranch_scc1 p_wx
v_mov_b32 v5, 0
buffer_load_dword v4, v5, s[44:47], 0 offen sc1
s_waitcnt vmcnt(0)
s_mov_b32 s60, 0
p_g2:
v_readfirstlane_b32 s61, v4
s_cmp_lg_u32 s61, 0
s_cbranch_scc1 p_g2x
s_add_u32 s60, s60, 1
s_cmp_gt_u32 s60, 40000
s_cbranch_scc1 main_kernel_end
s_sleep 2
buffer_load_dword v4, v5, s[44:47], 0 offen sc1
s_waitcnt vmcnt(0)
s_branch p_g2
p_g2x:
s_lshr_b32 s12, s40, 2
s_lshl_b32 s12, s12, 7
s_lshl_b32 s13, s41, 7
s_add_u32 s13, s13, 2048
s_mov_b64 s[30:31], 1
v_mov_b32 v4, s12
v_mov_b32 v5, s13
v_cndmask_b32 v5, v5, v4, s[30:31]
v_cndmask_b32 v8, 3, 4, s[30:31]
s_mov_b32 s60, 0
s_mov_b32 s13, 30036480
p_w:
buffer_load_dword v4, v5, s[8:11], s13 offen sc1
s_add_u32 s60, s60, 1
s_waitcnt vmcnt(0)
v_cmp_ge_u32 vcc, v4, v8
s_nop 4
s_cmp_eq_u64 vcc, -1
s_cbranch_scc1 p_wx
s_cmp_gt_u32 s60, 40000
s_cbranch_scc1 main_kernel_end
s_sleep 4
s_branch p_w
p_wx:
s_barrier
s_add_u32 s26, s21, 0
buffer_load_dwordx4 a[0:3], v1, s[8:11], s26 offen offset:0 sc1
s_add_u32 s24, s50, 0
s_mov_b32 m0, s24
s_add_u32 s25, s51, 0
buffer_load_dwordx4 v1, s[8:11], s25 offen offset:0 lds
buffer_load_dwordx4 a[4:7], v1, s[8:11], s26 offen offset:1024 sc1
buffer_load_dwordx4 v1, s[8:11], s25 offen offset:1024 lds
buffer_load_dwordx4 a[8:11], v1, s[8:11], s26 offen offset:2048 sc1
buffer_load_dwordx4 v1, s[8:11], s25 offen offset:2048 lds
buffer_load_dwordx4 a[12:15], v1, s[8:11], s26 offen offset:3072 sc1
s_add_u32 s26, s21, 4096
buffer_load_dwordx4 a[16:19], v1, s[8:11], s26 offen offset:0 sc1
s_add_u32 s24, s50, 12288
s_mov_b32 m0, s24
s_add_u32 s25, s51, 12288
buffer_load_dwordx4 v1, s[8:11], s25 offen offset:0 lds
buffer_load_dwordx4 a[20:23], v1, s[8:11], s26 offen offset:1024 sc1
buffer_load_dwordx4 v1, s[8:11], s25 offen offset:1024 lds
buffer_load_dwordx4 a[24:27], v1, s[8:11], s26 offen offset:2048 sc1
buffer_load_dwordx4 v1, s[8:11], s25 offen offset:2048 lds
buffer_load_dwordx4 a[28:31], v1, s[8:11], s26 offen offset:3072 sc1
s_add_u32 s26, s21, 8192
buffer_load_dwordx4 a[32:35], v1, s[8:11], s26 offen offset:0 sc1
s_add_u32 s24, s50, 24576
s_mov_b32 m0, s24
s_add_u32 s25, s51, 24576
buffer_load_dwordx4 v1, s[8:11], s25 offen offset:0 lds
buffer_load_dwordx4 a[36:39], v1, s[8:11], s26 offen offset:1024 sc1
buffer_load_dwordx4 v1, s[8:11], s25 offen offset:1024 lds
buffer_load_dwordx4 a[40:43], v1, s[8:11], s26 offen offset:2048 sc1
buffer_load_dwordx4 v1, s[8:11], s25 offen offset:2048 lds
buffer_load_dwordx4 a[44:47], v1, s[8:11], s26 offen offset:3072 sc1
s_waitcnt vmcnt(14)
s_barrier
ds_read_b128 v[64:67], v1 offset:0
ds_read_b128 v[68:71], v1 offset:1024
ds_read_b128 v[72:75], v1 offset:2048
ds_read_b128 v[76:79], v1 offset:3072
ds_read_b128 v[80:83], v1 offset:4096
ds_read_b128 v[84:87], v1 offset:5120
s_waitcnt lgkmcnt(3)
v_mfma_f32_32x32x16_bf16 v[16:31], v[64:67], a[0:3], 0
ds_read_b128 v[88:91], v1 offset:6144
ds_read_b128 v[92:95], v1 offset:7168
ds_read_b128 v[96:99], v1 offset:8192
s_add_u32 s26, s21, 12288
buffer_load_dwordx4 a[48:51], v1, s[8:11], s26 offen offset:0 sc1
v_mfma_f32_32x32x16_bf16 v[32:47], v[68:71], a[0:3], 0
s_add_u32 s24, s50, 36864
s_mov_b32 m0, s24
s_add_u32 s25, s51, 36864
buffer_load_dwordx4 v1, s[8:11], s25 offen offset:0 lds
v_mfma_f32_32x32x16_bf16 v[48:63], a[0:3], v[72:75], 0
s_waitcnt lgkmcnt(3)
v_mfma_f32_32x32x16_bf16 v[16:31], v[76:79], a[4:7], v[16:31]
ds_read_b128 v[64:67], v1 offset:9216
ds_read_b128 v[68:71], v1 offset:10240
ds_read_b128 v[72:75], v1 offset:11264
buffer_load_dwordx4 a[52:55], v1, s[8:11], s26 offen offset:1024 sc1
v_mfma_f32_32x32x16_bf16 v[32:47], v[80:83], a[4:7], v[32:47]
buffer_load_dwordx4 v1, s[8:11], s25 offen offset:1024 lds
v_mfma_f32_32x32x16_bf16 v[48:63], a[4:7], v[84:87], v[48:63]
s_waitcnt lgkmcnt(3)
v_mfma_f32_32x32x16_bf16 v[16:31], v[88:91], a[8:11], v[16:31]
s_waitcnt vmcnt(11)
s_barrier
ds_read_b128 v[76:79], v1 offset:12288
ds_read_b128 v[80:83], v1 offset:13312
ds_read_b128 v[84:87], v1 offset:14336
buffer_load_dwordx4 a[56:59], v1, s[8:11], s26 offen offset:2048 sc1
v_mfma_f32_32x32x16_bf16 v[32:47], v[92:95], a[8:11], v[32:47]
buffer_load_dwordx4 v1, s[8:11], s25 offen offset:2048 lds
v_mfma_f32_32x32x16_bf16 v[48:63], a[8:11], v[96:99], v[48:63]
s_waitcnt lgkmcnt(3)
v_mfma_f32_32x32x16_bf16 v[16:31], v[64:67], a[12:15], v[16:31]
ds_read_b128 v[88:91], v1 offset:15360
ds_read_b128 v[92:95], v1 offset:16384
ds_read_b128 v[96:99], v1 offset:17408
buffer_load_dwordx4 a[60:63], v1, s[8:11], s26 offen offset:3072 sc1
v_mfma_f32_32x32x16_bf16 v[32:47], v[68:71], a[12:15], v[32:47]
v_mfma_f32_32x32x16_bf16 v[48:63], a[12:15], v[72:75], v[48:63]
s_waitcnt lgkmcnt(3)
v_mfma_f32_32x32x16_bf16 v[16:31], v[76:79], a[16:19], v[16:31]
ds_read_b128 v[64:67], v1 offset:18432
ds_read_b128 v[68:71], v1 offset:19456
ds_read_b128 v[72:75], v1 offset:20480
s_add_u32 s26, s21, 16384
buffer_load_dwordx4 a[64:67], v1, s[8:11], s26 offen offset:0 sc1
v_mfma_f32_32x32x16_bf16 v[32:47], v[80:83], a[16:19], v[32:47]
s_add_u32 s24, s50, 49152
s_mov_b32 m0, s24
s_add_u32 s25, s51, 49152
buffer_load_dwordx4 v1, s[8:11], s25 offen offset:0 lds
v_mfma_f32_32x32x16_bf16 v[48:63], a[16:19], v[84:87], v[48:63]
s_waitcnt lgkmcnt(3)
v_mfma_f32_32x32x16_bf16 v[16:31], v[88:91], a[20:23], v[16:31]
ds_read_b128 v[76:79], v1 offset:21504
ds_read_b128 v[80:83], v1 offset:22528
ds_read_b128 v[84:87], v1 offset:23552
buffer_load_dwordx4 a[68:71], v1, s[8:11], s26 offen offset:1024 sc1
v_mfma_f32_32x32x16_bf16 v[32:47], v[92:95], a[20:23], v[32:47]
buffer_load_dwordx4 v1, s[8:11], s25 offen offset:1024 lds
v_mfma_f32_32x32x16_bf16 v[48:63], a[20:23], v[96:99], v[48:63]
s_waitcnt lgkmcnt(3)
v_mfma_f32_32x32x16_bf16 v[16:31], v[64:67], a[24:27], v[16:31]
s_waitcnt vmcnt(11)
s_barrier
ds_read_b128 v[88:91], v1 offset:24576
ds_read_b128 v[92:95], v1 offset:25600
ds_read_b128 v[96:99], v1 offset:26624
buffer_load_dwordx4 a[72:75], v1, s[8:11], s26 offen offset:2048 sc1
v_mfma_f32_32x32x16_bf16 v[32:47], v[68:71], a[24:27], v[32:47]
buffer_load_dwordx4 v1, s[8:11], s25 offen offset:2048 lds
v_mfma_f32_32x32x16_bf16 v[48:63], a[24:27], v[72:75], v[48:63]
s_waitcnt lgkmcnt(3)
v_mfma_f32_32x32x16_bf16 v[16:31], v[76:79], a[28:31], v[16:31]
ds_read_b128 v[64:67], v1 offset:27648
ds_read_b128 v[68:71], v1 offset:28672
ds_read_b128 v[72:75], v1 offset:29696
buffer_load_dwordx4 a[76:79], v1, s[8:11], s26 offen offset:3072 sc1
v_mfma_f32_32x32x16_bf16 v[32:47], v[80:83], a[28:31], v[32:47]
v_mfma_f32_32x32x16_bf16 v[48:63], a[28:31], v[84:87], v[48:63]
s_waitcnt lgkmcnt(3)
v_mfma_f32_32x32x16_bf16 v[16:31], v[88:91], a[32:35], v[16:31]
ds_read_b128 v[76:79], v1 offset:30720
ds_read_b128 v[80:83], v1 offset:31744
ds_read_b128 v[84:87], v1 offset:32768
s_add_u32 s26, s21, 20480
buffer_load_dwordx4 a[80:83], v1, s[8:11], s26 offen offset:0 sc1
v_mfma_f32_32x32x16_bf16 v[32:47], v[92:95], a[32:35], v[32:47]
s_add_u32 s24, s50, 61440
s_mov_b32 m0, s24
s_add_u32 s25, s51, 61440
buffer_load_dwordx4 v1, s[8:11], s25 offen offset:0 lds
v_mfma_f32_32x32x16_bf16 v[48:63], a[32:35], v[96:99], v[48:63]
s_waitcnt lgkmcnt(3)
v_mfma_f32_32x32x16_bf16 v[16:31], v[64:67], a[36:39], v[16:31]
ds_read_b128 v[88:91], v1 offset:33792
ds_read_b128 v[92:95], v1 offset:34816
ds_read_b128 v[96:99], v1 offset:35840
buffer_load_dwordx4 a[84:87], v1, s[8:11], s26 offen offset:1024 sc1
v_mfma_f32_32x32x16_bf16 v[32:47], v[68:71], a[36:39], v[32:47]
buffer_load_dwordx4 v1, s[8:11], s25 offen offset:1024 lds
v_mfma_f32_32x32x16_bf16 v[48:63], a[36:39], v[72:75], v[48:63]
s_waitcnt lgkmcnt(3)
v_mfma_f32_32x32x16_bf16 v[16:31], v[76:79], a[40:43], v[16:31]
s_waitcnt vmcnt(11)
s_barrier
ds_read_b128 v[64:67], v1 offset:36864
ds_read_b128 v[68:71], v1 offset:37888
ds_read_b128 v[72:75], v1 offset:38912
buffer_load_dwordx4 a[88:91], v1, s[8:11], s26 offen offset:2048 sc1
v_mfma_f32_32x32x16_bf16 v[32:47], v[80:83], a[40:43], v[32:47]
buffer_load_dwordx4 v1, s[8:11], s25 offen offset:2048 lds
v_mfma_f32_32x32x16_bf16 v[48:63], a[40:43], v[84:87], v[48:63]
s_waitcnt lgkmcnt(3)
v_mfma_f32_32x32x16_bf16 v[16:31], v[88:91], a[44:47], v[16:31]
ds_read_b128 v[76:79], v1 offset:39936
ds_read_b128 v[80:83], v1 offset:40960
ds_read_b128 v[84:87], v1 offset:41984
buffer_load_dwordx4 a[92:95], v1, s[8:11], s26 offen offset:3072 sc1
v_mfma_f32_32x32x16_bf16 v[32:47], v[92:95], a[44:47], v[32:47]
v_mfma_f32_32x32x16_bf16 v[48:63], a[44:47], v[96:99], v[48:63]
s_waitcnt lgkmcnt(3)
v_mfma_f32_32x32x16_bf16 v[16:31], v[64:67], a[48:51], v[16:31]
ds_read_b128 v[88:91], v1 offset:43008
ds_read_b128 v[92:95], v1 offset:44032
ds_read_b128 v[96:99], v1 offset:45056
s_add_u32 s26, s21, 24576
buffer_load_dwordx4 a[96:99], v1, s[8:11], s26 offen offset:0 sc1
v_mfma_f32_32x32x16_bf16 v[32:47], v[68:71], a[48:51], v[32:47]
s_add_u32 s24, s50, 73728
s_mov_b32 m0, s24
s_add_u32 s25, s51, 73728
buffer_load_dwordx4 v1, s[8:11], s25 offen offset:0 lds
v_mfma_f32_32x32x16_bf16 v[48:63], a[48:51], v[72:75], v[48:63]
s_waitcnt lgkmcnt(3)
v_mfma_f32_32x32x16_bf16 v[16:31], v[76:79], a[52:55], v[16:31]
ds_read_b128 v[64:67], v1 offset:46080
ds_read_b128 v[68:71], v1 offset:47104
ds_read_b128 v[72:75], v1 offset:48128
buffer_load_dwordx4 a[100:103], v1, s[8:11], s26 offen offset:1024 sc1
v_mfma_f32_32x32x16_bf16 v[32:47], v[80:83], a[52:55], v[32:47]
buffer_load_dwordx4 v1, s[8:11], s25 offen offset:1024 lds
v_mfma_f32_32x32x16_bf16 v[48:63], a[52:55], v[84:87], v[48:63]
s_waitcnt lgkmcnt(3)
v_mfma_f32_32x32x16_bf16 v[16:31], v[88:91], a[56:59], v[16:31]
s_waitcnt vmcnt(11)
s_barrier
ds_read_b128 v[76:79], v1 offset:49152
ds_read_b128 v[80:83], v1 offset:50176
ds_read_b128 v[84:87], v1 offset:51200
buffer_load_dwordx4 a[104:107], v1, s[8:11], s26 offen offset:2048 sc1
v_mfma_f32_32x32x16_bf16 v[32:47], v[92:95], a[56:59], v[32:47]
buffer_load_dwordx4 v1, s[8:11], s25 offen offset:2048 lds
v_mfma_f32_32x32x16_bf16 v[48:63], a[56:59], v[96:99], v[48:63]
s_waitcnt lgkmcnt(3)
v_mfma_f32_32x32x16_bf16 v[16:31], v[64:67], a[60:63], v[16:31]
ds_read_b128 v[88:91], v1 offset:52224
ds_read_b128 v[92:95], v1 offset:53248
ds_read_b128 v[96:99], v1 offset:54272
buffer_load_dwordx4 a[108:111], v1, s[8:11], s26 offen offset:3072 sc1
v_mfma_f32_32x32x16_bf16 v[32:47], v[68:71], a[60:63], v[32:47]
v_mfma_f32_32x32x16_bf16 v[48:63], a[60:63], v[72:75], v[48:63]
s_waitcnt lgkmcnt(3)
v_mfma_f32_32x32x16_bf16 v[16:31], v[76:79], a[64:67], v[16:31]
ds_read_b128 v[64:67], v1 offset:55296
ds_read_b128 v[68:71], v1 offset:56320
ds_read_b128 v[72:75], v1 offset:57344
v_and_b32 v4, 31, v0
v_lshlrev_b32 v4, 3, v4
v_lshrrev_b32 v5, 5, v0
v_mul_u32_u24 v5, 1792, v5
v_add_u32 v4, v4, v5
buffer_load_dwordx2 v[100:101], v4, s[8:11], s27 offen offset:0 sc1
buffer_load_dwordx2 v[102:103], v4, s[8:11], s27 offen offset:256 sc1
buffer_load_dwordx2 v[104:105], v4, s[8:11], s27 offen offset:512 sc1
buffer_load_dwordx2 v[106:107], v4, s[8:11], s27 offen offset:768 sc1
buffer_load_dwordx2 v[108:109], v4, s[8:11], s27 offen offset:1024 sc1
buffer_load_dwordx2 v[110:111], v4, s[8:11], s27 offen offset:1280 sc1
buffer_load_dwordx2 v[112:113], v4, s[8:11], s27 offen offset:1536 sc1
v_mfma_f32_32x32x16_bf16 v[32:47], v[80:83], a[64:67], v[32:47]
buffer_load_dwordx4 v[116:119], v6, s[8:11], s28 offen offset:0 sc1
v_mfma_f32_32x32x16_bf16 v[48:63], a[64:67], v[84:87], v[48:63]
buffer_load_dwordx4 v[120:123], v6, s[8:11], s28 offen offset:16 sc1
s_waitcnt lgkmcnt(3)
v_mfma_f32_32x32x16_bf16 v[16:31], v[88:91], a[68:71], v[16:31]
ds_read_b128 v[76:79], v1 offset:58368
ds_read_b128 v[80:83], v1 offset:59392
ds_read_b128 v[84:87], v1 offset:60416
buffer_load_dwordx4 v[124:127], v6, s[8:11], s28 offen offset:32 sc1
v_mfma_f32_32x32x16_bf16 v[32:47], v[92:95], a[68:71], v[32:47]
buffer_load_dwordx4 v[128:131], v6, s[8:11], s28 offen offset:48 sc1
v_mfma_f32_32x32x16_bf16 v[48:63], a[68:71], v[96:99], v[48:63]
buffer_load_dwordx4 v[132:135], v6, s[8:11], s28 offen offset:128 sc1
s_waitcnt lgkmcnt(3)
v_mfma_f32_32x32x16_bf16 v[16:31], v[64:67], a[72:75], v[16:31]
s_waitcnt vmcnt(19)
s_barrier
ds_read_b128 v[88:91], v1 offset:61440
ds_read_b128 v[92:95], v1 offset:62464
ds_read_b128 v[96:99], v1 offset:63488
buffer_load_dwordx4 v[136:139], v6, s[8:11], s28 offen offset:144 sc1
v_mfma_f32_32x32x16_bf16 v[32:47], v[68:71], a[72:75], v[32:47]
buffer_load_dwordx4 v[140:143], v6, s[8:11], s28 offen offset:160 sc1
v_mfma_f32_32x32x16_bf16 v[48:63], a[72:75], v[72:75], v[48:63]
buffer_load_dwordx4 v[144:147], v6, s[8:11], s28 offen offset:176 sc1
s_waitcnt lgkmcnt(3)
v_mfma_f32_32x32x16_bf16 v[16:31], v[76:79], a[76:79], v[16:31]
ds_read_b128 v[64:67], v1 offset:64512
ds_read_b128 v[68:71], v2 offset:0
ds_read_b128 v[72:75], v2 offset:1024
buffer_load_dword v8, v7, s[8:11], s28 offen offset:256
v_mfma_f32_32x32x16_bf16 v[32:47], v[80:83], a[76:79], v[32:47]
v_mfma_f32_32x32x16_bf16 v[48:63], a[76:79], v[84:87], v[48:63]
s_waitcnt lgkmcnt(3)
v_mfma_f32_32x32x16_bf16 v[16:31], v[88:91], a[80:83], v[16:31]
ds_read_b128 v[76:79], v2 offset:2048
ds_read_b128 v[80:83], v2 offset:3072
ds_read_b128 v[84:87], v2 offset:4096
v_mfma_f32_32x32x16_bf16 v[32:47], v[92:95], a[80:83], v[32:47]
v_mfma_f32_32x32x16_bf16 v[48:63], a[80:83], v[96:99], v[48:63]
s_waitcnt lgkmcnt(3)
v_mfma_f32_32x32x16_bf16 v[16:31], v[64:67], a[84:87], v[16:31]
ds_read_b128 v[88:91], v2 offset:5120
ds_read_b128 v[92:95], v2 offset:6144
ds_read_b128 v[96:99], v2 offset:7168
v_mfma_f32_32x32x16_bf16 v[32:47], v[68:71], a[84:87], v[32:47]
v_mfma_f32_32x32x16_bf16 v[48:63], a[84:87], v[72:75], v[48:63]
s_waitcnt lgkmcnt(3)
v_mfma_f32_32x32x16_bf16 v[16:31], v[76:79], a[88:91], v[16:31]
s_waitcnt vmcnt(16)
s_barrier
ds_read_b128 v[64:67], v2 offset:8192
ds_read_b128 v[68:71], v2 offset:9216
ds_read_b128 v[72:75], v2 offset:10240
v_mfma_f32_32x32x16_bf16 v[32:47], v[80:83], a[88:91], v[32:47]
v_mfma_f32_32x32x16_bf16 v[48:63], a[88:91], v[84:87], v[48:63]
s_waitcnt lgkmcnt(3)
v_mfma_f32_32x32x16_bf16 v[16:31], v[88:91], a[92:95], v[16:31]
ds_read_b128 v[76:79], v2 offset:11264
ds_read_b128 v[80:83], v2 offset:12288
ds_read_b128 v[84:87], v2 offset:13312
v_mfma_f32_32x32x16_bf16 v[32:47], v[92:95], a[92:95], v[32:47]
v_mfma_f32_32x32x16_bf16 v[48:63], a[92:95], v[96:99], v[48:63]
s_waitcnt lgkmcnt(3)
v_mfma_f32_32x32x16_bf16 v[16:31], v[64:67], a[96:99], v[16:31]
ds_read_b128 v[88:91], v2 offset:14336
ds_read_b128 v[92:95], v2 offset:15360
ds_read_b128 v[96:99], v2 offset:16384
v_mfma_f32_32x32x16_bf16 v[32:47], v[68:71], a[96:99], v[32:47]
v_mfma_f32_32x32x16_bf16 v[48:63], a[96:99], v[72:75], v[48:63]
s_waitcnt lgkmcnt(3)
v_mfma_f32_32x32x16_bf16 v[16:31], v[76:79], a[100:103], v[16:31]
ds_read_b128 v[64:67], v2 offset:17408
ds_read_b128 v[68:71], v2 offset:18432
ds_read_b128 v[72:75], v2 offset:19456
v_mfma_f32_32x32x16_bf16 v[32:47], v[80:83], a[100:103], v[32:47]
v_mfma_f32_32x32x16_bf16 v[48:63], a[100:103], v[84:87], v[48:63]
s_waitcnt lgkmcnt(3)
v_mfma_f32_32x32x16_bf16 v[16:31], v[88:91], a[104:107], v[16:31]
v_mfma_f32_32x32x16_bf16 v[32:47], v[92:95], a[104:107], v[32:47]
v_mfma_f32_32x32x16_bf16 v[48:63], a[104:107], v[96:99], v[48:63]
s_waitcnt lgkmcnt(0)
v_mfma_f32_32x32x16_bf16 v[16:31], v[64:67], a[108:111], v[16:31]
v_mfma_f32_32x32x16_bf16 v[32:47], v[68:71], a[108:111], v[32:47]
v_mfma_f32_32x32x16_bf16 v[48:63], a[108:111], v[72:75], v[48:63]
s_and_b32 s42, s2, 7
s_lshl_b32 s42, s42, 1
s_bfe_u32 s13, s2, 0x10003
s_add_u32 s42, s42, s13
s_lshr_b32 s43, s2, 4
s_and_b32 s12, s2, 7
s_lshr_b32 s13, s2, 3
s_mul_hi_u32 s14, s13, 613566757
s_mul_i32 s16, s14, 7
s_sub_u32 s15, s13, s16
s_lshl_b32 s12, s12, 2
s_add_u32 s12, s12, s14
s_lshr_b32 s16, s3, 1
s_and_b32 s17, s3, 1
s_lshl_b32 s12, s12, 1
s_add_u32 s44, s12, s16
s_xor_b32 s45, s44, 1
s_lshl_b32 s15, s15, 1
s_add_u32 s46, s15, s17
s_xor_b32 s47, s46, 1
s_and_b32 s48, s2, 1
s_lshl_b32 s48, s48, 3
s_bfe_u32 s13, s2, 0x30003
s_add_u32 s48, s48, s13
s_lshl_b32 s48, s48, 2
s_add_u32 s48, s48, s3
s_bfe_u32 s49, s2, 0x20001
s_lshl_b32 s49, s49, 2
s_lshr_b32 s14, s2, 6
s_add_u32 s49, s49, s14
s_mul_i32 s52, s49, 200704
s_add_u32 s52, s52, 7340032
s_mul_i32 s53, s3, 7168
s_add_u32 s54, s52, s53
s_add_u32 s52, s52, s50
s_mul_i32 s55, s46, 32768
s_mul_i32 s13, s3, 8192
s_add_u32 s55, s55, s13
s_add_u32 s55, s55, 6291456
s_mul_i32 s56, s47, 32768
s_mul_i32 s13, s3, 8192
s_add_u32 s56, s56, s13
s_add_u32 s56, s56, 6291456
s_mul_i32 s57, s46, 114688
s_mul_i32 s13, s3, 28672
s_add_u32 s57, s57, s13
s_add_u32 s57, s57, 11534336
s_mul_i32 s58, s47, 114688
s_mul_i32 s13, s3, 28672
s_add_u32 s58, s58, s13
s_add_u32 s58, s58, 11534336
s_waitcnt vmcnt(0)
v_add_f32 v100, v100, v102
v_add_f32 v101, v101, v103
v_add_f32 v100, v100, v104
v_add_f32 v101, v101, v105
v_add_f32 v100, v100, v106
v_add_f32 v101, v101, v107
v_add_f32 v100, v100, v108
v_add_f32 v101, v101, v109
v_add_f32 v100, v100, v110
v_add_f32 v101, v101, v111
v_add_f32 v100, v100, v112
v_add_f32 v101, v101, v113
v_mov_b32 v102, v100
v_mov_b32 v103, v101
s_nop 1
v_permlane32_swap_b32 v100, v102
v_permlane32_swap_b32 v101, v103
s_nop 1
v_add_f32 v100, v100, v102
v_add_f32 v101, v101, v103
v_mul_f32 v9, 0x3b124925, v100
v_mul_f32 v101, 0x3b124925, v101
v_fma_f32 v101, -v9, v9, v101
v_max_f32 v101, 0, v101
v_add_f32 v101, 0x3727c5ac, v101
v_rsq_f32 v10, v101
s_nop 0
v_mul_f32 v11, v9, v10
s_lshl_b32 s29, s3, 8
s_add_u32 s29, s29, 86016
v_lshrrev_b32 v12, 5, v0
v_lshl_add_u32 v13, v12, 7, v7
v_add_u32 v13, s29, v13
s_mov_b32 s30, 0
s_mov_b32 s31, -1
v_cndmask_b32 v14, v10, v11, s[30:31]
ds_write_b32 v13, v14
v_lshl_add_u32 v12, v12, 4, s29
s_waitcnt lgkmcnt(0)
ds_read_b128 v[148:151], v12 offset:0
ds_read_b128 v[164:167], v12 offset:128
ds_read_b128 v[152:155], v12 offset:32
ds_read_b128 v[168:171], v12 offset:160
ds_read_b128 v[156:159], v12 offset:64
ds_read_b128 v[172:175], v12 offset:192
ds_read_b128 v[160:163], v12 offset:96
ds_read_b128 v[176:179], v12 offset:224
v_mul_f32 v12, 0x3e8b97f6, v10
s_lshl_b32 s14, s41, 6
s_add_u32 s14, s14, s40
s_lshl_b32 s15, s14, 11
s_add_u32 s15, s15, 13631488
s_lshl_b32 s16, s14, 12
s_add_u32 s16, s16, 15728640
s_mov_b32 s34, 0x3f803f80
v_mov_b32 v15, s34
s_mov_b32 s32, 0x10000000
s_mov_b32 s33, 0x10000000
v_fma_f32 v32, -v9, v132, v32
v_fma_f32 v33, -v9, v133, v33
v_fma_f32 v34, -v9, v134, v34
v_fma_f32 v35, -v9, v135, v35
v_fma_f32 v36, -v9, v136, v36
v_fma_f32 v37, -v9, v137, v37
v_fma_f32 v38, -v9, v138, v38
v_fma_f32 v39, -v9, v139, v39
v_fma_f32 v40, -v9, v140, v40
v_fma_f32 v41, -v9, v141, v41
v_fma_f32 v42, -v9, v142, v42
v_fma_f32 v43, -v9, v143, v43
v_fma_f32 v44, -v9, v144, v44
v_fma_f32 v45, -v9, v145, v45
v_fma_f32 v46, -v9, v146, v46
v_fma_f32 v47, -v9, v147, v47
v_mul_f32 v32, v32, v10
v_mul_f32 v33, v33, v10
v_mul_f32 v34, v34, v10
v_mul_f32 v35, v35, v10
v_mul_f32 v36, v36, v10
v_mul_f32 v37, v37, v10
v_mul_f32 v38, v38, v10
v_mul_f32 v39, v39, v10
v_mul_f32 v40, v40, v10
v_mul_f32 v41, v41, v10
v_mul_f32 v42, v42, v10
v_mul_f32 v43, v43, v10
v_mul_f32 v44, v44, v10
v_mul_f32 v45, v45, v10
v_mul_f32 v46, v46, v10
v_mul_f32 v47, v47, v10
v_cvt_pk_bf16_f32 v188, v32, v33
v_cvt_pk_bf16_f32 v189, v34, v35
v_cvt_pk_bf16_f32 v190, v36, v37
v_cvt_pk_bf16_f32 v191, v38, v39
v_cvt_pk_bf16_f32 v192, v40, v41
v_cvt_pk_bf16_f32 v193, v42, v43
v_cvt_pk_bf16_f32 v194, v44, v45
v_cvt_pk_bf16_f32 v195, v46, v47
v_cndmask_b32 v194, v194, v15, s[30:31]
buffer_store_dwordx4 v[188:191], v1, s[8:11], s16 offen offset:0 sc1
buffer_store_dwordx4 v[192:195], v1, s[8:11], s16 offen offset:1024 sc1
s_waitcnt lgkmcnt(0)
v_mul_f32 v48, v48, v148
v_mul_f32 v49, v49, v149
v_mul_f32 v50, v50, v150
v_mul_f32 v51, v51, v151
v_mul_f32 v52, v52, v152
v_mul_f32 v53, v53, v153
v_mul_f32 v54, v54, v154
v_mul_f32 v55, v55, v155
v_mul_f32 v56, v56, v156
v_mul_f32 v57, v57, v157
v_mul_f32 v58, v58, v158
v_mul_f32 v59, v59, v159
v_mul_f32 v60, v60, v160
v_mul_f32 v61, v61, v161
v_mul_f32 v62, v62, v162
v_mul_f32 v63, v63, v163
v_fma_f32 v48, -v164, v8, v48
v_fma_f32 v49, -v165, v8, v49
v_fma_f32 v50, -v166, v8, v50
v_fma_f32 v51, -v167, v8, v51
v_fma_f32 v52, -v168, v8, v52
v_fma_f32 v53, -v169, v8, v53
v_fma_f32 v54, -v170, v8, v54
v_fma_f32 v55, -v171, v8, v55
v_fma_f32 v56, -v172, v8, v56
v_fma_f32 v57, -v173, v8, v57
v_fma_f32 v58, -v174, v8, v58
v_fma_f32 v59, -v175, v8, v59
v_fma_f32 v60, -v176, v8, v60
v_fma_f32 v61, -v177, v8, v61
v_fma_f32 v62, -v178, v8, v62
v_fma_f32 v63, -v179, v8, v63
v_cvt_pk_bf16_f32 v196, v48, v49
v_cvt_pk_bf16_f32 v197, v50, v51
v_cvt_pk_bf16_f32 v198, v52, v53
v_cvt_pk_bf16_f32 v199, v54, v55
v_cvt_pk_bf16_f32 v200, v56, v57
v_cvt_pk_bf16_f32 v201, v58, v59
v_cvt_pk_bf16_f32 v202, v60, v61
v_cvt_pk_bf16_f32 v203, v62, v63
v_cndmask_b32 v196, v196, v15, s[32:33]
v_cndmask_b32 v197, v197, v15, s[32:33]
v_cndmask_b32 v198, v198, v15, s[32:33]
v_cndmask_b32 v199, v199, v15, s[32:33]
v_cndmask_b32 v200, v200, v15, s[32:33]
v_cndmask_b32 v201, v201, v15, s[32:33]
v_cndmask_b32 v202, v202, v15, s[32:33]
v_cndmask_b32 v203, v203, v15, s[32:33]
buffer_store_dwordx4 v[196:199], v1, s[8:11], s16 offen offset:2048 sc1
buffer_store_dwordx4 v[200:203], v1, s[8:11], s16 offen offset:3072 sc1
v_fma_f32 v16, -v9, v116, v16
v_fma_f32 v17, -v9, v117, v17
v_fma_f32 v18, -v9, v118, v18
v_fma_f32 v19, -v9, v119, v19
v_fma_f32 v20, -v9, v120, v20
v_fma_f32 v21, -v9, v121, v21
v_fma_f32 v22, -v9, v122, v22
v_fma_f32 v23, -v9, v123, v23
v_fma_f32 v24, -v9, v124, v24
v_fma_f32 v25, -v9, v125, v25
v_fma_f32 v26, -v9, v126, v26
v_fma_f32 v27, -v9, v127, v27
v_fma_f32 v28, -v9, v128, v28
v_fma_f32 v29, -v9, v129, v29
v_fma_f32 v30, -v9, v130, v30
v_fma_f32 v31, -v9, v131, v31
v_mul_f32 v16, v16, v12
v_mul_f32 v17, v17, v12
v_mul_f32 v18, v18, v12
v_mul_f32 v19, v19, v12
v_mul_f32 v20, v20, v12
v_mul_f32 v21, v21, v12
v_mul_f32 v22, v22, v12
v_mul_f32 v23, v23, v12
v_mul_f32 v24, v24, v12
v_mul_f32 v25, v25, v12
v_mul_f32 v26, v26, v12
v_mul_f32 v27, v27, v12
v_mul_f32 v28, v28, v12
v_mul_f32 v29, v29, v12
v_mul_f32 v30, v30, v12
v_mul_f32 v31, v31, v12
v_cvt_pk_bf16_f32 v180, v16, v17
v_cvt_pk_bf16_f32 v181, v18, v19
v_cvt_pk_bf16_f32 v182, v20, v21
v_cvt_pk_bf16_f32 v183, v22, v23
v_cvt_pk_bf16_f32 v184, v24, v25
v_cvt_pk_bf16_f32 v185, v26, v27
v_cvt_pk_bf16_f32 v186, v28, v29
v_cvt_pk_bf16_f32 v187, v30, v31
buffer_store_dwordx4 v[180:183], v1, s[8:11], s15 offen offset:0 sc1
buffer_store_dwordx4 v[184:187], v1, s[8:11], s15 offen offset:1024 sc1
s_lshl_b32 s13, s41, 7
s_add_u32 s13, s13, 30015488
s_waitcnt vmcnt(0)
s_barrier
s_cmp_lg_u32 s3, 0
s_cbranch_scc1 main_kernel_sg2
v_mov_b32 v4, 1
v_mov_b32 v5, 0
s_mov_b64 exec, 1
buffer_atomic_add v4, v5, s[8:11], s13 offen sc1
s_mov_b64 exec, -1
main_kernel_sg2:
s_cmp_ge_u32 s63, 182
s_cbranch_scc1 q_end
v_and_b32 v2, 31, v0
v_lshrrev_b32 v3, 5, v0
v_bfe_u32 v4, v0, 2, 2
v_and_b32 v5, 1, v0
v_lshlrev_b32 v5, 1, v5
v_bfe_u32 v6, v0, 1, 1
v_or_b32 v5, v5, v6
s_mul_i32 s24, s3, 8704
s_add_u32 s24, s24, 114688
v_add_u32 v20, s24, v1
v_bfe_u32 v21, v0, 4, 1
s_mov_b32 s34, 0x3f803f80
s_cmp_lt_u32 s63, 112
s_cbranch_scc1 q_gu
s_cmp_lt_u32 s63, 168
s_cbranch_scc1 q_wd
s_sub_u32 s15, s63, 168
s_lshl_b32 s20, s15, 5
s_lshl_b32 s17, s3, 3
s_add_u32 s20, s20, s17
s_lshl_b32 s20, s20, 10
s_add_u32 s20, s20, 6291456
v_lshl_add_u32 v22, v3, 3, v4
v_lshlrev_b32 v22, 6, v22
v_lshl_add_u32 v23, v21, 2, v5
v_lshl_add_u32 v22, v23, 3, v22
v_add_u32 v22, s24, v22
ds_write_b128 v20, v[208:211] offset:0
ds_write_b128 v20, v[212:215] offset:1024
ds_write_b128 v20, v[216:219] offset:2048
ds_write_b128 v20, v[220:223] offset:3072
ds_write_b128 v20, v[224:227] offset:4096
ds_write_b128 v20, v[228:231] offset:5120
ds_write_b128 v20, v[232:235] offset:6144
ds_write_b128 v20, v[236:239] offset:7168
s_waitcnt lgkmcnt(0)
ds_read_b64_tr_b16 v[64:65], v22 offset:0
ds_read_b64_tr_b16 v[66:67], v22 offset:256
ds_read_b64_tr_b16 v[68:69], v22 offset:1024
ds_read_b64_tr_b16 v[70:71], v22 offset:1280
ds_read_b64_tr_b16 v[72:73], v22 offset:2048
ds_read_b64_tr_b16 v[74:75], v22 offset:2304
ds_read_b64_tr_b16 v[76:77], v22 offset:3072
ds_read_b64_tr_b16 v[78:79], v22 offset:3328
ds_read_b64_tr_b16 v[80:81], v22 offset:4096
ds_read_b64_tr_b16 v[82:83], v22 offset:4352
ds_read_b64_tr_b16 v[84:85], v22 offset:5120
ds_read_b64_tr_b16 v[86:87], v22 offset:5376
ds_read_b64_tr_b16 v[88:89], v22 offset:6144
ds_read_b64_tr_b16 v[90:91], v22 offset:6400
ds_read_b64_tr_b16 v[92:93], v22 offset:7168
ds_read_b64_tr_b16 v[94:95], v22 offset:7424
s_waitcnt lgkmcnt(0)
s_mov_b32 s30, -1
s_mov_b32 s31, 0
v_cndmask_b32 v70, 0, v70, s[30:31]
v_cndmask_b32 v71, 0, v71, s[30:31]
v_cndmask_b32 v78, 0, v78, s[30:31]
v_cndmask_b32 v79, 0, v79, s[30:31]
v_cndmask_b32 v86, 0, v86, s[30:31]
v_cndmask_b32 v87, 0, v87, s[30:31]
v_cndmask_b32 v94, 0, v94, s[30:31]
v_cndmask_b32 v95, 0, v95, s[30:31]
buffer_store_dwordx4 v[64:67], v1, s[8:11], s20 offen sc1
s_add_u32 s20, s20, 1024
buffer_store_dwordx4 v[68:71], v1, s[8:11], s20 offen sc1
s_add_u32 s20, s20, 1024
buffer_store_dwordx4 v[72:75], v1, s[8:11], s20 offen sc1
s_add_u32 s20, s20, 1024
buffer_store_dwordx4 v[76:79], v1, s[8:11], s20 offen sc1
s_add_u32 s20, s20, 1024
buffer_store_dwordx4 v[80:83], v1, s[8:11], s20 offen sc1
s_add_u32 s20, s20, 1024
buffer_store_dwordx4 v[84:87], v1, s[8:11], s20 offen sc1
s_add_u32 s20, s20, 1024
buffer_store_dwordx4 v[88:91], v1, s[8:11], s20 offen sc1
s_add_u32 s20, s20, 1024
buffer_store_dwordx4 v[92:95], v1, s[8:11], s20 offen sc1
s_add_u32 s20, s20, 1024
s_branch q_end
q_wd:
s_sub_u32 s14, s63, 112
s_and_b32 s15, s14, 7
s_mul_i32 s15, s15, 7
s_lshr_b32 s14, s14, 3
s_add_u32 s14, s14, s15
s_mul_hi_u32 s16, s14, 306783379
s_mul_i32 s17, s16, 14
s_sub_u32 s15, s14, s17
s_mul_i32 s17, s16, 28
s_mul_i32 s18, s3, 7
s_add_u32 s17, s17, s18
s_mul_i32 s20, s15, 112
s_add_u32 s20, s20, s17
s_lshl_b32 s20, s20, 10
s_add_u32 s20, s20, 11534336
v_lshl_add_u32 v22, v3, 3, v4
v_lshlrev_b32 v22, 6, v22
v_lshl_add_u32 v23, v21, 2, v5
v_lshl_add_u32 v22, v23, 3, v22
v_add_u32 v22, s24, v22
ds_write_b128 v20, v[208:211] offset:0
ds_write_b128 v20, v[212:215] offset:1024
ds_write_b128 v20, v[216:219] offset:2048
ds_write_b128 v20, v[220:223] offset:3072
ds_write_b128 v20, v[224:227] offset:4096
ds_write_b128 v20, v[228:231] offset:5120
ds_write_b128 v20, v[232:235] offset:6144
s_waitcnt lgkmcnt(0)
ds_read_b64_tr_b16 v[64:65], v22 offset:0
ds_read_b64_tr_b16 v[66:67], v22 offset:256
ds_read_b64_tr_b16 v[68:69], v22 offset:1024
ds_read_b64_tr_b16 v[70:71], v22 offset:1280
ds_read_b64_tr_b16 v[72:73], v22 offset:2048
ds_read_b64_tr_b16 v[74:75], v22 offset:2304
ds_read_b64_tr_b16 v[76:77], v22 offset:3072
ds_read_b64_tr_b16 v[78:79], v22 offset:3328
ds_read_b64_tr_b16 v[80:81], v22 offset:4096
ds_read_b64_tr_b16 v[82:83], v22 offset:4352
ds_read_b64_tr_b16 v[84:85], v22 offset:5120
ds_read_b64_tr_b16 v[86:87], v22 offset:5376
ds_read_b64_tr_b16 v[88:89], v22 offset:6144
ds_read_b64_tr_b16 v[90:91], v22 offset:6400
s_waitcnt lgkmcnt(0)
buffer_store_dwordx4 v[64:67], v1, s[8:11], s20 offen sc1
s_add_u32 s20, s20, 1024
buffer_store_dwordx4 v[68:71], v1, s[8:11], s20 offen sc1
s_add_u32 s20, s20, 1024
buffer_store_dwordx4 v[72:75], v1, s[8:11], s20 offen sc1
s_add_u32 s20, s20, 1024
buffer_store_dwordx4 v[76:79], v1, s[8:11], s20 offen sc1
s_add_u32 s20, s20, 1024
buffer_store_dwordx4 v[80:83], v1, s[8:11], s20 offen sc1
s_add_u32 s20, s20, 1024
buffer_store_dwordx4 v[84:87], v1, s[8:11], s20 offen sc1
s_add_u32 s20, s20, 1024
buffer_store_dwordx4 v[88:91], v1, s[8:11], s20 offen sc1
s_add_u32 s20, s20, 1024
s_branch q_end
q_gu:
s_and_b32 s14, s2, 7
s_mul_i32 s14, s14, 14
s_lshr_b32 s15, s2, 3
s_add_u32 s14, s14, s15
s_mul_hi_u32 s15, s14, 613566757
s_mul_i32 s17, s15, 7
s_sub_u32 s16, s14, s17
s_lshl_b32 s21, s14, 7
s_add_u32 s21, s21, 29425664
s_mov_b64 s[30:31], -1
s_mul_i32 s20, s15, 200704
s_add_u32 s20, s20, 7340032
s_mul_i32 s17, s3, 21
s_add_u32 s17, s17, s16
s_movk_i32 s23, 3072
s_mul_i32 s18, s16, 28
s_mul_i32 s19, s3, 7
s_add_u32 s18, s18, s19
s_cmp_lt_u32 s16, 3
s_cselect_b32 s17, s17, s18
s_cselect_b32 s23, s23, 1024
s_lshl_b32 s17, s17, 10
s_add_u32 s20, s20, s17
v_lshl_add_u32 v22, v3, 3, v4
v_lshlrev_b32 v22, 5, v22
v_lshl_add_u32 v22, v5, 3, v22
v_mul_u32_u24 v23, 4224, v21
v_add3_u32 v22, v22, v23, s24
ds_write_b128 v20, v[208:211] offset:0
ds_write_b128 v20, v[212:215] offset:4224
ds_write_b128 v20, v[216:219] offset:1024
ds_write_b128 v20, v[220:223] offset:5248
ds_write_b128 v20, v[224:227] offset:2048
ds_write_b128 v20, v[228:231] offset:6272
ds_write_b128 v20, v[232:235] offset:3072
ds_write_b128 v20, v[236:239] offset:7296
s_waitcnt lgkmcnt(0)
ds_read_b64_tr_b16 v[64:65], v22 offset:0
ds_read_b64_tr_b16 v[66:67], v22 offset:128
ds_read_b64_tr_b16 v[68:69], v22 offset:512
ds_read_b64_tr_b16 v[70:71], v22 offset:640
ds_read_b64_tr_b16 v[72:73], v22 offset:1024
ds_read_b64_tr_b16 v[74:75], v22 offset:1152
ds_read_b64_tr_b16 v[76:77], v22 offset:1536
ds_read_b64_tr_b16 v[78:79], v22 offset:1664
ds_read_b64_tr_b16 v[80:81], v22 offset:2048
ds_read_b64_tr_b16 v[82:83], v22 offset:2176
ds_read_b64_tr_b16 v[84:85], v22 offset:2560
ds_read_b64_tr_b16 v[86:87], v22 offset:2688
ds_read_b64_tr_b16 v[88:89], v22 offset:3072
ds_read_b64_tr_b16 v[90:91], v22 offset:3200
s_waitcnt lgkmcnt(0)
buffer_store_dwordx4 v[64:67], v1, s[8:11], s20 offen sc1
s_add_u32 s20, s20, s23
buffer_store_dwordx4 v[68:71], v1, s[8:11], s20 offen sc1
s_add_u32 s20, s20, s23
buffer_store_dwordx4 v[72:75], v1, s[8:11], s20 offen sc1
s_add_u32 s20, s20, s23
buffer_store_dwordx4 v[76:79], v1, s[8:11], s20 offen sc1
s_add_u32 s20, s20, s23
buffer_store_dwordx4 v[80:83], v1, s[8:11], s20 offen sc1
s_add_u32 s20, s20, s23
buffer_store_dwordx4 v[84:87], v1, s[8:11], s20 offen sc1
s_add_u32 s20, s20, s23
buffer_store_dwordx4 v[88:91], v1, s[8:11], s20 offen sc1
s_add_u32 s20, s20, s23
v_mov_b32 v16, 0
v_mov_b32 v17, 0
v_dot2_f32_bf16 v16, v64, s34, v16
v_dot2_f32_bf16 v17, v65, s34, v17
v_dot2_f32_bf16 v16, v66, s34, v16
v_dot2_f32_bf16 v17, v67, s34, v17
v_dot2_f32_bf16 v16, v68, s34, v16
v_dot2_f32_bf16 v17, v69, s34, v17
v_dot2_f32_bf16 v16, v70, s34, v16
v_dot2_f32_bf16 v17, v71, s34, v17
v_dot2_f32_bf16 v16, v72, s34, v16
v_dot2_f32_bf16 v17, v73, s34, v17
v_dot2_f32_bf16 v16, v74, s34, v16
v_dot2_f32_bf16 v17, v75, s34, v17
v_dot2_f32_bf16 v16, v76, s34, v16
v_dot2_f32_bf16 v17, v77, s34, v17
v_dot2_f32_bf16 v16, v78, s34, v16
v_dot2_f32_bf16 v17, v79, s34, v17
v_dot2_f32_bf16 v16, v80, s34, v16
v_dot2_f32_bf16 v17, v81, s34, v17
v_dot2_f32_bf16 v16, v82, s34, v16
v_dot2_f32_bf16 v17, v83, s34, v17
v_dot2_f32_bf16 v16, v84, s34, v16
v_dot2_f32_bf16 v17, v85, s34, v17
v_dot2_f32_bf16 v16, v86, s34, v16
v_dot2_f32_bf16 v17, v87, s34, v17
v_dot2_f32_bf16 v16, v88, s34, v16
v_dot2_f32_bf16 v17, v89, s34, v17
v_dot2_f32_bf16 v16, v90, s34, v16
v_dot2_f32_bf16 v17, v91, s34, v17
s_lshl_b32 s22, s3, 8
s_add_u32 s22, s22, 149504
v_lshl_add_u32 v18, v0, 2, s22
s_nop 2
v_add_f32 v16, v16, v17
ds_write_b32 v18, v16
s_waitcnt lgkmcnt(0)
s_barrier
v_lshlrev_b32 v17, 2, v2
v_add_u32 v17, 149504, v17
ds_read_b32 v24, v17 offset:0
ds_read_b32 v25, v17 offset:128
ds_read_b32 v26, v17 offset:256
ds_read_b32 v27, v17 offset:384
ds_read_b32 v28, v17 offset:512
ds_read_b32 v29, v17 offset:640
ds_read_b32 v30, v17 offset:768
ds_read_b32 v31, v17 offset:896
v_and_b32 v18, 3, v2
v_lshrrev_b32 v19, 3, v2
v_lshl_add_u32 v18, v19, 2, v18
v_bfe_u32 v19, v2, 2, 1
v_lshl_add_u32 v18, v19, 4, v18
v_cndmask_b32 v18, v2, v18, s[30:31]
v_lshlrev_b32 v18, 2, v18
s_waitcnt lgkmcnt(0)
v_add_f32 v24, v24, v25
v_add_f32 v24, v24, v26
v_add_f32 v24, v24, v27
v_add_f32 v24, v24, v28
v_add_f32 v24, v24, v29
v_add_f32 v24, v24, v30
v_add_f32 v24, v24, v31
buffer_store_dword v24, v18, s[8:11], s21 offen sc1
q_end:
v_add_u32 v2, 65536, v1
v_add_u32 v3, 65536, v2
s_lshl_b32 s14, s42, 6
s_lshl_b32 s15, s43, 2
s_add_u32 s15, s15, s14
s_lshl_b32 s15, s15, 11
s_add_u32 s15, s15, 13631488
s_add_u32 s16, s15, 4096
s_lshl_b32 s17, s3, 4
s_add_u32 s17, s17, s14
s_lshl_b32 s17, s17, 12
s_add_u32 s17, s17, 15728640
s_mov_b32 s19, 0
s_lshl_b32 s13, s42, 7
s_add_u32 s13, s13, 30015488
s_cmp_lg_u32 s3, 0
s_cbranch_scc1 main_kernel_wt3x
s_mov_b32 s60, 0
v_mov_b32 v5, 0
main_kernel_wt3:
buffer_load_dword v4, v5, s[8:11], s13 offen sc1
s_add_u32 s60, s60, 1
s_waitcnt vmcnt(0)
v_readfirstlane_b32 s61, v4
s_cmp_ge_u32 s61, 16
s_cbranch_scc1 main_kernel_wt3x
s_cmp_gt_u32 s60, 40000
s_cbranch_scc1 main_kernel_end
s_sleep 1
s_branch main_kernel_wt3
main_kernel_wt3x:
s_waitcnt vmcnt(0)
s_barrier
s_cmp_lg_u32 s3, 0
s_cbranch_scc1 q_sx
s_cmp_ge_u32 s63, 182
s_cbranch_scc1 q_sx
s_and_b32 s12, s63, 3
s_lshl_b32 s12, s12, 7
s_add_u32 s12, s12, 30035968
v_mov_b32 v4, 1
v_mov_b32 v5, 0
s_mov_b64 exec, 1
buffer_atomic_add v4, v5, s[8:11], s12 offen sc1
s_mov_b64 exec, -1
q_sx:
v_and_b32 v248, 3, v0
v_cmp_gt_u32 vcc, 2, v248
v_cndmask_b32 v249, 45, 46, vcc
v_lshlrev_b32 v248, 7, v248
s_add_u32 s18, s17, 0
buffer_load_dwordx4 v[152:155], v1, s[8:11], s18 offen offset:0 sc1
buffer_load_dwordx4 v[16:19], v1, s[8:11], s15 offen offset:0 sc1
buffer_load_dwordx4 v[156:159], v1, s[8:11], s18 offen offset:1024 sc1
buffer_load_dwordx4 v[20:23], v1, s[8:11], s15 offen offset:1024 sc1
buffer_load_dwordx4 v[24:27], v1, s[8:11], s15 offen offset:2048 sc1
buffer_load_dwordx4 v[28:31], v1, s[8:11], s15 offen offset:3072 sc1
buffer_load_dwordx4 v[160:163], v1, s[8:11], s18 offen offset:2048 sc1
buffer_load_dwordx4 v[164:167], v1, s[8:11], s18 offen offset:3072 sc1
buffer_load_dwordx4 v[32:35], v1, s[8:11], s16 offen offset:0 sc1
buffer_load_dwordx4 v[36:39], v1, s[8:11], s16 offen offset:1024 sc1
buffer_load_dwordx4 v[40:43], v1, s[8:11], s16 offen offset:2048 sc1
buffer_load_dwordx4 v[44:47], v1, s[8:11], s16 offen offset:3072 sc1
main_kernel_b0_go:
s_add_u32 s18, s17, 4096
buffer_load_dwordx4 v[168:171], v1, s[8:11], s18 offen offset:0 sc1
buffer_load_dwordx4 v[172:175], v1, s[8:11], s18 offen offset:1024 sc1
buffer_load_dwordx4 v[176:179], v1, s[8:11], s18 offen offset:2048 sc1
buffer_load_dwordx4 v[180:183], v1, s[8:11], s18 offen offset:3072 sc1
s_waitcnt vmcnt(13)
s_waitcnt vmcnt(12)
v_mfma_f32_32x32x16_bf16 v[112:127], v[152:155], v[16:19], 0
v_mfma_f32_32x32x16_bf16 v[112:127], v[156:159], v[20:23], v[112:127]
s_nop 10
s_waitcnt vmcnt(10)
v_mfma_f32_32x32x16_bf16 v[128:143], v[152:155], v[24:27], 0
v_exp_f32 v112, v112
v_exp_f32 v113, v113
v_exp_f32 v114, v114
v_exp_f32 v115, v115
v_cvt_pk_bf16_f32 v144, v112, v113
v_cvt_pk_bf16_f32 v145, v114, v115
v_exp_f32 v116, v116
v_exp_f32 v117, v117
v_exp_f32 v118, v118
v_exp_f32 v119, v119
v_cvt_pk_bf16_f32 v146, v116, v117
v_cvt_pk_bf16_f32 v147, v118, v119
v_mfma_f32_32x32x16_bf16 v[128:143], v[156:159], v[28:31], v[128:143]
s_add_u32 s18, s17, 8192
buffer_load_dwordx4 v[184:187], v1, s[8:11], s18 offen offset:0 sc1
v_exp_f32 v120, v120
v_exp_f32 v121, v121
v_exp_f32 v122, v122
v_exp_f32 v123, v123
v_cvt_pk_bf16_f32 v148, v120, v121
v_cvt_pk_bf16_f32 v149, v122, v123
s_waitcnt vmcnt(9)
v_mfma_f32_32x32x16_bf16 v[48:63], v[160:163], v[144:147], 0
buffer_load_dwordx4 v[188:191], v1, s[8:11], s18 offen offset:1024 sc1
v_exp_f32 v124, v124
v_exp_f32 v125, v125
v_exp_f32 v126, v126
v_exp_f32 v127, v127
v_cvt_pk_bf16_f32 v150, v124, v125
v_cvt_pk_bf16_f32 v151, v126, v127
s_waitcnt vmcnt(8)
v_mfma_f32_32x32x16_bf16 v[112:127], v[152:155], v[32:35], 0
v_exp_f32 v128, v128
v_exp_f32 v129, v129
v_exp_f32 v130, v130
v_exp_f32 v131, v131
v_cvt_pk_bf16_f32 v144, v128, v129
v_cvt_pk_bf16_f32 v145, v130, v131
v_mfma_f32_32x32x16_bf16 v[48:63], v[164:167], v[148:151], v[48:63]
v_exp_f32 v132, v132
v_exp_f32 v133, v133
v_exp_f32 v134, v134
v_exp_f32 v135, v135
v_cvt_pk_bf16_f32 v146, v132, v133
v_cvt_pk_bf16_f32 v147, v134, v135
v_mfma_f32_32x32x16_bf16 v[112:127], v[156:159], v[36:39], v[112:127]
buffer_load_dwordx4 v[192:195], v1, s[8:11], s18 offen offset:2048 sc1
v_exp_f32 v136, v136
v_exp_f32 v137, v137
v_exp_f32 v138, v138
v_exp_f32 v139, v139
v_cvt_pk_bf16_f32 v148, v136, v137
v_cvt_pk_bf16_f32 v149, v138, v139
v_mfma_f32_32x32x16_bf16 v[64:79], v[160:163], v[144:147], 0
buffer_load_dwordx4 v[196:199], v1, s[8:11], s18 offen offset:3072 sc1
v_exp_f32 v140, v140
v_exp_f32 v141, v141
v_exp_f32 v142, v142
v_exp_f32 v143, v143
v_cvt_pk_bf16_f32 v150, v140, v141
v_cvt_pk_bf16_f32 v151, v142, v143
s_waitcnt vmcnt(8)
v_mfma_f32_32x32x16_bf16 v[128:143], v[152:155], v[40:43], 0
v_exp_f32 v112, v112
v_exp_f32 v113, v113
v_exp_f32 v114, v114
v_exp_f32 v115, v115
v_cvt_pk_bf16_f32 v144, v112, v113
v_cvt_pk_bf16_f32 v145, v114, v115
v_mfma_f32_32x32x16_bf16 v[64:79], v[164:167], v[148:151], v[64:79]
v_exp_f32 v116, v116
v_exp_f32 v117, v117
v_exp_f32 v118, v118
v_exp_f32 v119, v119
v_cvt_pk_bf16_f32 v146, v116, v117
v_cvt_pk_bf16_f32 v147, v118, v119
v_mfma_f32_32x32x16_bf16 v[128:143], v[156:159], v[44:47], v[128:143]
s_add_u32 s18, s17, 12288
buffer_load_dwordx4 v[200:203], v1, s[8:11], s18 offen offset:0 sc1
v_exp_f32 v120, v120
v_exp_f32 v121, v121
v_exp_f32 v122, v122
v_exp_f32 v123, v123
v_cvt_pk_bf16_f32 v148, v120, v121
v_cvt_pk_bf16_f32 v149, v122, v123
v_mfma_f32_32x32x16_bf16 v[80:95], v[160:163], v[144:147], 0
buffer_load_dwordx4 v[204:207], v1, s[8:11], s18 offen offset:1024 sc1
v_exp_f32 v124, v124
v_exp_f32 v125, v125
v_exp_f32 v126, v126
v_exp_f32 v127, v127
v_cvt_pk_bf16_f32 v150, v124, v125
v_cvt_pk_bf16_f32 v151, v126, v127
s_waitcnt vmcnt(8)
v_mfma_f32_32x32x16_bf16 v[112:127], v[168:171], v[16:19], 0
v_exp_f32 v128, v128
v_exp_f32 v129, v129
v_exp_f32 v130, v130
v_exp_f32 v131, v131
v_cvt_pk_bf16_f32 v144, v128, v129
v_cvt_pk_bf16_f32 v145, v130, v131
v_mfma_f32_32x32x16_bf16 v[80:95], v[164:167], v[148:151], v[80:95]
v_exp_f32 v132, v132
v_exp_f32 v133, v133
v_exp_f32 v134, v134
v_exp_f32 v135, v135
v_cvt_pk_bf16_f32 v146, v132, v133
v_cvt_pk_bf16_f32 v147, v134, v135
v_mfma_f32_32x32x16_bf16 v[112:127], v[172:175], v[20:23], v[112:127]
buffer_load_dwordx4 v[208:211], v1, s[8:11], s18 offen offset:2048 sc1
v_exp_f32 v136, v136
v_exp_f32 v137, v137
v_exp_f32 v138, v138
v_exp_f32 v139, v139
v_cvt_pk_bf16_f32 v148, v136, v137
v_cvt_pk_bf16_f32 v149, v138, v139
v_mfma_f32_32x32x16_bf16 v[96:111], v[160:163], v[144:147], 0
buffer_load_dwordx4 v[212:215], v1, s[8:11], s18 offen offset:3072 sc1
v_exp_f32 v140, v140
v_exp_f32 v141, v141
v_exp_f32 v142, v142
v_exp_f32 v143, v143
v_cvt_pk_bf16_f32 v150, v140, v141
v_cvt_pk_bf16_f32 v151, v142, v143
v_mfma_f32_32x32x16_bf16 v[128:143], v[168:171], v[24:27], 0
v_exp_f32 v112, v112
v_exp_f32 v113, v113
v_exp_f32 v114, v114
v_exp_f32 v115, v115
v_cvt_pk_bf16_f32 v144, v112, v113
v_cvt_pk_bf16_f32 v145, v114, v115
v_mfma_f32_32x32x16_bf16 v[96:111], v[164:167], v[148:151], v[96:111]
v_exp_f32 v116, v116
v_exp_f32 v117, v117
v_exp_f32 v118, v118
v_exp_f32 v119, v119
v_cvt_pk_bf16_f32 v146, v116, v117
v_cvt_pk_bf16_f32 v147, v118, v119
v_mfma_f32_32x32x16_bf16 v[128:143], v[172:175], v[28:31], v[128:143]
s_add_u32 s18, s17, 16384
buffer_load_dwordx4 v[216:219], v1, s[8:11], s18 offen offset:0 sc1
v_exp_f32 v120, v120
v_exp_f32 v121, v121
v_exp_f32 v122, v122
v_exp_f32 v123, v123
v_cvt_pk_bf16_f32 v148, v120, v121
v_cvt_pk_bf16_f32 v149, v122, v123
s_waitcnt vmcnt(9)
v_mfma_f32_32x32x16_bf16 v[48:63], v[176:179], v[144:147], v[48:63]
buffer_load_dwordx4 v[220:223], v1, s[8:11], s18 offen offset:1024 sc1
v_exp_f32 v124, v124
v_exp_f32 v125, v125
v_exp_f32 v126, v126
v_exp_f32 v127, v127
v_cvt_pk_bf16_f32 v150, v124, v125
v_cvt_pk_bf16_f32 v151, v126, v127
v_mfma_f32_32x32x16_bf16 v[112:127], v[168:171], v[32:35], 0
v_exp_f32 v128, v128
v_exp_f32 v129, v129
v_exp_f32 v130, v130
v_exp_f32 v131, v131
v_cvt_pk_bf16_f32 v144, v128, v129
v_cvt_pk_bf16_f32 v145, v130, v131
v_mfma_f32_32x32x16_bf16 v[48:63], v[180:183], v[148:151], v[48:63]
v_exp_f32 v132, v132
v_exp_f32 v133, v133
v_exp_f32 v134, v134
v_exp_f32 v135, v135
v_cvt_pk_bf16_f32 v146, v132, v133
v_cvt_pk_bf16_f32 v147, v134, v135
v_mfma_f32_32x32x16_bf16 v[112:127], v[172:175], v[36:39], v[112:127]
buffer_load_dwordx4 v[224:227], v1, s[8:11], s18 offen offset:2048 sc1
v_exp_f32 v136, v136
v_exp_f32 v137, v137
v_exp_f32 v138, v138
v_exp_f32 v139, v139
v_cvt_pk_bf16_f32 v148, v136, v137
v_cvt_pk_bf16_f32 v149, v138, v139
v_mfma_f32_32x32x16_bf16 v[64:79], v[176:179], v[144:147], v[64:79]
buffer_load_dwordx4 v[228:231], v1, s[8:11], s18 offen offset:3072 sc1
v_exp_f32 v140, v140
v_exp_f32 v141, v141
v_exp_f32 v142, v142
v_exp_f32 v143, v143
v_cvt_pk_bf16_f32 v150, v140, v141
v_cvt_pk_bf16_f32 v151, v142, v143
v_mfma_f32_32x32x16_bf16 v[128:143], v[168:171], v[40:43], 0
v_exp_f32 v112, v112
v_exp_f32 v113, v113
v_exp_f32 v114, v114
v_exp_f32 v115, v115
v_cvt_pk_bf16_f32 v144, v112, v113
v_cvt_pk_bf16_f32 v145, v114, v115
v_mfma_f32_32x32x16_bf16 v[64:79], v[180:183], v[148:151], v[64:79]
v_exp_f32 v116, v116
v_exp_f32 v117, v117
v_exp_f32 v118, v118
v_exp_f32 v119, v119
v_cvt_pk_bf16_f32 v146, v116, v117
v_cvt_pk_bf16_f32 v147, v118, v119
v_mfma_f32_32x32x16_bf16 v[128:143], v[172:175], v[44:47], v[128:143]
s_add_u32 s18, s17, 20480
buffer_load_dwordx4 v[232:235], v1, s[8:11], s18 offen offset:0 sc1
v_exp_f32 v120, v120
v_exp_f32 v121, v121
v_exp_f32 v122, v122
v_exp_f32 v123, v123
v_cvt_pk_bf16_f32 v148, v120, v121
v_cvt_pk_bf16_f32 v149, v122, v123
v_mfma_f32_32x32x16_bf16 v[80:95], v[176:179], v[144:147], v[80:95]
buffer_load_dwordx4 v[236:239], v1, s[8:11], s18 offen offset:1024 sc1
v_exp_f32 v124, v124
v_exp_f32 v125, v125
v_exp_f32 v126, v126
v_exp_f32 v127, v127
v_cvt_pk_bf16_f32 v150, v124, v125
v_cvt_pk_bf16_f32 v151, v126, v127
s_waitcnt vmcnt(12)
v_mfma_f32_32x32x16_bf16 v[112:127], v[184:187], v[16:19], 0
v_exp_f32 v128, v128
v_exp_f32 v129, v129
v_exp_f32 v130, v130
v_exp_f32 v131, v131
v_cvt_pk_bf16_f32 v144, v128, v129
v_cvt_pk_bf16_f32 v145, v130, v131
v_mfma_f32_32x32x16_bf16 v[80:95], v[180:183], v[148:151], v[80:95]
v_exp_f32 v132, v132
v_exp_f32 v133, v133
v_exp_f32 v134, v134
v_exp_f32 v135, v135
v_cvt_pk_bf16_f32 v146, v132, v133
v_cvt_pk_bf16_f32 v147, v134, v135
v_mfma_f32_32x32x16_bf16 v[112:127], v[188:191], v[20:23], v[112:127]
buffer_load_dwordx4 v[240:243], v1, s[8:11], s18 offen offset:2048 sc1
v_exp_f32 v136, v136
v_exp_f32 v137, v137
v_exp_f32 v138, v138
v_exp_f32 v139, v139
v_cvt_pk_bf16_f32 v148, v136, v137
v_cvt_pk_bf16_f32 v149, v138, v139
v_mfma_f32_32x32x16_bf16 v[96:111], v[176:179], v[144:147], v[96:111]
buffer_load_dwordx4 v[244:247], v1, s[8:11], s18 offen offset:3072 sc1
v_exp_f32 v140, v140
v_exp_f32 v141, v141
v_exp_f32 v142, v142
v_exp_f32 v143, v143
v_cvt_pk_bf16_f32 v150, v140, v141
v_cvt_pk_bf16_f32 v151, v142, v143
v_mfma_f32_32x32x16_bf16 v[128:143], v[184:187], v[24:27], 0
v_exp_f32 v112, v112
v_exp_f32 v113, v113
v_exp_f32 v114, v114
v_exp_f32 v115, v115
v_cvt_pk_bf16_f32 v144, v112, v113
v_cvt_pk_bf16_f32 v145, v114, v115
v_mfma_f32_32x32x16_bf16 v[96:111], v[180:183], v[148:151], v[96:111]
v_exp_f32 v116, v116
v_exp_f32 v117, v117
v_exp_f32 v118, v118
v_exp_f32 v119, v119
v_cvt_pk_bf16_f32 v146, v116, v117
v_cvt_pk_bf16_f32 v147, v118, v119
v_mfma_f32_32x32x16_bf16 v[128:143], v[188:191], v[28:31], v[128:143]
s_add_u32 s18, s17, 24576
buffer_load_dwordx4 v[152:155], v1, s[8:11], s18 offen offset:0 sc1
v_exp_f32 v120, v120
v_exp_f32 v121, v121
v_exp_f32 v122, v122
v_exp_f32 v123, v123
v_cvt_pk_bf16_f32 v148, v120, v121
v_cvt_pk_bf16_f32 v149, v122, v123
s_waitcnt vmcnt(13)
v_mfma_f32_32x32x16_bf16 v[48:63], v[192:195], v[144:147], v[48:63]
buffer_load_dwordx4 v[156:159], v1, s[8:11], s18 offen offset:1024 sc1
v_exp_f32 v124, v124
v_exp_f32 v125, v125
v_exp_f32 v126, v126
v_exp_f32 v127, v127
v_cvt_pk_bf16_f32 v150, v124, v125
v_cvt_pk_bf16_f32 v151, v126, v127
v_mfma_f32_32x32x16_bf16 v[112:127], v[184:187], v[32:35], 0
v_exp_f32 v128, v128
v_exp_f32 v129, v129
v_exp_f32 v130, v130
v_exp_f32 v131, v131
v_cvt_pk_bf16_f32 v144, v128, v129
v_cvt_pk_bf16_f32 v145, v130, v131
v_mfma_f32_32x32x16_bf16 v[48:63], v[196:199], v[148:151], v[48:63]
v_exp_f32 v132, v132
v_exp_f32 v133, v133
v_exp_f32 v134, v134
v_exp_f32 v135, v135
v_cvt_pk_bf16_f32 v146, v132, v133
v_cvt_pk_bf16_f32 v147, v134, v135
v_mfma_f32_32x32x16_bf16 v[112:127], v[188:191], v[36:39], v[112:127]
buffer_load_dwordx4 v[160:163], v1, s[8:11], s18 offen offset:2048 sc1
v_exp_f32 v136, v136
v_exp_f32 v137, v137
v_exp_f32 v138, v138
v_exp_f32 v139, v139
v_cvt_pk_bf16_f32 v148, v136, v137
v_cvt_pk_bf16_f32 v149, v138, v139
v_mfma_f32_32x32x16_bf16 v[64:79], v[192:195], v[144:147], v[64:79]
buffer_load_dwordx4 v[164:167], v1, s[8:11], s18 offen offset:3072 sc1
v_exp_f32 v140, v140
v_exp_f32 v141, v141
v_exp_f32 v142, v142
v_exp_f32 v143, v143
v_cvt_pk_bf16_f32 v150, v140, v141
v_cvt_pk_bf16_f32 v151, v142, v143
v_mfma_f32_32x32x16_bf16 v[128:143], v[184:187], v[40:43], 0
v_exp_f32 v112, v112
v_exp_f32 v113, v113
v_exp_f32 v114, v114
v_exp_f32 v115, v115
v_cvt_pk_bf16_f32 v144, v112, v113
v_cvt_pk_bf16_f32 v145, v114, v115
v_mfma_f32_32x32x16_bf16 v[64:79], v[196:199], v[148:151], v[64:79]
v_exp_f32 v116, v116
v_exp_f32 v117, v117
v_exp_f32 v118, v118
v_exp_f32 v119, v119
v_cvt_pk_bf16_f32 v146, v116, v117
v_cvt_pk_bf16_f32 v147, v118, v119
v_mfma_f32_32x32x16_bf16 v[128:143], v[188:191], v[44:47], v[128:143]
s_add_u32 s18, s17, 28672
buffer_load_dwordx4 v[168:171], v1, s[8:11], s18 offen offset:0 sc1
v_exp_f32 v120, v120
v_exp_f32 v121, v121
v_exp_f32 v122, v122
v_exp_f32 v123, v123
v_cvt_pk_bf16_f32 v148, v120, v121
v_cvt_pk_bf16_f32 v149, v122, v123
v_mfma_f32_32x32x16_bf16 v[80:95], v[192:195], v[144:147], v[80:95]
buffer_load_dwordx4 v[172:175], v1, s[8:11], s18 offen offset:1024 sc1
v_exp_f32 v124, v124
v_exp_f32 v125, v125
v_exp_f32 v126, v126
v_exp_f32 v127, v127
v_cvt_pk_bf16_f32 v150, v124, v125
v_cvt_pk_bf16_f32 v151, v126, v127
s_waitcnt vmcnt(16)
v_mfma_f32_32x32x16_bf16 v[112:127], v[200:203], v[16:19], 0
v_exp_f32 v128, v128
v_exp_f32 v129, v129
v_exp_f32 v130, v130
v_exp_f32 v131, v131
v_cvt_pk_bf16_f32 v144, v128, v129
v_cvt_pk_bf16_f32 v145, v130, v131
v_mfma_f32_32x32x16_bf16 v[80:95], v[196:199], v[148:151], v[80:95]
v_exp_f32 v132, v132
v_exp_f32 v133, v133
v_exp_f32 v134, v134
v_exp_f32 v135, v135
v_cvt_pk_bf16_f32 v146, v132, v133
v_cvt_pk_bf16_f32 v147, v134, v135
v_mfma_f32_32x32x16_bf16 v[112:127], v[204:207], v[20:23], v[112:127]
buffer_load_dwordx4 v[176:179], v1, s[8:11], s18 offen offset:2048 sc1
v_exp_f32 v136, v136
v_exp_f32 v137, v137
v_exp_f32 v138, v138
v_exp_f32 v139, v139
v_cvt_pk_bf16_f32 v148, v136, v137
v_cvt_pk_bf16_f32 v149, v138, v139
v_mfma_f32_32x32x16_bf16 v[96:111], v[192:195], v[144:147], v[96:111]
buffer_load_dwordx4 v[180:183], v1, s[8:11], s18 offen offset:3072 sc1
v_exp_f32 v140, v140
v_exp_f32 v141, v141
v_exp_f32 v142, v142
v_exp_f32 v143, v143
v_cvt_pk_bf16_f32 v150, v140, v141
v_cvt_pk_bf16_f32 v151, v142, v143
v_mfma_f32_32x32x16_bf16 v[128:143], v[200:203], v[24:27], 0
v_exp_f32 v112, v112
v_exp_f32 v113, v113
v_exp_f32 v114, v114
v_exp_f32 v115, v115
v_cvt_pk_bf16_f32 v144, v112, v113
v_cvt_pk_bf16_f32 v145, v114, v115
v_mfma_f32_32x32x16_bf16 v[96:111], v[196:199], v[148:151], v[96:111]
v_exp_f32 v116, v116
v_exp_f32 v117, v117
v_exp_f32 v118, v118
v_exp_f32 v119, v119
v_cvt_pk_bf16_f32 v146, v116, v117
v_cvt_pk_bf16_f32 v147, v118, v119
v_mfma_f32_32x32x16_bf16 v[128:143], v[204:207], v[28:31], v[128:143]
v_exp_f32 v120, v120
v_exp_f32 v121, v121
v_exp_f32 v122, v122
v_exp_f32 v123, v123
v_cvt_pk_bf16_f32 v148, v120, v121
v_cvt_pk_bf16_f32 v149, v122, v123
s_waitcnt vmcnt(16)
v_mfma_f32_32x32x16_bf16 v[48:63], v[208:211], v[144:147], v[48:63]
v_exp_f32 v124, v124
v_exp_f32 v125, v125
v_exp_f32 v126, v126
v_exp_f32 v127, v127
v_cvt_pk_bf16_f32 v150, v124, v125
v_cvt_pk_bf16_f32 v151, v126, v127
v_mfma_f32_32x32x16_bf16 v[112:127], v[200:203], v[32:35], 0
v_exp_f32 v128, v128
v_exp_f32 v129, v129
v_exp_f32 v130, v130
v_exp_f32 v131, v131
v_cvt_pk_bf16_f32 v144, v128, v129
v_cvt_pk_bf16_f32 v145, v130, v131
v_mfma_f32_32x32x16_bf16 v[48:63], v[212:215], v[148:151], v[48:63]
v_exp_f32 v132, v132
v_exp_f32 v133, v133
v_exp_f32 v134, v134
v_exp_f32 v135, v135
v_cvt_pk_bf16_f32 v146, v132, v133
v_cvt_pk_bf16_f32 v147, v134, v135
v_mfma_f32_32x32x16_bf16 v[112:127], v[204:207], v[36:39], v[112:127]
s_add_u32 s18, s17, 32768
buffer_load_dwordx4 v[184:187], v1, s[8:11], s18 offen offset:0 sc1
v_exp_f32 v136, v136
v_exp_f32 v137, v137
v_exp_f32 v138, v138
v_exp_f32 v139, v139
v_cvt_pk_bf16_f32 v148, v136, v137
v_cvt_pk_bf16_f32 v149, v138, v139
v_mfma_f32_32x32x16_bf16 v[64:79], v[208:211], v[144:147], v[64:79]
buffer_load_dwordx4 v[188:191], v1, s[8:11], s18 offen offset:1024 sc1
v_exp_f32 v140, v140
v_exp_f32 v141, v141
v_exp_f32 v142, v142
v_exp_f32 v143, v143
v_cvt_pk_bf16_f32 v150, v140, v141
v_cvt_pk_bf16_f32 v151, v142, v143
v_mfma_f32_32x32x16_bf16 v[128:143], v[200:203], v[40:43], 0
v_exp_f32 v112, v112
v_exp_f32 v113, v113
v_exp_f32 v114, v114
v_exp_f32 v115, v115
v_cvt_pk_bf16_f32 v144, v112, v113
v_cvt_pk_bf16_f32 v145, v114, v115
v_mfma_f32_32x32x16_bf16 v[64:79], v[212:215], v[148:151], v[64:79]
v_exp_f32 v116, v116
v_exp_f32 v117, v117
v_exp_f32 v118, v118
v_exp_f32 v119, v119
v_cvt_pk_bf16_f32 v146, v116, v117
v_cvt_pk_bf16_f32 v147, v118, v119
v_mfma_f32_32x32x16_bf16 v[128:143], v[204:207], v[44:47], v[128:143]
buffer_load_dwordx4 v[192:195], v1, s[8:11], s18 offen offset:2048 sc1
v_exp_f32 v120, v120
v_exp_f32 v121, v121
v_exp_f32 v122, v122
v_exp_f32 v123, v123
v_cvt_pk_bf16_f32 v148, v120, v121
v_cvt_pk_bf16_f32 v149, v122, v123
v_mfma_f32_32x32x16_bf16 v[80:95], v[208:211], v[144:147], v[80:95]
buffer_load_dwordx4 v[196:199], v1, s[8:11], s18 offen offset:3072 sc1
v_exp_f32 v124, v124
v_exp_f32 v125, v125
v_exp_f32 v126, v126
v_exp_f32 v127, v127
v_cvt_pk_bf16_f32 v150, v124, v125
v_cvt_pk_bf16_f32 v151, v126, v127
s_waitcnt vmcnt(18)
v_mfma_f32_32x32x16_bf16 v[112:127], v[216:219], v[16:19], 0
v_exp_f32 v128, v128
v_exp_f32 v129, v129
v_exp_f32 v130, v130
v_exp_f32 v131, v131
v_cvt_pk_bf16_f32 v144, v128, v129
v_cvt_pk_bf16_f32 v145, v130, v131
v_mfma_f32_32x32x16_bf16 v[80:95], v[212:215], v[148:151], v[80:95]
v_exp_f32 v132, v132
v_exp_f32 v133, v133
v_exp_f32 v134, v134
v_exp_f32 v135, v135
v_cvt_pk_bf16_f32 v146, v132, v133
v_cvt_pk_bf16_f32 v147, v134, v135
v_mfma_f32_32x32x16_bf16 v[112:127], v[220:223], v[20:23], v[112:127]
v_exp_f32 v136, v136
v_exp_f32 v137, v137
v_exp_f32 v138, v138
v_exp_f32 v139, v139
v_cvt_pk_bf16_f32 v148, v136, v137
v_cvt_pk_bf16_f32 v149, v138, v139
v_mfma_f32_32x32x16_bf16 v[96:111], v[208:211], v[144:147], v[96:111]
v_exp_f32 v140, v140
v_exp_f32 v141, v141
v_exp_f32 v142, v142
v_exp_f32 v143, v143
v_cvt_pk_bf16_f32 v150, v140, v141
v_cvt_pk_bf16_f32 v151, v142, v143
v_mfma_f32_32x32x16_bf16 v[128:143], v[216:219], v[24:27], 0
v_exp_f32 v112, v112
v_exp_f32 v113, v113
v_exp_f32 v114, v114
v_exp_f32 v115, v115
v_cvt_pk_bf16_f32 v144, v112, v113
v_cvt_pk_bf16_f32 v145, v114, v115
v_mfma_f32_32x32x16_bf16 v[96:111], v[212:215], v[148:151], v[96:111]
v_exp_f32 v116, v116
v_exp_f32 v117, v117
v_exp_f32 v118, v118
v_exp_f32 v119, v119
v_cvt_pk_bf16_f32 v146, v116, v117
v_cvt_pk_bf16_f32 v147, v118, v119
v_mfma_f32_32x32x16_bf16 v[128:143], v[220:223], v[28:31], v[128:143]
s_mov_b32 s12, 30035968
buffer_load_dword v250, v248, s[8:11], s12 offen sc1
v_exp_f32 v120, v120
v_exp_f32 v121, v121
v_exp_f32 v122, v122
v_exp_f32 v123, v123
v_cvt_pk_bf16_f32 v148, v120, v121
v_cvt_pk_bf16_f32 v149, v122, v123
s_waitcnt vmcnt(17)
v_mfma_f32_32x32x16_bf16 v[48:63], v[224:227], v[144:147], v[48:63]
v_exp_f32 v124, v124
v_exp_f32 v125, v125
v_exp_f32 v126, v126
v_exp_f32 v127, v127
v_cvt_pk_bf16_f32 v150, v124, v125
v_cvt_pk_bf16_f32 v151, v126, v127
v_mfma_f32_32x32x16_bf16 v[112:127], v[216:219], v[32:35], 0
v_exp_f32 v128, v128
v_exp_f32 v129, v129
v_exp_f32 v130, v130
v_exp_f32 v131, v131
v_cvt_pk_bf16_f32 v144, v128, v129
v_cvt_pk_bf16_f32 v145, v130, v131
v_mfma_f32_32x32x16_bf16 v[48:63], v[228:231], v[148:151], v[48:63]
v_exp_f32 v132, v132
v_exp_f32 v133, v133
v_exp_f32 v134, v134
v_exp_f32 v135, v135
v_cvt_pk_bf16_f32 v146, v132, v133
v_cvt_pk_bf16_f32 v147, v134, v135
v_mfma_f32_32x32x16_bf16 v[112:127], v[220:223], v[36:39], v[112:127]
v_exp_f32 v136, v136
v_exp_f32 v137, v137
v_exp_f32 v138, v138
v_exp_f32 v139, v139
v_cvt_pk_bf16_f32 v148, v136, v137
v_cvt_pk_bf16_f32 v149, v138, v139
v_mfma_f32_32x32x16_bf16 v[64:79], v[224:227], v[144:147], v[64:79]
s_add_u32 s18, s17, 36864
buffer_load_dwordx4 v[200:203], v1, s[8:11], s18 offen offset:0 sc1
v_exp_f32 v140, v140
v_exp_f32 v141, v141
v_exp_f32 v142, v142
v_exp_f32 v143, v143
v_cvt_pk_bf16_f32 v150, v140, v141
v_cvt_pk_bf16_f32 v151, v142, v143
v_mfma_f32_32x32x16_bf16 v[128:143], v[216:219], v[40:43], 0
v_exp_f32 v112, v112
v_exp_f32 v113, v113
v_exp_f32 v114, v114
v_exp_f32 v115, v115
v_cvt_pk_bf16_f32 v144, v112, v113
v_cvt_pk_bf16_f32 v145, v114, v115
v_mfma_f32_32x32x16_bf16 v[64:79], v[228:231], v[148:151], v[64:79]
v_exp_f32 v116, v116
v_exp_f32 v117, v117
v_exp_f32 v118, v118
v_exp_f32 v119, v119
v_cvt_pk_bf16_f32 v146, v116, v117
v_cvt_pk_bf16_f32 v147, v118, v119
v_mfma_f32_32x32x16_bf16 v[128:143], v[220:223], v[44:47], v[128:143]
v_exp_f32 v120, v120
v_exp_f32 v121, v121
v_exp_f32 v122, v122
v_exp_f32 v123, v123
v_cvt_pk_bf16_f32 v148, v120, v121
v_cvt_pk_bf16_f32 v149, v122, v123
v_mfma_f32_32x32x16_bf16 v[80:95], v[224:227], v[144:147], v[80:95]
buffer_load_dwordx4 v[204:207], v1, s[8:11], s18 offen offset:1024 sc1
v_exp_f32 v124, v124
v_exp_f32 v125, v125
v_exp_f32 v126, v126
v_exp_f32 v127, v127
v_cvt_pk_bf16_f32 v150, v124, v125
v_cvt_pk_bf16_f32 v151, v126, v127
s_waitcnt vmcnt(17)
v_mfma_f32_32x32x16_bf16 v[112:127], v[232:235], v[16:19], 0
v_exp_f32 v128, v128
v_exp_f32 v129, v129
v_exp_f32 v130, v130
v_exp_f32 v131, v131
v_cvt_pk_bf16_f32 v144, v128, v129
v_cvt_pk_bf16_f32 v145, v130, v131
v_mfma_f32_32x32x16_bf16 v[80:95], v[228:231], v[148:151], v[80:95]
v_exp_f32 v132, v132
v_exp_f32 v133, v133
v_exp_f32 v134, v134
v_exp_f32 v135, v135
v_cvt_pk_bf16_f32 v146, v132, v133
v_cvt_pk_bf16_f32 v147, v134, v135
v_mfma_f32_32x32x16_bf16 v[112:127], v[236:239], v[20:23], v[112:127]
v_exp_f32 v136, v136
v_exp_f32 v137, v137
v_exp_f32 v138, v138
v_exp_f32 v139, v139
v_cvt_pk_bf16_f32 v148, v136, v137
v_cvt_pk_bf16_f32 v149, v138, v139
v_mfma_f32_32x32x16_bf16 v[96:111], v[224:227], v[144:147], v[96:111]
buffer_load_dwordx4 v[208:211], v1, s[8:11], s18 offen offset:2048 sc1
v_exp_f32 v140, v140
v_exp_f32 v141, v141
v_exp_f32 v142, v142
v_exp_f32 v143, v143
v_cvt_pk_bf16_f32 v150, v140, v141
v_cvt_pk_bf16_f32 v151, v142, v143
v_mfma_f32_32x32x16_bf16 v[128:143], v[232:235], v[24:27], 0
v_exp_f32 v112, v112
v_exp_f32 v113, v113
v_exp_f32 v114, v114
v_exp_f32 v115, v115
v_cvt_pk_bf16_f32 v144, v112, v113
v_cvt_pk_bf16_f32 v145, v114, v115
v_mfma_f32_32x32x16_bf16 v[96:111], v[228:231], v[148:151], v[96:111]
v_exp_f32 v116, v116
v_exp_f32 v117, v117
v_exp_f32 v118, v118
v_exp_f32 v119, v119
v_cvt_pk_bf16_f32 v146, v116, v117
v_cvt_pk_bf16_f32 v147, v118, v119
v_mfma_f32_32x32x16_bf16 v[128:143], v[236:239], v[28:31], v[128:143]
v_exp_f32 v120, v120
v_exp_f32 v121, v121
v_exp_f32 v122, v122
v_exp_f32 v123, v123
v_cvt_pk_bf16_f32 v148, v120, v121
v_cvt_pk_bf16_f32 v149, v122, v123
s_waitcnt vmcnt(16)
v_mfma_f32_32x32x16_bf16 v[48:63], v[240:243], v[144:147], v[48:63]
buffer_load_dwordx4 v[212:215], v1, s[8:11], s18 offen offset:3072 sc1
v_exp_f32 v124, v124
v_exp_f32 v125, v125
v_exp_f32 v126, v126
v_exp_f32 v127, v127
v_cvt_pk_bf16_f32 v150, v124, v125
v_cvt_pk_bf16_f32 v151, v126, v127
v_mfma_f32_32x32x16_bf16 v[112:127], v[232:235], v[32:35], 0
v_exp_f32 v128, v128
v_exp_f32 v129, v129
v_exp_f32 v130, v130
v_exp_f32 v131, v131
v_cvt_pk_bf16_f32 v144, v128, v129
v_cvt_pk_bf16_f32 v145, v130, v131
v_mfma_f32_32x32x16_bf16 v[48:63], v[244:247], v[148:151], v[48:63]
v_exp_f32 v132, v132
v_exp_f32 v133, v133
v_exp_f32 v134, v134
v_exp_f32 v135, v135
v_cvt_pk_bf16_f32 v146, v132, v133
v_cvt_pk_bf16_f32 v147, v134, v135
v_mfma_f32_32x32x16_bf16 v[112:127], v[236:239], v[36:39], v[112:127]
v_exp_f32 v136, v136
v_exp_f32 v137, v137
v_exp_f32 v138, v138
v_exp_f32 v139, v139
v_cvt_pk_bf16_f32 v148, v136, v137
v_cvt_pk_bf16_f32 v149, v138, v139
v_mfma_f32_32x32x16_bf16 v[64:79], v[240:243], v[144:147], v[64:79]
s_add_u32 s18, s17, 40960
buffer_load_dwordx4 v[216:219], v1, s[8:11], s18 offen offset:0 sc1
v_exp_f32 v140, v140
v_exp_f32 v141, v141
v_exp_f32 v142, v142
v_exp_f32 v143, v143
v_cvt_pk_bf16_f32 v150, v140, v141
v_cvt_pk_bf16_f32 v151, v142, v143
v_mfma_f32_32x32x16_bf16 v[128:143], v[232:235], v[40:43], 0
v_exp_f32 v112, v112
v_exp_f32 v113, v113
v_exp_f32 v114, v114
v_exp_f32 v115, v115
v_cvt_pk_bf16_f32 v144, v112, v113
v_cvt_pk_bf16_f32 v145, v114, v115
v_mfma_f32_32x32x16_bf16 v[64:79], v[244:247], v[148:151], v[64:79]
v_exp_f32 v116, v116
v_exp_f32 v117, v117
v_exp_f32 v118, v118
v_exp_f32 v119, v119
v_cvt_pk_bf16_f32 v146, v116, v117
v_cvt_pk_bf16_f32 v147, v118, v119
v_mfma_f32_32x32x16_bf16 v[128:143], v[236:239], v[44:47], v[128:143]
v_exp_f32 v120, v120
v_exp_f32 v121, v121
v_exp_f32 v122, v122
v_exp_f32 v123, v123
v_cvt_pk_bf16_f32 v148, v120, v121
v_cvt_pk_bf16_f32 v149, v122, v123
v_mfma_f32_32x32x16_bf16 v[80:95], v[240:243], v[144:147], v[80:95]
buffer_load_dwordx4 v[220:223], v1, s[8:11], s18 offen offset:1024 sc1
v_exp_f32 v124, v124
v_exp_f32 v125, v125
v_exp_f32 v126, v126
v_exp_f32 v127, v127
v_cvt_pk_bf16_f32 v150, v124, v125
v_cvt_pk_bf16_f32 v151, v126, v127
s_waitcnt vmcnt(17)
v_mfma_f32_32x32x16_bf16 v[112:127], v[152:155], v[16:19], 0
v_exp_f32 v128, v128
v_exp_f32 v129, v129
v_exp_f32 v130, v130
v_exp_f32 v131, v131
v_cvt_pk_bf16_f32 v144, v128, v129
v_cvt_pk_bf16_f32 v145, v130, v131
v_mfma_f32_32x32x16_bf16 v[80:95], v[244:247], v[148:151], v[80:95]
v_exp_f32 v132, v132
v_exp_f32 v133, v133
v_exp_f32 v134, v134
v_exp_f32 v135, v135
v_cvt_pk_bf16_f32 v146, v132, v133
v_cvt_pk_bf16_f32 v147, v134, v135
v_mfma_f32_32x32x16_bf16 v[112:127], v[156:159], v[20:23], v[112:127]
s_waitcnt vmcnt(6)
s_mov_b32 s60, 0
q_w:
v_cmp_ge_u32 vcc, v250, v249
s_nop 4
s_cmp_eq_u64 vcc, -1
s_cbranch_scc1 q_wx
s_add_u32 s60, s60, 1
s_cmp_gt_u32 s60, 40000
s_cbranch_scc1 main_kernel_end
s_sleep 1
buffer_load_dword v250, v248, s[8:11], s12 offen sc1
s_waitcnt vmcnt(0)
s_branch q_w
q_wx:
v_exp_f32 v136, v136
v_exp_f32 v137, v137
v_exp_f32 v138, v138
v_exp_f32 v139, v139
v_cvt_pk_bf16_f32 v148, v136, v137
v_cvt_pk_bf16_f32 v149, v138, v139
v_mfma_f32_32x32x16_bf16 v[96:111], v[240:243], v[144:147], v[96:111]
buffer_load_dwordx4 v[224:227], v1, s[8:11], s18 offen offset:2048 sc1
v_exp_f32 v140, v140
v_exp_f32 v141, v141
v_exp_f32 v142, v142
v_exp_f32 v143, v143
v_cvt_pk_bf16_f32 v150, v140, v141
v_cvt_pk_bf16_f32 v151, v142, v143
v_mfma_f32_32x32x16_bf16 v[128:143], v[152:155], v[24:27], 0
v_exp_f32 v112, v112
v_exp_f32 v113, v113
v_exp_f32 v114, v114
v_exp_f32 v115, v115
v_cvt_pk_bf16_f32 v144, v112, v113
v_cvt_pk_bf16_f32 v145, v114, v115
v_mfma_f32_32x32x16_bf16 v[96:111], v[244:247], v[148:151], v[96:111]
s_add_u32 s24, s50, 0
s_mov_b32 m0, s24
s_add_u32 s25, s52, 0
buffer_load_dwordx4 v1, s[8:11], s25 offen offset:0 lds
v_exp_f32 v116, v116
v_exp_f32 v117, v117
v_exp_f32 v118, v118
v_exp_f32 v119, v119
v_cvt_pk_bf16_f32 v146, v116, v117
v_cvt_pk_bf16_f32 v147, v118, v119
v_mfma_f32_32x32x16_bf16 v[128:143], v[156:159], v[28:31], v[128:143]
buffer_load_dwordx4 v1, s[8:11], s25 offen offset:1024 lds
v_exp_f32 v120, v120
v_exp_f32 v121, v121
v_exp_f32 v122, v122
v_exp_f32 v123, v123
v_cvt_pk_bf16_f32 v148, v120, v121
v_cvt_pk_bf16_f32 v149, v122, v123
v_mfma_f32_32x32x16_bf16 v[48:63], v[160:163], v[144:147], v[48:63]
buffer_load_dwordx4 v[228:231], v1, s[8:11], s18 offen offset:3072 sc1
v_exp_f32 v124, v124
v_exp_f32 v125, v125
v_exp_f32 v126, v126
v_exp_f32 v127, v127
v_cvt_pk_bf16_f32 v150, v124, v125
v_cvt_pk_bf16_f32 v151, v126, v127
v_mfma_f32_32x32x16_bf16 v[112:127], v[152:155], v[32:35], 0
v_exp_f32 v128, v128
v_exp_f32 v129, v129
v_exp_f32 v130, v130
v_exp_f32 v131, v131
v_cvt_pk_bf16_f32 v144, v128, v129
v_cvt_pk_bf16_f32 v145, v130, v131
v_mfma_f32_32x32x16_bf16 v[48:63], v[164:167], v[148:151], v[48:63]
buffer_load_dwordx4 v1, s[8:11], s25 offen offset:2048 lds
v_exp_f32 v132, v132
v_exp_f32 v133, v133
v_exp_f32 v134, v134
v_exp_f32 v135, v135
v_cvt_pk_bf16_f32 v146, v132, v133
v_cvt_pk_bf16_f32 v147, v134, v135
v_mfma_f32_32x32x16_bf16 v[112:127], v[156:159], v[36:39], v[112:127]
s_add_u32 s24, s50, 12288
s_mov_b32 m0, s24
s_add_u32 s25, s52, 12288
buffer_load_dwordx4 v1, s[8:11], s25 offen offset:0 lds
v_exp_f32 v136, v136
v_exp_f32 v137, v137
v_exp_f32 v138, v138
v_exp_f32 v139, v139
v_cvt_pk_bf16_f32 v148, v136, v137
v_cvt_pk_bf16_f32 v149, v138, v139
v_mfma_f32_32x32x16_bf16 v[64:79], v[160:163], v[144:147], v[64:79]
s_add_u32 s18, s17, 45056
buffer_load_dwordx4 v[232:235], v1, s[8:11], s18 offen offset:0 sc1
v_exp_f32 v140, v140
v_exp_f32 v141, v141
v_exp_f32 v142, v142
v_exp_f32 v143, v143
v_cvt_pk_bf16_f32 v150, v140, v141
v_cvt_pk_bf16_f32 v151, v142, v143
v_mfma_f32_32x32x16_bf16 v[128:143], v[152:155], v[40:43], 0
v_exp_f32 v112, v112
v_exp_f32 v113, v113
v_exp_f32 v114, v114
v_exp_f32 v115, v115
v_cvt_pk_bf16_f32 v144, v112, v113
v_cvt_pk_bf16_f32 v145, v114, v115
v_mfma_f32_32x32x16_bf16 v[64:79], v[164:167], v[148:151], v[64:79]
buffer_load_dwordx4 v1, s[8:11], s25 offen offset:1024 lds
v_exp_f32 v116, v116
v_exp_f32 v117, v117
v_exp_f32 v118, v118
v_exp_f32 v119, v119
v_cvt_pk_bf16_f32 v146, v116, v117
v_cvt_pk_bf16_f32 v147, v118, v119
v_mfma_f32_32x32x16_bf16 v[128:143], v[156:159], v[44:47], v[128:143]
buffer_load_dwordx4 v1, s[8:11], s25 offen offset:2048 lds
v_exp_f32 v120, v120
v_exp_f32 v121, v121
v_exp_f32 v122, v122
v_exp_f32 v123, v123
v_cvt_pk_bf16_f32 v148, v120, v121
v_cvt_pk_bf16_f32 v149, v122, v123
v_mfma_f32_32x32x16_bf16 v[80:95], v[160:163], v[144:147], v[80:95]
buffer_load_dwordx4 v[236:239], v1, s[8:11], s18 offen offset:1024 sc1
v_exp_f32 v124, v124
v_exp_f32 v125, v125
v_exp_f32 v126, v126
v_exp_f32 v127, v127
v_cvt_pk_bf16_f32 v150, v124, v125
v_cvt_pk_bf16_f32 v151, v126, v127
v_mfma_f32_32x32x16_bf16 v[112:127], v[168:171], v[16:19], 0
v_exp_f32 v128, v128
v_exp_f32 v129, v129
v_exp_f32 v130, v130
v_exp_f32 v131, v131
v_cvt_pk_bf16_f32 v144, v128, v129
v_cvt_pk_bf16_f32 v145, v130, v131
v_mfma_f32_32x32x16_bf16 v[80:95], v[164:167], v[148:151], v[80:95]
s_add_u32 s24, s50, 24576
s_mov_b32 m0, s24
s_add_u32 s25, s52, 24576
buffer_load_dwordx4 v1, s[8:11], s25 offen offset:0 lds
v_exp_f32 v132, v132
v_exp_f32 v133, v133
v_exp_f32 v134, v134
v_exp_f32 v135, v135
v_cvt_pk_bf16_f32 v146, v132, v133
v_cvt_pk_bf16_f32 v147, v134, v135
v_mfma_f32_32x32x16_bf16 v[112:127], v[172:175], v[20:23], v[112:127]
buffer_load_dwordx4 v1, s[8:11], s25 offen offset:1024 lds
v_exp_f32 v136, v136
v_exp_f32 v137, v137
v_exp_f32 v138, v138
v_exp_f32 v139, v139
v_cvt_pk_bf16_f32 v148, v136, v137
v_cvt_pk_bf16_f32 v149, v138, v139
v_mfma_f32_32x32x16_bf16 v[96:111], v[160:163], v[144:147], v[96:111]
buffer_load_dwordx4 v[240:243], v1, s[8:11], s18 offen offset:2048 sc1
v_exp_f32 v140, v140
v_exp_f32 v141, v141
v_exp_f32 v142, v142
v_exp_f32 v143, v143
v_cvt_pk_bf16_f32 v150, v140, v141
v_cvt_pk_bf16_f32 v151, v142, v143
v_mfma_f32_32x32x16_bf16 v[128:143], v[168:171], v[24:27], 0
v_exp_f32 v112, v112
v_exp_f32 v113, v113
v_exp_f32 v114, v114
v_exp_f32 v115, v115
v_cvt_pk_bf16_f32 v144, v112, v113
v_cvt_pk_bf16_f32 v145, v114, v115
v_mfma_f32_32x32x16_bf16 v[96:111], v[164:167], v[148:151], v[96:111]
buffer_load_dwordx4 v1, s[8:11], s25 offen offset:2048 lds
v_exp_f32 v116, v116
v_exp_f32 v117, v117
v_exp_f32 v118, v118
v_exp_f32 v119, v119
v_cvt_pk_bf16_f32 v146, v116, v117
v_cvt_pk_bf16_f32 v147, v118, v119
v_mfma_f32_32x32x16_bf16 v[128:143], v[172:175], v[28:31], v[128:143]
s_add_u32 s24, s50, 36864
s_mov_b32 m0, s24
s_add_u32 s25, s52, 36864
buffer_load_dwordx4 v1, s[8:11], s25 offen offset:0 lds
v_exp_f32 v120, v120
v_exp_f32 v121, v121
v_exp_f32 v122, v122
v_exp_f32 v123, v123
v_cvt_pk_bf16_f32 v148, v120, v121
v_cvt_pk_bf16_f32 v149, v122, v123
v_mfma_f32_32x32x16_bf16 v[48:63], v[176:179], v[144:147], v[48:63]
buffer_load_dwordx4 v[244:247], v1, s[8:11], s18 offen offset:3072 sc1
v_exp_f32 v124, v124
v_exp_f32 v125, v125
v_exp_f32 v126, v126
v_exp_f32 v127, v127
v_cvt_pk_bf16_f32 v150, v124, v125
v_cvt_pk_bf16_f32 v151, v126, v127
v_mfma_f32_32x32x16_bf16 v[112:127], v[168:171], v[32:35], 0
v_exp_f32 v128, v128
v_exp_f32 v129, v129
v_exp_f32 v130, v130
v_exp_f32 v131, v131
v_cvt_pk_bf16_f32 v144, v128, v129
v_cvt_pk_bf16_f32 v145, v130, v131
v_mfma_f32_32x32x16_bf16 v[48:63], v[180:183], v[148:151], v[48:63]
buffer_load_dwordx4 v1, s[8:11], s25 offen offset:1024 lds
v_exp_f32 v132, v132
v_exp_f32 v133, v133
v_exp_f32 v134, v134
v_exp_f32 v135, v135
v_cvt_pk_bf16_f32 v146, v132, v133
v_cvt_pk_bf16_f32 v147, v134, v135
v_mfma_f32_32x32x16_bf16 v[112:127], v[172:175], v[36:39], v[112:127]
buffer_load_dwordx4 v1, s[8:11], s25 offen offset:2048 lds
v_exp_f32 v136, v136
v_exp_f32 v137, v137
v_exp_f32 v138, v138
v_exp_f32 v139, v139
v_cvt_pk_bf16_f32 v148, v136, v137
v_cvt_pk_bf16_f32 v149, v138, v139
v_mfma_f32_32x32x16_bf16 v[64:79], v[176:179], v[144:147], v[64:79]
s_add_u32 s18, s17, 49152
buffer_load_dwordx4 v[152:155], v1, s[8:11], s18 offen offset:0 sc1
v_exp_f32 v140, v140
v_exp_f32 v141, v141
v_exp_f32 v142, v142
v_exp_f32 v143, v143
v_cvt_pk_bf16_f32 v150, v140, v141
v_cvt_pk_bf16_f32 v151, v142, v143
v_mfma_f32_32x32x16_bf16 v[128:143], v[168:171], v[40:43], 0
v_exp_f32 v112, v112
v_exp_f32 v113, v113
v_exp_f32 v114, v114
v_exp_f32 v115, v115
v_cvt_pk_bf16_f32 v144, v112, v113
v_cvt_pk_bf16_f32 v145, v114, v115
v_mfma_f32_32x32x16_bf16 v[64:79], v[180:183], v[148:151], v[64:79]
s_add_u32 s24, s50, 49152
s_mov_b32 m0, s24
s_add_u32 s25, s52, 49152
buffer_load_dwordx4 v1, s[8:11], s25 offen offset:0 lds
v_exp_f32 v116, v116
v_exp_f32 v117, v117
v_exp_f32 v118, v118
v_exp_f32 v119, v119
v_cvt_pk_bf16_f32 v146, v116, v117
v_cvt_pk_bf16_f32 v147, v118, v119
v_mfma_f32_32x32x16_bf16 v[128:143], v[172:175], v[44:47], v[128:143]
buffer_load_dwordx4 v1, s[8:11], s25 offen offset:1024 lds
v_exp_f32 v120, v120
v_exp_f32 v121, v121
v_exp_f32 v122, v122
v_exp_f32 v123, v123
v_cvt_pk_bf16_f32 v148, v120, v121
v_cvt_pk_bf16_f32 v149, v122, v123
v_mfma_f32_32x32x16_bf16 v[80:95], v[176:179], v[144:147], v[80:95]
buffer_load_dwordx4 v[156:159], v1, s[8:11], s18 offen offset:1024 sc1
v_exp_f32 v124, v124
v_exp_f32 v125, v125
v_exp_f32 v126, v126
v_exp_f32 v127, v127
v_cvt_pk_bf16_f32 v150, v124, v125
v_cvt_pk_bf16_f32 v151, v126, v127
v_mfma_f32_32x32x16_bf16 v[112:127], v[184:187], v[16:19], 0
v_exp_f32 v128, v128
v_exp_f32 v129, v129
v_exp_f32 v130, v130
v_exp_f32 v131, v131
v_cvt_pk_bf16_f32 v144, v128, v129
v_cvt_pk_bf16_f32 v145, v130, v131
v_mfma_f32_32x32x16_bf16 v[80:95], v[180:183], v[148:151], v[80:95]
buffer_load_dwordx4 v1, s[8:11], s25 offen offset:2048 lds
v_exp_f32 v132, v132
v_exp_f32 v133, v133
v_exp_f32 v134, v134
v_exp_f32 v135, v135
v_cvt_pk_bf16_f32 v146, v132, v133
v_cvt_pk_bf16_f32 v147, v134, v135
v_mfma_f32_32x32x16_bf16 v[112:127], v[188:191], v[20:23], v[112:127]
s_add_u32 s24, s50, 61440
s_mov_b32 m0, s24
s_add_u32 s25, s52, 61440
buffer_load_dwordx4 v1, s[8:11], s25 offen offset:0 lds
v_exp_f32 v136, v136
v_exp_f32 v137, v137
v_exp_f32 v138, v138
v_exp_f32 v139, v139
v_cvt_pk_bf16_f32 v148, v136, v137
v_cvt_pk_bf16_f32 v149, v138, v139
v_mfma_f32_32x32x16_bf16 v[96:111], v[176:179], v[144:147], v[96:111]
buffer_load_dwordx4 v[160:163], v1, s[8:11], s18 offen offset:2048 sc1
v_exp_f32 v140, v140
v_exp_f32 v141, v141
v_exp_f32 v142, v142
v_exp_f32 v143, v143
v_cvt_pk_bf16_f32 v150, v140, v141
v_cvt_pk_bf16_f32 v151, v142, v143
v_mfma_f32_32x32x16_bf16 v[128:143], v[184:187], v[24:27], 0
v_exp_f32 v112, v112
v_exp_f32 v113, v113
v_exp_f32 v114, v114
v_exp_f32 v115, v115
v_cvt_pk_bf16_f32 v144, v112, v113
v_cvt_pk_bf16_f32 v145, v114, v115
v_mfma_f32_32x32x16_bf16 v[96:111], v[180:183], v[148:151], v[96:111]
buffer_load_dwordx4 v1, s[8:11], s25 offen offset:1024 lds
v_exp_f32 v116, v116
v_exp_f32 v117, v117
v_exp_f32 v118, v118
v_exp_f32 v119, v119
v_cvt_pk_bf16_f32 v146, v116, v117
v_cvt_pk_bf16_f32 v147, v118, v119
v_mfma_f32_32x32x16_bf16 v[128:143], v[188:191], v[28:31], v[128:143]
buffer_load_dwordx4 v1, s[8:11], s25 offen offset:2048 lds
v_exp_f32 v120, v120
v_exp_f32 v121, v121
v_exp_f32 v122, v122
v_exp_f32 v123, v123
v_cvt_pk_bf16_f32 v148, v120, v121
v_cvt_pk_bf16_f32 v149, v122, v123
v_mfma_f32_32x32x16_bf16 v[48:63], v[192:195], v[144:147], v[48:63]
buffer_load_dwordx4 v[164:167], v1, s[8:11], s18 offen offset:3072 sc1
v_exp_f32 v124, v124
v_exp_f32 v125, v125
v_exp_f32 v126, v126
v_exp_f32 v127, v127
v_cvt_pk_bf16_f32 v150, v124, v125
v_cvt_pk_bf16_f32 v151, v126, v127
v_mfma_f32_32x32x16_bf16 v[112:127], v[184:187], v[32:35], 0
v_exp_f32 v128, v128
v_exp_f32 v129, v129
v_exp_f32 v130, v130
v_exp_f32 v131, v131
v_cvt_pk_bf16_f32 v144, v128, v129
v_cvt_pk_bf16_f32 v145, v130, v131
v_mfma_f32_32x32x16_bf16 v[48:63], v[196:199], v[148:151], v[48:63]
s_add_u32 s24, s50, 73728
s_mov_b32 m0, s24
s_add_u32 s25, s52, 73728
buffer_load_dwordx4 v1, s[8:11], s25 offen offset:0 lds
v_exp_f32 v132, v132
v_exp_f32 v133, v133
v_exp_f32 v134, v134
v_exp_f32 v135, v135
v_cvt_pk_bf16_f32 v146, v132, v133
v_cvt_pk_bf16_f32 v147, v134, v135
v_mfma_f32_32x32x16_bf16 v[112:127], v[188:191], v[36:39], v[112:127]
buffer_load_dwordx4 v1, s[8:11], s25 offen offset:1024 lds
v_exp_f32 v136, v136
v_exp_f32 v137, v137
v_exp_f32 v138, v138
v_exp_f32 v139, v139
v_cvt_pk_bf16_f32 v148, v136, v137
v_cvt_pk_bf16_f32 v149, v138, v139
v_mfma_f32_32x32x16_bf16 v[64:79], v[192:195], v[144:147], v[64:79]
s_add_u32 s18, s17, 53248
buffer_load_dwordx4 v[168:171], v1, s[8:11], s18 offen offset:0 sc1
v_exp_f32 v140, v140
v_exp_f32 v141, v141
v_exp_f32 v142, v142
v_exp_f32 v143, v143
v_cvt_pk_bf16_f32 v150, v140, v141
v_cvt_pk_bf16_f32 v151, v142, v143
v_mfma_f32_32x32x16_bf16 v[128:143], v[184:187], v[40:43], 0
v_exp_f32 v112, v112
v_exp_f32 v113, v113
v_exp_f32 v114, v114
v_exp_f32 v115, v115
v_cvt_pk_bf16_f32 v144, v112, v113
v_cvt_pk_bf16_f32 v145, v114, v115
v_mfma_f32_32x32x16_bf16 v[64:79], v[196:199], v[148:151], v[64:79]
buffer_load_dwordx4 v1, s[8:11], s25 offen offset:2048 lds
v_exp_f32 v116, v116
v_exp_f32 v117, v117
v_exp_f32 v118, v118
v_exp_f32 v119, v119
v_cvt_pk_bf16_f32 v146, v116, v117
v_cvt_pk_bf16_f32 v147, v118, v119
v_mfma_f32_32x32x16_bf16 v[128:143], v[188:191], v[44:47], v[128:143]
s_add_u32 s26, s55, 0
buffer_load_dwordx4 a[0:3], v1, s[8:11], s26 offen offset:0
v_exp_f32 v120, v120
v_exp_f32 v121, v121
v_exp_f32 v122, v122
v_exp_f32 v123, v123
v_cvt_pk_bf16_f32 v148, v120, v121
v_cvt_pk_bf16_f32 v149, v122, v123
v_mfma_f32_32x32x16_bf16 v[80:95], v[192:195], v[144:147], v[80:95]
buffer_load_dwordx4 v[172:175], v1, s[8:11], s18 offen offset:1024 sc1
v_exp_f32 v124, v124
v_exp_f32 v125, v125
v_exp_f32 v126, v126
v_exp_f32 v127, v127
v_cvt_pk_bf16_f32 v150, v124, v125
v_cvt_pk_bf16_f32 v151, v126, v127
s_waitcnt vmcnt(38)
v_mfma_f32_32x32x16_bf16 v[112:127], v[200:203], v[16:19], 0
v_exp_f32 v128, v128
v_exp_f32 v129, v129
v_exp_f32 v130, v130
v_exp_f32 v131, v131
v_cvt_pk_bf16_f32 v144, v128, v129
v_cvt_pk_bf16_f32 v145, v130, v131
v_mfma_f32_32x32x16_bf16 v[80:95], v[196:199], v[148:151], v[80:95]
s_add_u32 s26, s56, 0
buffer_load_dwordx4 a[4:7], v1, s[8:11], s26 offen offset:0
v_exp_f32 v132, v132
v_exp_f32 v133, v133
v_exp_f32 v134, v134
v_exp_f32 v135, v135
v_cvt_pk_bf16_f32 v146, v132, v133
v_cvt_pk_bf16_f32 v147, v134, v135
v_mfma_f32_32x32x16_bf16 v[112:127], v[204:207], v[20:23], v[112:127]
s_add_u32 s26, s55, 0
buffer_load_dwordx4 a[8:11], v1, s[8:11], s26 offen offset:1024
v_exp_f32 v136, v136
v_exp_f32 v137, v137
v_exp_f32 v138, v138
v_exp_f32 v139, v139
v_cvt_pk_bf16_f32 v148, v136, v137
v_cvt_pk_bf16_f32 v149, v138, v139
v_mfma_f32_32x32x16_bf16 v[96:111], v[192:195], v[144:147], v[96:111]
buffer_load_dwordx4 v[176:179], v1, s[8:11], s18 offen offset:2048 sc1
v_exp_f32 v140, v140
v_exp_f32 v141, v141
v_exp_f32 v142, v142
v_exp_f32 v143, v143
v_cvt_pk_bf16_f32 v150, v140, v141
v_cvt_pk_bf16_f32 v151, v142, v143
v_mfma_f32_32x32x16_bf16 v[128:143], v[200:203], v[24:27], 0
v_exp_f32 v112, v112
v_exp_f32 v113, v113
v_exp_f32 v114, v114
v_exp_f32 v115, v115
v_cvt_pk_bf16_f32 v144, v112, v113
v_cvt_pk_bf16_f32 v145, v114, v115
v_mfma_f32_32x32x16_bf16 v[96:111], v[196:199], v[148:151], v[96:111]
s_add_u32 s26, s56, 0
buffer_load_dwordx4 a[12:15], v1, s[8:11], s26 offen offset:1024
v_exp_f32 v116, v116
v_exp_f32 v117, v117
v_exp_f32 v118, v118
v_exp_f32 v119, v119
v_cvt_pk_bf16_f32 v146, v116, v117
v_cvt_pk_bf16_f32 v147, v118, v119
v_mfma_f32_32x32x16_bf16 v[128:143], v[204:207], v[28:31], v[128:143]
s_add_u32 s26, s55, 0
buffer_load_dwordx4 a[16:19], v1, s[8:11], s26 offen offset:2048
v_exp_f32 v120, v120
v_exp_f32 v121, v121
v_exp_f32 v122, v122
v_exp_f32 v123, v123
v_cvt_pk_bf16_f32 v148, v120, v121
v_cvt_pk_bf16_f32 v149, v122, v123
s_waitcnt vmcnt(41)
v_mfma_f32_32x32x16_bf16 v[48:63], v[208:211], v[144:147], v[48:63]
buffer_load_dwordx4 v[180:183], v1, s[8:11], s18 offen offset:3072 sc1
v_exp_f32 v124, v124
v_exp_f32 v125, v125
v_exp_f32 v126, v126
v_exp_f32 v127, v127
v_cvt_pk_bf16_f32 v150, v124, v125
v_cvt_pk_bf16_f32 v151, v126, v127
v_mfma_f32_32x32x16_bf16 v[112:127], v[200:203], v[32:35], 0
v_exp_f32 v128, v128
v_exp_f32 v129, v129
v_exp_f32 v130, v130
v_exp_f32 v131, v131
v_cvt_pk_bf16_f32 v144, v128, v129
v_cvt_pk_bf16_f32 v145, v130, v131
v_mfma_f32_32x32x16_bf16 v[48:63], v[212:215], v[148:151], v[48:63]
s_add_u32 s26, s56, 0
buffer_load_dwordx4 a[20:23], v1, s[8:11], s26 offen offset:2048
v_exp_f32 v132, v132
v_exp_f32 v133, v133
v_exp_f32 v134, v134
v_exp_f32 v135, v135
v_cvt_pk_bf16_f32 v146, v132, v133
v_cvt_pk_bf16_f32 v147, v134, v135
v_mfma_f32_32x32x16_bf16 v[112:127], v[204:207], v[36:39], v[112:127]
s_add_u32 s26, s55, 0
buffer_load_dwordx4 a[24:27], v1, s[8:11], s26 offen offset:3072
v_exp_f32 v136, v136
v_exp_f32 v137, v137
v_exp_f32 v138, v138
v_exp_f32 v139, v139
v_cvt_pk_bf16_f32 v148, v136, v137
v_cvt_pk_bf16_f32 v149, v138, v139
v_mfma_f32_32x32x16_bf16 v[64:79], v[208:211], v[144:147], v[64:79]
s_add_u32 s18, s17, 57344
buffer_load_dwordx4 v[184:187], v1, s[8:11], s18 offen offset:0 sc1
v_exp_f32 v140, v140
v_exp_f32 v141, v141
v_exp_f32 v142, v142
v_exp_f32 v143, v143
v_cvt_pk_bf16_f32 v150, v140, v141
v_cvt_pk_bf16_f32 v151, v142, v143
v_mfma_f32_32x32x16_bf16 v[128:143], v[200:203], v[40:43], 0
v_exp_f32 v112, v112
v_exp_f32 v113, v113
v_exp_f32 v114, v114
v_exp_f32 v115, v115
v_cvt_pk_bf16_f32 v144, v112, v113
v_cvt_pk_bf16_f32 v145, v114, v115
v_mfma_f32_32x32x16_bf16 v[64:79], v[212:215], v[148:151], v[64:79]
s_add_u32 s26, s56, 0
buffer_load_dwordx4 a[28:31], v1, s[8:11], s26 offen offset:3072
v_exp_f32 v116, v116
v_exp_f32 v117, v117
v_exp_f32 v118, v118
v_exp_f32 v119, v119
v_cvt_pk_bf16_f32 v146, v116, v117
v_cvt_pk_bf16_f32 v147, v118, v119
v_mfma_f32_32x32x16_bf16 v[128:143], v[204:207], v[44:47], v[128:143]
s_add_u32 s26, s55, 4096
buffer_load_dwordx4 a[32:35], v1, s[8:11], s26 offen offset:0
v_exp_f32 v120, v120
v_exp_f32 v121, v121
v_exp_f32 v122, v122
v_exp_f32 v123, v123
v_cvt_pk_bf16_f32 v148, v120, v121
v_cvt_pk_bf16_f32 v149, v122, v123
v_mfma_f32_32x32x16_bf16 v[80:95], v[208:211], v[144:147], v[80:95]
buffer_load_dwordx4 v[188:191], v1, s[8:11], s18 offen offset:1024 sc1
v_exp_f32 v124, v124
v_exp_f32 v125, v125
v_exp_f32 v126, v126
v_exp_f32 v127, v127
v_cvt_pk_bf16_f32 v150, v124, v125
v_cvt_pk_bf16_f32 v151, v126, v127
s_waitcnt vmcnt(46)
v_mfma_f32_32x32x16_bf16 v[112:127], v[216:219], v[16:19], 0
v_exp_f32 v128, v128
v_exp_f32 v129, v129
v_exp_f32 v130, v130
v_exp_f32 v131, v131
v_cvt_pk_bf16_f32 v144, v128, v129
v_cvt_pk_bf16_f32 v145, v130, v131
v_mfma_f32_32x32x16_bf16 v[80:95], v[212:215], v[148:151], v[80:95]
s_add_u32 s26, s56, 4096
buffer_load_dwordx4 a[36:39], v1, s[8:11], s26 offen offset:0
v_exp_f32 v132, v132
v_exp_f32 v133, v133
v_exp_f32 v134, v134
v_exp_f32 v135, v135
v_cvt_pk_bf16_f32 v146, v132, v133
v_cvt_pk_bf16_f32 v147, v134, v135
v_mfma_f32_32x32x16_bf16 v[112:127], v[220:223], v[20:23], v[112:127]
s_add_u32 s26, s55, 4096
buffer_load_dwordx4 a[40:43], v1, s[8:11], s26 offen offset:1024
v_exp_f32 v136, v136
v_exp_f32 v137, v137
v_exp_f32 v138, v138
v_exp_f32 v139, v139
v_cvt_pk_bf16_f32 v148, v136, v137
v_cvt_pk_bf16_f32 v149, v138, v139
v_mfma_f32_32x32x16_bf16 v[96:111], v[208:211], v[144:147], v[96:111]
buffer_load_dwordx4 v[192:195], v1, s[8:11], s18 offen offset:2048 sc1
v_exp_f32 v140, v140
v_exp_f32 v141, v141
v_exp_f32 v142, v142
v_exp_f32 v143, v143
v_cvt_pk_bf16_f32 v150, v140, v141
v_cvt_pk_bf16_f32 v151, v142, v143
v_mfma_f32_32x32x16_bf16 v[128:143], v[216:219], v[24:27], 0
v_exp_f32 v112, v112
v_exp_f32 v113, v113
v_exp_f32 v114, v114
v_exp_f32 v115, v115
v_cvt_pk_bf16_f32 v144, v112, v113
v_cvt_pk_bf16_f32 v145, v114, v115
v_mfma_f32_32x32x16_bf16 v[96:111], v[212:215], v[148:151], v[96:111]
s_add_u32 s26, s56, 4096
buffer_load_dwordx4 a[44:47], v1, s[8:11], s26 offen offset:1024
v_exp_f32 v116, v116
v_exp_f32 v117, v117
v_exp_f32 v118, v118
v_exp_f32 v119, v119
v_cvt_pk_bf16_f32 v146, v116, v117
v_cvt_pk_bf16_f32 v147, v118, v119
v_mfma_f32_32x32x16_bf16 v[128:143], v[220:223], v[28:31], v[128:143]
s_add_u32 s26, s55, 4096
buffer_load_dwordx4 a[48:51], v1, s[8:11], s26 offen offset:2048
v_exp_f32 v120, v120
v_exp_f32 v121, v121
v_exp_f32 v122, v122
v_exp_f32 v123, v123
v_cvt_pk_bf16_f32 v148, v120, v121
v_cvt_pk_bf16_f32 v149, v122, v123
s_waitcnt vmcnt(47)
v_mfma_f32_32x32x16_bf16 v[48:63], v[224:227], v[144:147], v[48:63]
buffer_load_dwordx4 v[196:199], v1, s[8:11], s18 offen offset:3072 sc1
v_exp_f32 v124, v124
v_exp_f32 v125, v125
v_exp_f32 v126, v126
v_exp_f32 v127, v127
v_cvt_pk_bf16_f32 v150, v124, v125
v_cvt_pk_bf16_f32 v151, v126, v127
v_mfma_f32_32x32x16_bf16 v[112:127], v[216:219], v[32:35], 0
v_exp_f32 v128, v128
v_exp_f32 v129, v129
v_exp_f32 v130, v130
v_exp_f32 v131, v131
v_cvt_pk_bf16_f32 v144, v128, v129
v_cvt_pk_bf16_f32 v145, v130, v131
v_mfma_f32_32x32x16_bf16 v[48:63], v[228:231], v[148:151], v[48:63]
s_add_u32 s26, s56, 4096
buffer_load_dwordx4 a[52:55], v1, s[8:11], s26 offen offset:2048
v_exp_f32 v132, v132
v_exp_f32 v133, v133
v_exp_f32 v134, v134
v_exp_f32 v135, v135
v_cvt_pk_bf16_f32 v146, v132, v133
v_cvt_pk_bf16_f32 v147, v134, v135
v_mfma_f32_32x32x16_bf16 v[112:127], v[220:223], v[36:39], v[112:127]
s_add_u32 s26, s55, 4096
buffer_load_dwordx4 a[56:59], v1, s[8:11], s26 offen offset:3072
v_exp_f32 v136, v136
v_exp_f32 v137, v137
v_exp_f32 v138, v138
v_exp_f32 v139, v139
v_cvt_pk_bf16_f32 v148, v136, v137
v_cvt_pk_bf16_f32 v149, v138, v139
v_mfma_f32_32x32x16_bf16 v[64:79], v[224:227], v[144:147], v[64:79]
s_add_u32 s18, s17, 61440
buffer_load_dwordx4 v[200:203], v1, s[8:11], s18 offen offset:0 sc1
v_exp_f32 v140, v140
v_exp_f32 v141, v141
v_exp_f32 v142, v142
v_exp_f32 v143, v143
v_cvt_pk_bf16_f32 v150, v140, v141
v_cvt_pk_bf16_f32 v151, v142, v143
v_mfma_f32_32x32x16_bf16 v[128:143], v[216:219], v[40:43], 0
v_exp_f32 v112, v112
v_exp_f32 v113, v113
v_exp_f32 v114, v114
v_exp_f32 v115, v115
v_cvt_pk_bf16_f32 v144, v112, v113
v_cvt_pk_bf16_f32 v145, v114, v115
v_mfma_f32_32x32x16_bf16 v[64:79], v[228:231], v[148:151], v[64:79]
s_add_u32 s26, s56, 4096
buffer_load_dwordx4 a[60:63], v1, s[8:11], s26 offen offset:3072
v_exp_f32 v116, v116
v_exp_f32 v117, v117
v_exp_f32 v118, v118
v_exp_f32 v119, v119
v_cvt_pk_bf16_f32 v146, v116, v117
v_cvt_pk_bf16_f32 v147, v118, v119
v_mfma_f32_32x32x16_bf16 v[128:143], v[220:223], v[44:47], v[128:143]
s_add_u32 s26, s57, 0
buffer_load_dwordx4 a[112:115], v1, s[8:11], s26 offen offset:0
v_exp_f32 v120, v120
v_exp_f32 v121, v121
v_exp_f32 v122, v122
v_exp_f32 v123, v123
v_cvt_pk_bf16_f32 v148, v120, v121
v_cvt_pk_bf16_f32 v149, v122, v123
v_mfma_f32_32x32x16_bf16 v[80:95], v[224:227], v[144:147], v[80:95]
buffer_load_dwordx4 v[204:207], v1, s[8:11], s18 offen offset:1024 sc1
v_exp_f32 v124, v124
v_exp_f32 v125, v125
v_exp_f32 v126, v126
v_exp_f32 v127, v127
v_cvt_pk_bf16_f32 v150, v124, v125
v_cvt_pk_bf16_f32 v151, v126, v127
s_waitcnt vmcnt(48)
v_mfma_f32_32x32x16_bf16 v[112:127], v[232:235], v[16:19], 0
v_exp_f32 v128, v128
v_exp_f32 v129, v129
v_exp_f32 v130, v130
v_exp_f32 v131, v131
v_cvt_pk_bf16_f32 v144, v128, v129
v_cvt_pk_bf16_f32 v145, v130, v131
v_mfma_f32_32x32x16_bf16 v[80:95], v[228:231], v[148:151], v[80:95]
s_add_u32 s26, s58, 0
buffer_load_dwordx4 a[116:119], v1, s[8:11], s26 offen offset:0
v_exp_f32 v132, v132
v_exp_f32 v133, v133
v_exp_f32 v134, v134
v_exp_f32 v135, v135
v_cvt_pk_bf16_f32 v146, v132, v133
v_cvt_pk_bf16_f32 v147, v134, v135
v_mfma_f32_32x32x16_bf16 v[112:127], v[236:239], v[20:23], v[112:127]
s_add_u32 s26, s57, 0
buffer_load_dwordx4 a[120:123], v1, s[8:11], s26 offen offset:1024
v_exp_f32 v136, v136
v_exp_f32 v137, v137
v_exp_f32 v138, v138
v_exp_f32 v139, v139
v_cvt_pk_bf16_f32 v148, v136, v137
v_cvt_pk_bf16_f32 v149, v138, v139
v_mfma_f32_32x32x16_bf16 v[96:111], v[224:227], v[144:147], v[96:111]
buffer_load_dwordx4 v[208:211], v1, s[8:11], s18 offen offset:2048 sc1
v_exp_f32 v140, v140
v_exp_f32 v141, v141
v_exp_f32 v142, v142
v_exp_f32 v143, v143
v_cvt_pk_bf16_f32 v150, v140, v141
v_cvt_pk_bf16_f32 v151, v142, v143
v_mfma_f32_32x32x16_bf16 v[128:143], v[232:235], v[24:27], 0
v_exp_f32 v112, v112
v_exp_f32 v113, v113
v_exp_f32 v114, v114
v_exp_f32 v115, v115
v_cvt_pk_bf16_f32 v144, v112, v113
v_cvt_pk_bf16_f32 v145, v114, v115
v_mfma_f32_32x32x16_bf16 v[96:111], v[228:231], v[148:151], v[96:111]
s_add_u32 s26, s58, 0
buffer_load_dwordx4 a[124:127], v1, s[8:11], s26 offen offset:1024
v_exp_f32 v116, v116
v_exp_f32 v117, v117
v_exp_f32 v118, v118
v_exp_f32 v119, v119
v_cvt_pk_bf16_f32 v146, v116, v117
v_cvt_pk_bf16_f32 v147, v118, v119
v_mfma_f32_32x32x16_bf16 v[128:143], v[236:239], v[28:31], v[128:143]
s_add_u32 s26, s57, 0
buffer_load_dwordx4 a[128:131], v1, s[8:11], s26 offen offset:2048
v_exp_f32 v120, v120
v_exp_f32 v121, v121
v_exp_f32 v122, v122
v_exp_f32 v123, v123
v_cvt_pk_bf16_f32 v148, v120, v121
v_cvt_pk_bf16_f32 v149, v122, v123
s_waitcnt vmcnt(47)
v_mfma_f32_32x32x16_bf16 v[48:63], v[240:243], v[144:147], v[48:63]
buffer_load_dwordx4 v[212:215], v1, s[8:11], s18 offen offset:3072 sc1
v_exp_f32 v124, v124
v_exp_f32 v125, v125
v_exp_f32 v126, v126
v_exp_f32 v127, v127
v_cvt_pk_bf16_f32 v150, v124, v125
v_cvt_pk_bf16_f32 v151, v126, v127
v_mfma_f32_32x32x16_bf16 v[112:127], v[232:235], v[32:35], 0
v_exp_f32 v128, v128
v_exp_f32 v129, v129
v_exp_f32 v130, v130
v_exp_f32 v131, v131
v_cvt_pk_bf16_f32 v144, v128, v129
v_cvt_pk_bf16_f32 v145, v130, v131
v_mfma_f32_32x32x16_bf16 v[48:63], v[244:247], v[148:151], v[48:63]
s_add_u32 s26, s58, 0
buffer_load_dwordx4 a[132:135], v1, s[8:11], s26 offen offset:2048
v_exp_f32 v132, v132
v_exp_f32 v133, v133
v_exp_f32 v134, v134
v_exp_f32 v135, v135
v_cvt_pk_bf16_f32 v146, v132, v133
v_cvt_pk_bf16_f32 v147, v134, v135
v_mfma_f32_32x32x16_bf16 v[112:127], v[236:239], v[36:39], v[112:127]
s_add_u32 s26, s57, 0
buffer_load_dwordx4 a[136:139], v1, s[8:11], s26 offen offset:3072
v_exp_f32 v136, v136
v_exp_f32 v137, v137
v_exp_f32 v138, v138
v_exp_f32 v139, v139
v_cvt_pk_bf16_f32 v148, v136, v137
v_cvt_pk_bf16_f32 v149, v138, v139
v_mfma_f32_32x32x16_bf16 v[64:79], v[240:243], v[144:147], v[64:79]
s_add_u32 s26, s58, 0
buffer_load_dwordx4 a[140:143], v1, s[8:11], s26 offen offset:3072
v_exp_f32 v140, v140
v_exp_f32 v141, v141
v_exp_f32 v142, v142
v_exp_f32 v143, v143
v_cvt_pk_bf16_f32 v150, v140, v141
v_cvt_pk_bf16_f32 v151, v142, v143
v_mfma_f32_32x32x16_bf16 v[128:143], v[232:235], v[40:43], 0
v_exp_f32 v112, v112
v_exp_f32 v113, v113
v_exp_f32 v114, v114
v_exp_f32 v115, v115
v_cvt_pk_bf16_f32 v144, v112, v113
v_cvt_pk_bf16_f32 v145, v114, v115
v_mfma_f32_32x32x16_bf16 v[64:79], v[244:247], v[148:151], v[64:79]
s_add_u32 s26, s57, 4096
buffer_load_dwordx4 a[144:147], v1, s[8:11], s26 offen offset:0
v_exp_f32 v116, v116
v_exp_f32 v117, v117
v_exp_f32 v118, v118
v_exp_f32 v119, v119
v_cvt_pk_bf16_f32 v146, v116, v117
v_cvt_pk_bf16_f32 v147, v118, v119
v_mfma_f32_32x32x16_bf16 v[128:143], v[236:239], v[44:47], v[128:143]
s_add_u32 s26, s58, 4096
buffer_load_dwordx4 a[148:151], v1, s[8:11], s26 offen offset:0
v_exp_f32 v120, v120
v_exp_f32 v121, v121
v_exp_f32 v122, v122
v_exp_f32 v123, v123
v_cvt_pk_bf16_f32 v148, v120, v121
v_cvt_pk_bf16_f32 v149, v122, v123
v_mfma_f32_32x32x16_bf16 v[80:95], v[240:243], v[144:147], v[80:95]
s_add_u32 s26, s57, 4096
buffer_load_dwordx4 a[152:155], v1, s[8:11], s26 offen offset:1024
v_exp_f32 v124, v124
v_exp_f32 v125, v125
v_exp_f32 v126, v126
v_exp_f32 v127, v127
v_cvt_pk_bf16_f32 v150, v124, v125
v_cvt_pk_bf16_f32 v151, v126, v127
s_waitcnt vmcnt(48)
v_mfma_f32_32x32x16_bf16 v[112:127], v[152:155], v[16:19], 0
v_exp_f32 v128, v128
v_exp_f32 v129, v129
v_exp_f32 v130, v130
v_exp_f32 v131, v131
v_cvt_pk_bf16_f32 v144, v128, v129
v_cvt_pk_bf16_f32 v145, v130, v131
v_mfma_f32_32x32x16_bf16 v[80:95], v[244:247], v[148:151], v[80:95]
s_add_u32 s26, s58, 4096
buffer_load_dwordx4 a[156:159], v1, s[8:11], s26 offen offset:1024
v_exp_f32 v132, v132
v_exp_f32 v133, v133
v_exp_f32 v134, v134
v_exp_f32 v135, v135
v_cvt_pk_bf16_f32 v146, v132, v133
v_cvt_pk_bf16_f32 v147, v134, v135
v_mfma_f32_32x32x16_bf16 v[112:127], v[156:159], v[20:23], v[112:127]
s_add_u32 s26, s57, 4096
buffer_load_dwordx4 a[160:163], v1, s[8:11], s26 offen offset:2048
v_exp_f32 v136, v136
v_exp_f32 v137, v137
v_exp_f32 v138, v138
v_exp_f32 v139, v139
v_cvt_pk_bf16_f32 v148, v136, v137
v_cvt_pk_bf16_f32 v149, v138, v139
v_mfma_f32_32x32x16_bf16 v[96:111], v[240:243], v[144:147], v[96:111]
s_add_u32 s26, s58, 4096
buffer_load_dwordx4 a[164:167], v1, s[8:11], s26 offen offset:2048
v_exp_f32 v140, v140
v_exp_f32 v141, v141
v_exp_f32 v142, v142
v_exp_f32 v143, v143
v_cvt_pk_bf16_f32 v150, v140, v141
v_cvt_pk_bf16_f32 v151, v142, v143
v_mfma_f32_32x32x16_bf16 v[128:143], v[152:155], v[24:27], 0
v_exp_f32 v112, v112
v_exp_f32 v113, v113
v_exp_f32 v114, v114
v_exp_f32 v115, v115
v_cvt_pk_bf16_f32 v144, v112, v113
v_cvt_pk_bf16_f32 v145, v114, v115
v_mfma_f32_32x32x16_bf16 v[96:111], v[244:247], v[148:151], v[96:111]
s_add_u32 s26, s57, 4096
buffer_load_dwordx4 a[168:171], v1, s[8:11], s26 offen offset:3072
v_exp_f32 v116, v116
v_exp_f32 v117, v117
v_exp_f32 v118, v118
v_exp_f32 v119, v119
v_cvt_pk_bf16_f32 v146, v116, v117
v_cvt_pk_bf16_f32 v147, v118, v119
v_mfma_f32_32x32x16_bf16 v[128:143], v[156:159], v[28:31], v[128:143]
s_add_u32 s26, s58, 4096
buffer_load_dwordx4 a[172:175], v1, s[8:11], s26 offen offset:3072
v_exp_f32 v120, v120
v_exp_f32 v121, v121
v_exp_f32 v122, v122
v_exp_f32 v123, v123
v_cvt_pk_bf16_f32 v148, v120, v121
v_cvt_pk_bf16_f32 v149, v122, v123
s_waitcnt vmcnt(47)
v_mfma_f32_32x32x16_bf16 v[48:63], v[160:163], v[144:147], v[48:63]
s_add_u32 s26, s57, 8192
buffer_load_dwordx4 a[176:179], v1, s[8:11], s26 offen offset:0
v_exp_f32 v124, v124
v_exp_f32 v125, v125
v_exp_f32 v126, v126
v_exp_f32 v127, v127
v_cvt_pk_bf16_f32 v150, v124, v125
v_cvt_pk_bf16_f32 v151, v126, v127
v_mfma_f32_32x32x16_bf16 v[112:127], v[152:155], v[32:35], 0
v_exp_f32 v128, v128
v_exp_f32 v129, v129
v_exp_f32 v130, v130
v_exp_f32 v131, v131
v_cvt_pk_bf16_f32 v144, v128, v129
v_cvt_pk_bf16_f32 v145, v130, v131
v_mfma_f32_32x32x16_bf16 v[48:63], v[164:167], v[148:151], v[48:63]
s_add_u32 s26, s58, 8192
buffer_load_dwordx4 a[180:183], v1, s[8:11], s26 offen offset:0
v_exp_f32 v132, v132
v_exp_f32 v133, v133
v_exp_f32 v134, v134
v_exp_f32 v135, v135
v_cvt_pk_bf16_f32 v146, v132, v133
v_cvt_pk_bf16_f32 v147, v134, v135
v_mfma_f32_32x32x16_bf16 v[112:127], v[156:159], v[36:39], v[112:127]
s_add_u32 s26, s57, 8192
buffer_load_dwordx4 a[184:187], v1, s[8:11], s26 offen offset:1024
v_exp_f32 v136, v136
v_exp_f32 v137, v137
v_exp_f32 v138, v138
v_exp_f32 v139, v139
v_cvt_pk_bf16_f32 v148, v136, v137
v_cvt_pk_bf16_f32 v149, v138, v139
v_mfma_f32_32x32x16_bf16 v[64:79], v[160:163], v[144:147], v[64:79]
s_add_u32 s26, s58, 8192
buffer_load_dwordx4 a[188:191], v1, s[8:11], s26 offen offset:1024
v_exp_f32 v140, v140
v_exp_f32 v141, v141
v_exp_f32 v142, v142
v_exp_f32 v143, v143
v_cvt_pk_bf16_f32 v150, v140, v141
v_cvt_pk_bf16_f32 v151, v142, v143
v_mfma_f32_32x32x16_bf16 v[128:143], v[152:155], v[40:43], 0
v_exp_f32 v112, v112
v_exp_f32 v113, v113
v_exp_f32 v114, v114
v_exp_f32 v115, v115
v_cvt_pk_bf16_f32 v144, v112, v113
v_cvt_pk_bf16_f32 v145, v114, v115
v_mfma_f32_32x32x16_bf16 v[64:79], v[164:167], v[148:151], v[64:79]
s_add_u32 s26, s57, 8192
buffer_load_dwordx4 a[192:195], v1, s[8:11], s26 offen offset:2048
v_exp_f32 v116, v116
v_exp_f32 v117, v117
v_exp_f32 v118, v118
v_exp_f32 v119, v119
v_cvt_pk_bf16_f32 v146, v116, v117
v_cvt_pk_bf16_f32 v147, v118, v119
v_mfma_f32_32x32x16_bf16 v[128:143], v[156:159], v[44:47], v[128:143]
s_add_u32 s26, s58, 8192
buffer_load_dwordx4 a[196:199], v1, s[8:11], s26 offen offset:2048
v_exp_f32 v120, v120
v_exp_f32 v121, v121
v_exp_f32 v122, v122
v_exp_f32 v123, v123
v_cvt_pk_bf16_f32 v148, v120, v121
v_cvt_pk_bf16_f32 v149, v122, v123
v_mfma_f32_32x32x16_bf16 v[80:95], v[160:163], v[144:147], v[80:95]
s_add_u32 s26, s57, 8192
buffer_load_dwordx4 a[200:203], v1, s[8:11], s26 offen offset:3072
v_exp_f32 v124, v124
v_exp_f32 v125, v125
v_exp_f32 v126, v126
v_exp_f32 v127, v127
v_cvt_pk_bf16_f32 v150, v124, v125
v_cvt_pk_bf16_f32 v151, v126, v127
s_waitcnt vmcnt(48)
v_mfma_f32_32x32x16_bf16 v[112:127], v[168:171], v[16:19], 0
v_exp_f32 v128, v128
v_exp_f32 v129, v129
v_exp_f32 v130, v130
v_exp_f32 v131, v131
v_cvt_pk_bf16_f32 v144, v128, v129
v_cvt_pk_bf16_f32 v145, v130, v131
v_mfma_f32_32x32x16_bf16 v[80:95], v[164:167], v[148:151], v[80:95]
v_exp_f32 v132, v132
v_exp_f32 v133, v133
v_exp_f32 v134, v134
v_exp_f32 v135, v135
v_cvt_pk_bf16_f32 v146, v132, v133
v_cvt_pk_bf16_f32 v147, v134, v135
v_mfma_f32_32x32x16_bf16 v[112:127], v[172:175], v[20:23], v[112:127]
s_add_u32 s26, s58, 8192
buffer_load_dwordx4 a[204:207], v1, s[8:11], s26 offen offset:3072
v_exp_f32 v136, v136
v_exp_f32 v137, v137
v_exp_f32 v138, v138
v_exp_f32 v139, v139
v_cvt_pk_bf16_f32 v148, v136, v137
v_cvt_pk_bf16_f32 v149, v138, v139
v_mfma_f32_32x32x16_bf16 v[96:111], v[160:163], v[144:147], v[96:111]
s_add_u32 s26, s57, 12288
buffer_load_dwordx4 a[208:211], v1, s[8:11], s26 offen offset:0
v_exp_f32 v140, v140
v_exp_f32 v141, v141
v_exp_f32 v142, v142
v_exp_f32 v143, v143
v_cvt_pk_bf16_f32 v150, v140, v141
v_cvt_pk_bf16_f32 v151, v142, v143
v_mfma_f32_32x32x16_bf16 v[128:143], v[168:171], v[24:27], 0
v_exp_f32 v112, v112
v_exp_f32 v113, v113
v_exp_f32 v114, v114
v_exp_f32 v115, v115
v_cvt_pk_bf16_f32 v144, v112, v113
v_cvt_pk_bf16_f32 v145, v114, v115
v_mfma_f32_32x32x16_bf16 v[96:111], v[164:167], v[148:151], v[96:111]
v_exp_f32 v116, v116
v_exp_f32 v117, v117
v_exp_f32 v118, v118
v_exp_f32 v119, v119
v_cvt_pk_bf16_f32 v146, v116, v117
v_cvt_pk_bf16_f32 v147, v118, v119
v_mfma_f32_32x32x16_bf16 v[128:143], v[172:175], v[28:31], v[128:143]
s_add_u32 s26, s58, 12288
buffer_load_dwordx4 a[212:215], v1, s[8:11], s26 offen offset:0
v_exp_f32 v120, v120
v_exp_f32 v121, v121
v_exp_f32 v122, v122
v_exp_f32 v123, v123
v_cvt_pk_bf16_f32 v148, v120, v121
v_cvt_pk_bf16_f32 v149, v122, v123
s_waitcnt vmcnt(45)
v_mfma_f32_32x32x16_bf16 v[48:63], v[176:179], v[144:147], v[48:63]
s_add_u32 s26, s57, 12288
buffer_load_dwordx4 a[216:219], v1, s[8:11], s26 offen offset:1024
v_exp_f32 v124, v124
v_exp_f32 v125, v125
v_exp_f32 v126, v126
v_exp_f32 v127, v127
v_cvt_pk_bf16_f32 v150, v124, v125
v_cvt_pk_bf16_f32 v151, v126, v127
v_mfma_f32_32x32x16_bf16 v[112:127], v[168:171], v[32:35], 0
v_exp_f32 v128, v128
v_exp_f32 v129, v129
v_exp_f32 v130, v130
v_exp_f32 v131, v131
v_cvt_pk_bf16_f32 v144, v128, v129
v_cvt_pk_bf16_f32 v145, v130, v131
v_mfma_f32_32x32x16_bf16 v[48:63], v[180:183], v[148:151], v[48:63]
v_exp_f32 v132, v132
v_exp_f32 v133, v133
v_exp_f32 v134, v134
v_exp_f32 v135, v135
v_cvt_pk_bf16_f32 v146, v132, v133
v_cvt_pk_bf16_f32 v147, v134, v135
v_mfma_f32_32x32x16_bf16 v[112:127], v[172:175], v[36:39], v[112:127]
s_add_u32 s26, s58, 12288
buffer_load_dwordx4 a[220:223], v1, s[8:11], s26 offen offset:1024
v_exp_f32 v136, v136
v_exp_f32 v137, v137
v_exp_f32 v138, v138
v_exp_f32 v139, v139
v_cvt_pk_bf16_f32 v148, v136, v137
v_cvt_pk_bf16_f32 v149, v138, v139
v_mfma_f32_32x32x16_bf16 v[64:79], v[176:179], v[144:147], v[64:79]
s_add_u32 s26, s57, 12288
buffer_load_dwordx4 a[224:227], v1, s[8:11], s26 offen offset:2048
v_exp_f32 v140, v140
v_exp_f32 v141, v141
v_exp_f32 v142, v142
v_exp_f32 v143, v143
v_cvt_pk_bf16_f32 v150, v140, v141
v_cvt_pk_bf16_f32 v151, v142, v143
v_mfma_f32_32x32x16_bf16 v[128:143], v[168:171], v[40:43], 0
v_exp_f32 v112, v112
v_exp_f32 v113, v113
v_exp_f32 v114, v114
v_exp_f32 v115, v115
v_cvt_pk_bf16_f32 v144, v112, v113
v_cvt_pk_bf16_f32 v145, v114, v115
v_mfma_f32_32x32x16_bf16 v[64:79], v[180:183], v[148:151], v[64:79]
v_exp_f32 v116, v116
v_exp_f32 v117, v117
v_exp_f32 v118, v118
v_exp_f32 v119, v119
v_cvt_pk_bf16_f32 v146, v116, v117
v_cvt_pk_bf16_f32 v147, v118, v119
v_mfma_f32_32x32x16_bf16 v[128:143], v[172:175], v[44:47], v[128:143]
s_add_u32 s26, s58, 12288
buffer_load_dwordx4 a[228:231], v1, s[8:11], s26 offen offset:2048
v_exp_f32 v120, v120
v_exp_f32 v121, v121
v_exp_f32 v122, v122
v_exp_f32 v123, v123
v_cvt_pk_bf16_f32 v148, v120, v121
v_cvt_pk_bf16_f32 v149, v122, v123
v_mfma_f32_32x32x16_bf16 v[80:95], v[176:179], v[144:147], v[80:95]
s_add_u32 s26, s57, 12288
buffer_load_dwordx4 a[232:235], v1, s[8:11], s26 offen offset:3072
v_exp_f32 v124, v124
v_exp_f32 v125, v125
v_exp_f32 v126, v126
v_exp_f32 v127, v127
v_cvt_pk_bf16_f32 v150, v124, v125
v_cvt_pk_bf16_f32 v151, v126, v127
s_waitcnt vmcnt(44)
v_mfma_f32_32x32x16_bf16 v[112:127], v[184:187], v[16:19], 0
v_exp_f32 v128, v128
v_exp_f32 v129, v129
v_exp_f32 v130, v130
v_exp_f32 v131, v131
v_cvt_pk_bf16_f32 v144, v128, v129
v_cvt_pk_bf16_f32 v145, v130, v131
v_mfma_f32_32x32x16_bf16 v[80:95], v[180:183], v[148:151], v[80:95]
v_exp_f32 v132, v132
v_exp_f32 v133, v133
v_exp_f32 v134, v134
v_exp_f32 v135, v135
v_cvt_pk_bf16_f32 v146, v132, v133
v_cvt_pk_bf16_f32 v147, v134, v135
v_mfma_f32_32x32x16_bf16 v[112:127], v[188:191], v[20:23], v[112:127]
s_add_u32 s26, s58, 12288
buffer_load_dwordx4 a[236:239], v1, s[8:11], s26 offen offset:3072
v_exp_f32 v136, v136
v_exp_f32 v137, v137
v_exp_f32 v138, v138
v_exp_f32 v139, v139
v_cvt_pk_bf16_f32 v148, v136, v137
v_cvt_pk_bf16_f32 v149, v138, v139
v_mfma_f32_32x32x16_bf16 v[96:111], v[176:179], v[144:147], v[96:111]
s_add_u32 s26, s57, 16384
buffer_load_dwordx4 a[240:243], v1, s[8:11], s26 offen offset:0
v_exp_f32 v140, v140
v_exp_f32 v141, v141
v_exp_f32 v142, v142
v_exp_f32 v143, v143
v_cvt_pk_bf16_f32 v150, v140, v141
v_cvt_pk_bf16_f32 v151, v142, v143
v_mfma_f32_32x32x16_bf16 v[128:143], v[184:187], v[24:27], 0
v_exp_f32 v112, v112
v_exp_f32 v113, v113
v_exp_f32 v114, v114
v_exp_f32 v115, v115
v_cvt_pk_bf16_f32 v144, v112, v113
v_cvt_pk_bf16_f32 v145, v114, v115
v_mfma_f32_32x32x16_bf16 v[96:111], v[180:183], v[148:151], v[96:111]
v_exp_f32 v116, v116
v_exp_f32 v117, v117
v_exp_f32 v118, v118
v_exp_f32 v119, v119
v_cvt_pk_bf16_f32 v146, v116, v117
v_cvt_pk_bf16_f32 v147, v118, v119
v_mfma_f32_32x32x16_bf16 v[128:143], v[188:191], v[28:31], v[128:143]
s_add_u32 s26, s58, 16384
buffer_load_dwordx4 a[244:247], v1, s[8:11], s26 offen offset:0
v_exp_f32 v120, v120
v_exp_f32 v121, v121
v_exp_f32 v122, v122
v_exp_f32 v123, v123
v_cvt_pk_bf16_f32 v148, v120, v121
v_cvt_pk_bf16_f32 v149, v122, v123
s_waitcnt vmcnt(41)
v_mfma_f32_32x32x16_bf16 v[48:63], v[192:195], v[144:147], v[48:63]
s_add_u32 s26, s57, 16384
buffer_load_dwordx4 a[248:251], v1, s[8:11], s26 offen offset:1024
v_exp_f32 v124, v124
v_exp_f32 v125, v125
v_exp_f32 v126, v126
v_exp_f32 v127, v127
v_cvt_pk_bf16_f32 v150, v124, v125
v_cvt_pk_bf16_f32 v151, v126, v127
v_mfma_f32_32x32x16_bf16 v[112:127], v[184:187], v[32:35], 0
v_exp_f32 v128, v128
v_exp_f32 v129, v129
v_exp_f32 v130, v130
v_exp_f32 v131, v131
v_cvt_pk_bf16_f32 v144, v128, v129
v_cvt_pk_bf16_f32 v145, v130, v131
v_mfma_f32_32x32x16_bf16 v[48:63], v[196:199], v[148:151], v[48:63]
v_exp_f32 v132, v132
v_exp_f32 v133, v133
v_exp_f32 v134, v134
v_exp_f32 v135, v135
v_cvt_pk_bf16_f32 v146, v132, v133
v_cvt_pk_bf16_f32 v147, v134, v135
v_mfma_f32_32x32x16_bf16 v[112:127], v[188:191], v[36:39], v[112:127]
s_add_u32 s26, s58, 16384
buffer_load_dwordx4 a[252:255], v1, s[8:11], s26 offen offset:1024
v_exp_f32 v136, v136
v_exp_f32 v137, v137
v_exp_f32 v138, v138
v_exp_f32 v139, v139
v_cvt_pk_bf16_f32 v148, v136, v137
v_cvt_pk_bf16_f32 v149, v138, v139
v_mfma_f32_32x32x16_bf16 v[64:79], v[192:195], v[144:147], v[64:79]
v_exp_f32 v140, v140
v_exp_f32 v141, v141
v_exp_f32 v142, v142
v_exp_f32 v143, v143
v_cvt_pk_bf16_f32 v150, v140, v141
v_cvt_pk_bf16_f32 v151, v142, v143
v_mfma_f32_32x32x16_bf16 v[128:143], v[184:187], v[40:43], 0
v_exp_f32 v112, v112
v_exp_f32 v113, v113
v_exp_f32 v114, v114
v_exp_f32 v115, v115
v_cvt_pk_bf16_f32 v144, v112, v113
v_cvt_pk_bf16_f32 v145, v114, v115
v_mfma_f32_32x32x16_bf16 v[64:79], v[196:199], v[148:151], v[64:79]
v_exp_f32 v116, v116
v_exp_f32 v117, v117
v_exp_f32 v118, v118
v_exp_f32 v119, v119
v_cvt_pk_bf16_f32 v146, v116, v117
v_cvt_pk_bf16_f32 v147, v118, v119
v_mfma_f32_32x32x16_bf16 v[128:143], v[188:191], v[44:47], v[128:143]
v_exp_f32 v120, v120
v_exp_f32 v121, v121
v_exp_f32 v122, v122
v_exp_f32 v123, v123
v_cvt_pk_bf16_f32 v148, v120, v121
v_cvt_pk_bf16_f32 v149, v122, v123
v_mfma_f32_32x32x16_bf16 v[80:95], v[192:195], v[144:147], v[80:95]
v_exp_f32 v124, v124
v_exp_f32 v125, v125
v_exp_f32 v126, v126
v_exp_f32 v127, v127
v_cvt_pk_bf16_f32 v150, v124, v125
v_cvt_pk_bf16_f32 v151, v126, v127
s_waitcnt vmcnt(37)
v_mfma_f32_32x32x16_bf16 v[112:127], v[200:203], v[16:19], 0
v_exp_f32 v128, v128
v_exp_f32 v129, v129
v_exp_f32 v130, v130
v_exp_f32 v131, v131
v_cvt_pk_bf16_f32 v144, v128, v129
v_cvt_pk_bf16_f32 v145, v130, v131
v_mfma_f32_32x32x16_bf16 v[80:95], v[196:199], v[148:151], v[80:95]
v_exp_f32 v132, v132
v_exp_f32 v133, v133
v_exp_f32 v134, v134
v_exp_f32 v135, v135
v_cvt_pk_bf16_f32 v146, v132, v133
v_cvt_pk_bf16_f32 v147, v134, v135
v_mfma_f32_32x32x16_bf16 v[112:127], v[204:207], v[20:23], v[112:127]
v_exp_f32 v136, v136
v_exp_f32 v137, v137
v_exp_f32 v138, v138
v_exp_f32 v139, v139
v_cvt_pk_bf16_f32 v148, v136, v137
v_cvt_pk_bf16_f32 v149, v138, v139
v_mfma_f32_32x32x16_bf16 v[96:111], v[192:195], v[144:147], v[96:111]
v_exp_f32 v140, v140
v_exp_f32 v141, v141
v_exp_f32 v142, v142
v_exp_f32 v143, v143
v_cvt_pk_bf16_f32 v150, v140, v141
v_cvt_pk_bf16_f32 v151, v142, v143
v_mfma_f32_32x32x16_bf16 v[128:143], v[200:203], v[24:27], 0
v_exp_f32 v112, v112
v_exp_f32 v113, v113
v_exp_f32 v114, v114
v_exp_f32 v115, v115
v_cvt_pk_bf16_f32 v144, v112, v113
v_cvt_pk_bf16_f32 v145, v114, v115
v_mfma_f32_32x32x16_bf16 v[96:111], v[196:199], v[148:151], v[96:111]
v_exp_f32 v116, v116
v_exp_f32 v117, v117
v_exp_f32 v118, v118
v_exp_f32 v119, v119
v_cvt_pk_bf16_f32 v146, v116, v117
v_cvt_pk_bf16_f32 v147, v118, v119
v_mfma_f32_32x32x16_bf16 v[128:143], v[204:207], v[28:31], v[128:143]
v_exp_f32 v120, v120
v_exp_f32 v121, v121
v_exp_f32 v122, v122
v_exp_f32 v123, v123
v_cvt_pk_bf16_f32 v148, v120, v121
v_cvt_pk_bf16_f32 v149, v122, v123
s_waitcnt vmcnt(31)
v_mfma_f32_32x32x16_bf16 v[48:63], v[208:211], v[144:147], v[48:63]
v_exp_f32 v124, v124
v_exp_f32 v125, v125
v_exp_f32 v126, v126
v_exp_f32 v127, v127
v_cvt_pk_bf16_f32 v150, v124, v125
v_cvt_pk_bf16_f32 v151, v126, v127
v_mfma_f32_32x32x16_bf16 v[112:127], v[200:203], v[32:35], 0
v_exp_f32 v128, v128
v_exp_f32 v129, v129
v_exp_f32 v130, v130
v_exp_f32 v131, v131
v_cvt_pk_bf16_f32 v144, v128, v129
v_cvt_pk_bf16_f32 v145, v130, v131
v_mfma_f32_32x32x16_bf16 v[48:63], v[212:215], v[148:151], v[48:63]
v_exp_f32 v132, v132
v_exp_f32 v133, v133
v_exp_f32 v134, v134
v_exp_f32 v135, v135
v_cvt_pk_bf16_f32 v146, v132, v133
v_cvt_pk_bf16_f32 v147, v134, v135
v_mfma_f32_32x32x16_bf16 v[112:127], v[204:207], v[36:39], v[112:127]
v_exp_f32 v136, v136
v_exp_f32 v137, v137
v_exp_f32 v138, v138
v_exp_f32 v139, v139
v_cvt_pk_bf16_f32 v148, v136, v137
v_cvt_pk_bf16_f32 v149, v138, v139
v_mfma_f32_32x32x16_bf16 v[64:79], v[208:211], v[144:147], v[64:79]
v_exp_f32 v140, v140
v_exp_f32 v141, v141
v_exp_f32 v142, v142
v_exp_f32 v143, v143
v_cvt_pk_bf16_f32 v150, v140, v141
v_cvt_pk_bf16_f32 v151, v142, v143
v_mfma_f32_32x32x16_bf16 v[128:143], v[200:203], v[40:43], 0
v_exp_f32 v112, v112
v_exp_f32 v113, v113
v_exp_f32 v114, v114
v_exp_f32 v115, v115
v_cvt_pk_bf16_f32 v144, v112, v113
v_cvt_pk_bf16_f32 v145, v114, v115
v_mfma_f32_32x32x16_bf16 v[64:79], v[212:215], v[148:151], v[64:79]
v_exp_f32 v116, v116
v_exp_f32 v117, v117
v_exp_f32 v118, v118
v_exp_f32 v119, v119
v_cvt_pk_bf16_f32 v146, v116, v117
v_cvt_pk_bf16_f32 v147, v118, v119
v_mfma_f32_32x32x16_bf16 v[128:143], v[204:207], v[44:47], v[128:143]
v_exp_f32 v120, v120
v_exp_f32 v121, v121
v_exp_f32 v122, v122
v_exp_f32 v123, v123
v_cvt_pk_bf16_f32 v148, v120, v121
v_cvt_pk_bf16_f32 v149, v122, v123
v_mfma_f32_32x32x16_bf16 v[80:95], v[208:211], v[144:147], v[80:95]
v_exp_f32 v124, v124
v_exp_f32 v125, v125
v_exp_f32 v126, v126
v_exp_f32 v127, v127
v_cvt_pk_bf16_f32 v150, v124, v125
v_cvt_pk_bf16_f32 v151, v126, v127
v_exp_f32 v128, v128
v_exp_f32 v129, v129
v_exp_f32 v130, v130
v_exp_f32 v131, v131
v_cvt_pk_bf16_f32 v144, v128, v129
v_cvt_pk_bf16_f32 v145, v130, v131
v_mfma_f32_32x32x16_bf16 v[80:95], v[212:215], v[148:151], v[80:95]
v_exp_f32 v132, v132
v_exp_f32 v133, v133
v_exp_f32 v134, v134
v_exp_f32 v135, v135
v_cvt_pk_bf16_f32 v146, v132, v133
v_cvt_pk_bf16_f32 v147, v134, v135
v_exp_f32 v136, v136
v_exp_f32 v137, v137
v_exp_f32 v138, v138
v_exp_f32 v139, v139
v_cvt_pk_bf16_f32 v148, v136, v137
v_cvt_pk_bf16_f32 v149, v138, v139
v_mfma_f32_32x32x16_bf16 v[96:111], v[208:211], v[144:147], v[96:111]
v_exp_f32 v140, v140
v_exp_f32 v141, v141
v_exp_f32 v142, v142
v_exp_f32 v143, v143
v_cvt_pk_bf16_f32 v150, v140, v141
v_cvt_pk_bf16_f32 v151, v142, v143
s_nop 1
v_mfma_f32_32x32x16_bf16 v[96:111], v[212:215], v[148:151], v[96:111]
s_sub_u32 s20, s3, 1
s_and_b32 s20, s20, 3
s_lshl_b32 s20, s20, 12
s_add_u32 s20, s20, 114688
v_add_u32 v4, s20, v1
s_sub_u32 s20, s3, 2
s_and_b32 s20, s20, 3
s_lshl_b32 s20, s20, 12
s_add_u32 s20, s20, 126976
v_add_u32 v5, s20, v1
s_sub_u32 s20, s3, 3
s_and_b32 s20, s20, 3
s_lshl_b32 s20, s20, 12
s_add_u32 s20, s20, 139264
v_add_u32 v6, s20, v1
s_sub_u32 s20, s3, 4
s_and_b32 s20, s20, 3
s_lshl_b32 s20, s20, 12
s_add_u32 s20, s20, 151552
v_add_u32 v7, s20, v1
s_mul_i32 s20, s3, 12288
s_add_u32 s20, s20, 114688
v_add_u32 v12, s20, v1
s_lshl_b32 s28, s3, 2
s_add_u32 s28, s28, 113664
v_mov_b32 v9, s28
v_mov_b32 v10, 113664
v_mov_b32 v8, 0x1f800000
s_lshl_b32 s25, s43, 2
s_add_u32 s25, s25, s3
s_lshl_b32 s25, s25, 5
s_lshl_b32 s26, s42, 1
s_add_u32 s25, s25, s26
s_lshl_b32 s25, s25, 10
s_add_u32 s25, s25, 19922944
s_cmp_eq_u32 s3, 0
s_cbranch_scc1 main_kernel_b0_own0
ds_write_b128 v4, v[48:51] offset:0
ds_write_b128 v4, v[52:55] offset:1024
ds_write_b128 v4, v[56:59] offset:2048
ds_write_b128 v4, v[60:63] offset:3072
s_branch main_kernel_b0_nx0
main_kernel_b0_own0:
v_mov_b32 v112, v48
v_mov_b32 v113, v49
v_mov_b32 v114, v50
v_mov_b32 v115, v51
v_mov_b32 v116, v52
v_mov_b32 v117, v53
v_mov_b32 v118, v54
v_mov_b32 v119, v55
v_mov_b32 v120, v56
v_mov_b32 v121, v57
v_mov_b32 v122, v58
v_mov_b32 v123, v59
v_mov_b32 v124, v60
v_mov_b32 v125, v61
v_mov_b32 v126, v62
v_mov_b32 v127, v63
main_kernel_b0_nx0:
s_cmp_eq_u32 s3, 1
s_cbranch_scc1 main_kernel_b0_own1
ds_write_b128 v5, v[64:67] offset:0
ds_write_b128 v5, v[68:71] offset:1024
ds_write_b128 v5, v[72:75] offset:2048
ds_write_b128 v5, v[76:79] offset:3072
s_branch main_kernel_b0_nx1
main_kernel_b0_own1:
v_mov_b32 v112, v64
v_mov_b32 v113, v65
v_mov_b32 v114, v66
v_mov_b32 v115, v67
v_mov_b32 v116, v68
v_mov_b32 v117, v69
v_mov_b32 v118, v70
v_mov_b32 v119, v71
v_mov_b32 v120, v72
v_mov_b32 v121, v73
v_mov_b32 v122, v74
v_mov_b32 v123, v75
v_mov_b32 v124, v76
v_mov_b32 v125, v77
v_mov_b32 v126, v78
v_mov_b32 v127, v79
main_kernel_b0_nx1:
s_cmp_eq_u32 s3, 2
s_cbranch_scc1 main_kernel_b0_own2
ds_write_b128 v6, v[80:83] offset:0
ds_write_b128 v6, v[84:87] offset:1024
ds_write_b128 v6, v[88:91] offset:2048
ds_write_b128 v6, v[92:95] offset:3072
s_branch main_kernel_b0_nx2
main_kernel_b0_own2:
v_mov_b32 v112, v80
v_mov_b32 v113, v81
v_mov_b32 v114, v82
v_mov_b32 v115, v83
v_mov_b32 v116, v84
v_mov_b32 v117, v85
v_mov_b32 v118, v86
v_mov_b32 v119, v87
v_mov_b32 v120, v88
v_mov_b32 v121, v89
v_mov_b32 v122, v90
v_mov_b32 v123, v91
v_mov_b32 v124, v92
v_mov_b32 v125, v93
v_mov_b32 v126, v94
v_mov_b32 v127, v95
main_kernel_b0_nx2:
s_nop 3
s_cmp_eq_u32 s3, 3
s_cbranch_scc1 main_kernel_b0_own3
ds_write_b128 v7, v[96:99] offset:0
ds_write_b128 v7, v[100:103] offset:1024
ds_write_b128 v7, v[104:107] offset:2048
ds_write_b128 v7, v[108:111] offset:3072
s_branch main_kernel_b0_nx3
main_kernel_b0_own3:
v_mov_b32 v112, v96
v_mov_b32 v113, v97
v_mov_b32 v114, v98
v_mov_b32 v115, v99
v_mov_b32 v116, v100
v_mov_b32 v117, v101
v_mov_b32 v118, v102
v_mov_b32 v119, v103
v_mov_b32 v120, v104
v_mov_b32 v121, v105
v_mov_b32 v122, v106
v_mov_b32 v123, v107
v_mov_b32 v124, v108
v_mov_b32 v125, v109
v_mov_b32 v126, v110
v_mov_b32 v127, v111
main_kernel_b0_nx3:
s_mov_b64 s[30:31], 0
v_cmp_nge_f32 vcc, 0x5d800000, v60
v_cmp_nge_f32 s[28:29], v60, v8
s_or_b32 s31, s31, vcc_hi
s_or_b32 s31, s31, s29
v_cmp_nge_f32 vcc, 0x5d800000, v76
v_cmp_nge_f32 s[28:29], v76, v8
s_or_b32 s31, s31, vcc_hi
s_or_b32 s31, s31, s29
v_cmp_nge_f32 vcc, 0x5d800000, v92
v_cmp_nge_f32 s[28:29], v92, v8
s_or_b32 s31, s31, vcc_hi
s_or_b32 s31, s31, s29
v_cmp_nge_f32 vcc, 0x5d800000, v108
v_cmp_nge_f32 s[28:29], v108, v8
s_or_b32 s31, s31, vcc_hi
s_or_b32 s31, s31, s29
s_cmp_lg_u32 s31, 0
s_cselect_b32 s27, 1, 0
v_mov_b32 v8, s27
ds_write_b32 v9, v8
s_waitcnt lgkmcnt(0)
s_barrier
ds_read_b128 v[4:7], v10
ds_read_b128 v[152:155], v12 offset:0
ds_read_b128 v[156:159], v12 offset:1024
ds_read_b128 v[160:163], v12 offset:2048
ds_read_b128 v[164:167], v12 offset:3072
ds_read_b128 v[168:171], v12 offset:4096
ds_read_b128 v[172:175], v12 offset:5120
ds_read_b128 v[176:179], v12 offset:6144
ds_read_b128 v[180:183], v12 offset:7168
ds_read_b128 v[184:187], v12 offset:8192
ds_read_b128 v[188:191], v12 offset:9216
ds_read_b128 v[192:195], v12 offset:10240
ds_read_b128 v[196:199], v12 offset:11264
s_cmp_lg_u32 s19, 0
s_cbranch_scc1 main_kernel_b0_fin
s_waitcnt lgkmcnt(12)
v_or3_b32 v8, v4, v5, v6
v_or_b32 v8, v8, v7
s_nop 0
v_readfirstlane_b32 s27, v8
s_cmp_lg_u32 s27, 0
s_cbranch_scc1 main_kernel_b0_slow
main_kernel_b0_fin:
s_waitcnt lgkmcnt(8)
v_add_f32 v112, v112, v152
v_add_f32 v113, v113, v153
v_add_f32 v114, v114, v154
v_add_f32 v115, v115, v155
v_add_f32 v116, v116, v156
v_add_f32 v117, v117, v157
v_add_f32 v118, v118, v158
v_add_f32 v119, v119, v159
v_add_f32 v120, v120, v160
v_add_f32 v121, v121, v161
v_add_f32 v122, v122, v162
v_add_f32 v123, v123, v163
v_add_f32 v124, v124, v164
v_add_f32 v125, v125, v165
v_add_f32 v126, v126, v166
v_add_f32 v127, v127, v167
s_waitcnt lgkmcnt(4)
v_add_f32 v112, v112, v168
v_add_f32 v113, v113, v169
v_add_f32 v114, v114, v170
v_add_f32 v115, v115, v171
v_add_f32 v116, v116, v172
v_add_f32 v117, v117, v173
v_add_f32 v118, v118, v174
v_add_f32 v119, v119, v175
v_add_f32 v120, v120, v176
v_add_f32 v121, v121, v177
v_add_f32 v122, v122, v178
v_add_f32 v123, v123, v179
v_add_f32 v124, v124, v180
v_add_f32 v125, v125, v181
v_add_f32 v126, v126, v182
v_add_f32 v127, v127, v183
s_waitcnt lgkmcnt(0)
v_add_f32 v112, v112, v184
v_add_f32 v113, v113, v185
v_add_f32 v114, v114, v186
v_add_f32 v115, v115, v187
v_add_f32 v116, v116, v188
v_add_f32 v117, v117, v189
v_add_f32 v118, v118, v190
v_add_f32 v119, v119, v191
v_add_f32 v120, v120, v192
v_add_f32 v121, v121, v193
v_add_f32 v122, v122, v194
v_add_f32 v123, v123, v195
v_add_f32 v124, v124, v196
v_add_f32 v125, v125, v197
v_add_f32 v126, v126, v198
v_add_f32 v127, v127, v199
v_mov_b32 v8, v124
v_mov_b32 v9, v124
s_nop 1
v_permlane32_swap_b32 v8, v9
s_nop 1
v_rcp_f32 v9, v9
s_nop 0
v_mul_f32 v112, v112, v9
v_mul_f32 v113, v113, v9
v_mul_f32 v114, v114, v9
v_mul_f32 v115, v115, v9
v_mul_f32 v116, v116, v9
v_mul_f32 v117, v117, v9
v_mul_f32 v118, v118, v9
v_mul_f32 v119, v119, v9
v_mul_f32 v120, v120, v9
v_mul_f32 v121, v121, v9
v_mul_f32 v122, v122, v9
v_mul_f32 v123, v123, v9
v_mul_f32 v124, v124, v9
v_mul_f32 v125, v125, v9
v_mul_f32 v126, v126, v9
v_mul_f32 v127, v127, v9
v_cvt_pk_bf16_f32 v144, v112, v113
v_cvt_pk_bf16_f32 v145, v114, v115
v_cvt_pk_bf16_f32 v146, v116, v117
v_cvt_pk_bf16_f32 v147, v118, v119
v_cvt_pk_bf16_f32 v148, v120, v121
v_cvt_pk_bf16_f32 v149, v122, v123
v_cvt_pk_bf16_f32 v150, v124, v125
v_cvt_pk_bf16_f32 v151, v126, v127
buffer_store_dwordx4 v[144:147], v1, s[8:11], s25 offen offset:0 sc1
buffer_store_dwordx4 v[148:151], v1, s[8:11], s25 offen offset:1024 sc1
s_lshl_b32 s13, s43, 7
s_add_u32 s13, s13, 30017536
s_waitcnt vmcnt(0)
s_barrier
s_cmp_lg_u32 s3, 0
s_cbranch_scc1 main_kernel_sg4
v_mov_b32 v4, 1
v_mov_b32 v5, 0
s_mov_b64 exec, 1
buffer_atomic_add v4, v5, s[8:11], s13 offen sc1
s_mov_b64 exec, -1
main_kernel_sg4:
s_add_u32 s24, s53, 86016
s_mov_b32 m0, s24
s_add_u32 s25, s54, 86016
buffer_load_dwordx4 v1, s[8:11], s25 offen offset:0 lds
buffer_load_dwordx4 v1, s[8:11], s25 offen offset:1024 lds
buffer_load_dwordx4 v1, s[8:11], s25 offen offset:2048 lds
buffer_load_dwordx4 v1, s[8:11], s25 offen offset:3072 lds
s_add_u32 s24, s53, 90112
s_mov_b32 m0, s24
s_add_u32 s25, s54, 90112
buffer_load_dwordx4 v1, s[8:11], s25 offen offset:0 lds
buffer_load_dwordx4 v1, s[8:11], s25 offen offset:1024 lds
buffer_load_dwordx4 v1, s[8:11], s25 offen offset:2048 lds
s_cmp_ge_u32 s2, 224
s_cbranch_scc1 main_kernel_ce00
s_mul_i32 s18, s3, 8192
s_mul_i32 s20, s44, 32768
s_add_u32 s20, s20, s18
s_add_u32 s20, s20, 19922944
s_mul_i32 s21, s45, 32768
s_add_u32 s21, s21, s18
s_add_u32 s21, s21, 19922944
s_mul_i32 s24, s44, 28
s_lshl_b32 s25, s46, 1
s_add_u32 s24, s24, s25
s_lshl_b32 s24, s24, 10
s_add_u32 s25, s24, 0
s_lshr_b32 s12, s44, 2
s_lshl_b32 s13, s12, 7
s_add_u32 s13, s13, 30017536
s_cmp_lg_u32 s3, 0
s_cbranch_scc1 main_kernel_wt5x
s_mov_b32 s60, 0
v_mov_b32 v5, 0
main_kernel_wt5:
buffer_load_dword v4, v5, s[8:11], s13 offen sc1
s_add_u32 s60, s60, 1
s_waitcnt vmcnt(0)
v_readfirstlane_b32 s61, v4
s_cmp_ge_u32 s61, 16
s_cbranch_scc1 main_kernel_wt5x
s_cmp_gt_u32 s60, 40000
s_cbranch_scc1 main_kernel_end
s_sleep 1
s_branch main_kernel_wt5
main_kernel_wt5x:
s_waitcnt vmcnt(0)
s_barrier
buffer_load_dwordx4 v[80:83], v1, s[8:11], s20 offen offset:0 sc1
buffer_load_dwordx4 v[84:87], v1, s[8:11], s21 offen offset:0 sc1
buffer_load_dwordx4 v[88:91], v1, s[8:11], s20 offen offset:1024 sc1
buffer_load_dwordx4 v[92:95], v1, s[8:11], s21 offen offset:1024 sc1
buffer_load_dwordx4 v[96:99], v1, s[8:11], s20 offen offset:2048 sc1
buffer_load_dwordx4 v[100:103], v1, s[8:11], s21 offen offset:2048 sc1
buffer_load_dwordx4 v[104:107], v1, s[8:11], s20 offen offset:3072 sc1
buffer_load_dwordx4 v[108:111], v1, s[8:11], s21 offen offset:3072 sc1
s_add_u32 s20, s20, 4096
s_add_u32 s21, s21, 4096
buffer_load_dwordx4 v[112:115], v1, s[8:11], s20 offen offset:0 sc1
buffer_load_dwordx4 v[116:119], v1, s[8:11], s21 offen offset:0 sc1
buffer_load_dwordx4 v[120:123], v1, s[8:11], s20 offen offset:1024 sc1
buffer_load_dwordx4 v[124:127], v1, s[8:11], s21 offen offset:1024 sc1
buffer_load_dwordx4 v[128:131], v1, s[8:11], s20 offen offset:2048 sc1
buffer_load_dwordx4 v[132:135], v1, s[8:11], s21 offen offset:2048 sc1
buffer_load_dwordx4 v[136:139], v1, s[8:11], s20 offen offset:3072 sc1
buffer_load_dwordx4 v[140:143], v1, s[8:11], s21 offen offset:3072 sc1
s_waitcnt vmcnt(14)
v_mfma_f32_32x32x16_bf16 v[16:31], a[0:3], v[80:83], 0
v_mfma_f32_32x32x16_bf16 v[32:47], a[4:7], v[80:83], 0
v_mfma_f32_32x32x16_bf16 v[48:63], a[0:3], v[84:87], 0
v_mfma_f32_32x32x16_bf16 v[64:79], a[4:7], v[84:87], 0
s_waitcnt vmcnt(12)
v_mfma_f32_32x32x16_bf16 v[16:31], a[8:11], v[88:91], v[16:31]
v_mfma_f32_32x32x16_bf16 v[32:47], a[12:15], v[88:91], v[32:47]
v_mfma_f32_32x32x16_bf16 v[48:63], a[8:11], v[92:95], v[48:63]
v_mfma_f32_32x32x16_bf16 v[64:79], a[12:15], v[92:95], v[64:79]
s_waitcnt vmcnt(10)
v_mfma_f32_32x32x16_bf16 v[16:31], a[16:19], v[96:99], v[16:31]
v_mfma_f32_32x32x16_bf16 v[32:47], a[20:23], v[96:99], v[32:47]
v_mfma_f32_32x32x16_bf16 v[48:63], a[16:19], v[100:103], v[48:63]
v_mfma_f32_32x32x16_bf16 v[64:79], a[20:23], v[100:103], v[64:79]
buffer_load_dwordx4 v[208:211], v1, s[8:11], s25 offen offset:0 sc1
buffer_load_dwordx4 v[212:215], v1, s[8:11], s25 offen offset:1024 sc1
s_waitcnt vmcnt(10)
v_mfma_f32_32x32x16_bf16 v[16:31], a[24:27], v[104:107], v[16:31]
v_mfma_f32_32x32x16_bf16 v[32:47], a[28:31], v[104:107], v[32:47]
v_mfma_f32_32x32x16_bf16 v[48:63], a[24:27], v[108:111], v[48:63]
v_mfma_f32_32x32x16_bf16 v[64:79], a[28:31], v[108:111], v[64:79]
s_waitcnt vmcnt(8)
v_mfma_f32_32x32x16_bf16 v[16:31], a[32:35], v[112:115], v[16:31]
v_mfma_f32_32x32x16_bf16 v[32:47], a[36:39], v[112:115], v[32:47]
v_mfma_f32_32x32x16_bf16 v[48:63], a[32:35], v[116:119], v[48:63]
v_mfma_f32_32x32x16_bf16 v[64:79], a[36:39], v[116:119], v[64:79]
s_waitcnt vmcnt(6)
v_mfma_f32_32x32x16_bf16 v[16:31], a[40:43], v[120:123], v[16:31]
v_mfma_f32_32x32x16_bf16 v[32:47], a[44:47], v[120:123], v[32:47]
v_mfma_f32_32x32x16_bf16 v[48:63], a[40:43], v[124:127], v[48:63]
v_mfma_f32_32x32x16_bf16 v[64:79], a[44:47], v[124:127], v[64:79]
s_waitcnt vmcnt(4)
v_mfma_f32_32x32x16_bf16 v[16:31], a[48:51], v[128:131], v[16:31]
v_mfma_f32_32x32x16_bf16 v[32:47], a[52:55], v[128:131], v[32:47]
v_mfma_f32_32x32x16_bf16 v[48:63], a[48:51], v[132:135], v[48:63]
v_mfma_f32_32x32x16_bf16 v[64:79], a[52:55], v[132:135], v[64:79]
s_waitcnt vmcnt(2)
v_mfma_f32_32x32x16_bf16 v[16:31], a[56:59], v[136:139], v[16:31]
v_mfma_f32_32x32x16_bf16 v[32:47], a[60:63], v[136:139], v[32:47]
v_mfma_f32_32x32x16_bf16 v[48:63], a[56:59], v[140:143], v[48:63]
v_mfma_f32_32x32x16_bf16 v[64:79], a[60:63], v[140:143], v[64:79]
s_xor_b32 s26, s3, 1
s_mul_i32 s26, s26, 12288
s_add_u32 s26, s26, 114688
v_add_u32 v12, s26, v1
s_xor_b32 s26, s3, 2
s_mul_i32 s26, s26, 12288
s_add_u32 s26, s26, 118784
v_add_u32 v13, s26, v1
s_xor_b32 s26, s3, 3
s_mul_i32 s26, s26, 12288
s_add_u32 s26, s26, 122880
v_add_u32 v14, s26, v1
s_mul_i32 s26, s3, 12288
s_add_u32 s26, s26, 114688
v_add_u32 v5, s26, v1
ds_write_b128 v12, v[32:35] offset:0
ds_write_b128 v12, v[36:39] offset:1024
ds_write_b128 v12, v[40:43] offset:2048
ds_write_b128 v12, v[44:47] offset:3072
ds_write_b128 v13, v[48:51] offset:0
ds_write_b128 v13, v[52:55] offset:1024
ds_write_b128 v13, v[56:59] offset:2048
ds_write_b128 v13, v[60:63] offset:3072
ds_write_b128 v14, v[64:67] offset:0
ds_write_b128 v14, v[68:71] offset:1024
ds_write_b128 v14, v[72:75] offset:2048
ds_write_b128 v14, v[76:79] offset:3072
v_and_b32 v6, 31, v0
v_lshrrev_b32 v7, 5, v0
s_waitcnt vmcnt(0)
v_lshlrev_b32 v8, 16, v208
v_and_b32 v9, 0xffff0000, v208
v_add_f32 v16, v16, v8
v_add_f32 v17, v17, v9
v_lshlrev_b32 v8, 16, v209
v_and_b32 v9, 0xffff0000, v209
v_add_f32 v18, v18, v8
v_add_f32 v19, v19, v9
v_lshlrev_b32 v8, 16, v210
v_and_b32 v9, 0xffff0000, v210
v_add_f32 v20, v20, v8
v_add_f32 v21, v21, v9
v_lshlrev_b32 v8, 16, v211
v_and_b32 v9, 0xffff0000, v211
v_add_f32 v22, v22, v8
v_add_f32 v23, v23, v9
v_lshlrev_b32 v8, 16, v212
v_and_b32 v9, 0xffff0000, v212
v_add_f32 v24, v24, v8
v_add_f32 v25, v25, v9
v_lshlrev_b32 v8, 16, v213
v_and_b32 v9, 0xffff0000, v213
v_add_f32 v26, v26, v8
v_add_f32 v27, v27, v9
v_lshlrev_b32 v8, 16, v214
v_and_b32 v9, 0xffff0000, v214
v_add_f32 v28, v28, v8
v_add_f32 v29, v29, v9
v_lshlrev_b32 v8, 16, v215
v_and_b32 v9, 0xffff0000, v215
v_add_f32 v30, v30, v8
v_add_f32 v31, v31, v9
s_waitcnt lgkmcnt(0)
s_barrier
ds_read_b128 v[80:83], v5 offset:0
ds_read_b128 v[84:87], v5 offset:1024
ds_read_b128 v[88:91], v5 offset:2048
ds_read_b128 v[92:95], v5 offset:3072
ds_read_b128 v[96:99], v5 offset:4096
ds_read_b128 v[100:103], v5 offset:5120
ds_read_b128 v[104:107], v5 offset:6144
ds_read_b128 v[108:111], v5 offset:7168
ds_read_b128 v[112:115], v5 offset:8192
ds_read_b128 v[116:119], v5 offset:9216
ds_read_b128 v[120:123], v5 offset:10240
ds_read_b128 v[124:127], v5 offset:11264
s_waitcnt lgkmcnt(8)
v_add_f32 v16, v16, v80
v_add_f32 v17, v17, v81
v_add_f32 v18, v18, v82
v_add_f32 v19, v19, v83
v_add_f32 v20, v20, v84
v_add_f32 v21, v21, v85
v_add_f32 v22, v22, v86
v_add_f32 v23, v23, v87
v_add_f32 v24, v24, v88
v_add_f32 v25, v25, v89
v_add_f32 v26, v26, v90
v_add_f32 v27, v27, v91
v_add_f32 v28, v28, v92
v_add_f32 v29, v29, v93
v_add_f32 v30, v30, v94
v_add_f32 v31, v31, v95
s_waitcnt lgkmcnt(4)
v_add_f32 v16, v16, v96
v_add_f32 v17, v17, v97
v_add_f32 v18, v18, v98
v_add_f32 v19, v19, v99
v_add_f32 v20, v20, v100
v_add_f32 v21, v21, v101
v_add_f32 v22, v22, v102
v_add_f32 v23, v23, v103
v_add_f32 v24, v24, v104
v_add_f32 v25, v25, v105
v_add_f32 v26, v26, v106
v_add_f32 v27, v27, v107
v_add_f32 v28, v28, v108
v_add_f32 v29, v29, v109
v_add_f32 v30, v30, v110
v_add_f32 v31, v31, v111
s_waitcnt lgkmcnt(0)
v_add_f32 v16, v16, v112
v_add_f32 v17, v17, v113
v_add_f32 v18, v18, v114
v_add_f32 v19, v19, v115
v_add_f32 v20, v20, v116
v_add_f32 v21, v21, v117
v_add_f32 v22, v22, v118
v_add_f32 v23, v23, v119
v_add_f32 v24, v24, v120
v_add_f32 v25, v25, v121
v_add_f32 v26, v26, v122
v_add_f32 v27, v27, v123
v_add_f32 v28, v28, v124
v_add_f32 v29, v29, v125
v_add_f32 v30, v30, v126
v_add_f32 v31, v31, v127
v_cvt_pk_bf16_f32 v208, v16, v17
v_cvt_pk_bf16_f32 v209, v18, v19
v_cvt_pk_bf16_f32 v210, v20, v21
v_cvt_pk_bf16_f32 v211, v22, v23
v_cvt_pk_bf16_f32 v212, v24, v25
v_cvt_pk_bf16_f32 v213, v26, v27
v_cvt_pk_bf16_f32 v214, v28, v29
v_cvt_pk_bf16_f32 v215, v30, v31
s_add_u32 s25, s24, 2097152
buffer_store_dwordx4 v[208:211], v1, s[8:11], s25 offen offset:0 sc1
buffer_store_dwordx4 v[212:215], v1, s[8:11], s25 offen offset:1024 sc1
v_lshlrev_b32 v6, 3, v6
v_lshl_add_u32 v6, v7, 2, v6
s_mul_i32 s25, s44, 3584
s_lshl_b32 s26, s46, 8
s_add_u32 s25, s25, s26
s_add_u32 s25, s25, 29753344
s_mov_b32 s27, 0x3f803f80
v_mov_b32 v10, 0
v_mov_b32 v11, 0
v_dot2_f32_bf16 v10, v208, s27, v10
v_dot2_f32_bf16 v11, v208, v208, v11
v_dot2_f32_bf16 v10, v209, s27, v10
v_dot2_f32_bf16 v11, v209, v209, v11
v_dot2_f32_bf16 v10, v210, s27, v10
v_dot2_f32_bf16 v11, v210, v210, v11
v_dot2_f32_bf16 v10, v211, s27, v10
v_dot2_f32_bf16 v11, v211, v211, v11
v_dot2_f32_bf16 v10, v212, s27, v10
v_dot2_f32_bf16 v11, v212, v212, v11
v_dot2_f32_bf16 v10, v213, s27, v10
v_dot2_f32_bf16 v11, v213, v213, v11
v_dot2_f32_bf16 v10, v214, s27, v10
v_dot2_f32_bf16 v11, v214, v214, v11
v_dot2_f32_bf16 v10, v215, s27, v10
v_dot2_f32_bf16 v11, v215, v215, v11
s_nop 3
v_permlane32_swap_b32 v10, v11
s_nop 1
v_add_f32 v10, v10, v11
buffer_store_dword v10, v6, s[8:11], s25 offen sc1
s_lshl_b32 s13, s12, 7
s_add_u32 s13, s13, 30019584
s_waitcnt vmcnt(0)
s_barrier
s_cmp_lg_u32 s3, 0
s_cbranch_scc1 main_kernel_sg6
v_mov_b32 v4, 1
v_mov_b32 v5, 0
s_mov_b64 exec, 1
buffer_atomic_add v4, v5, s[8:11], s13 offen sc1
s_mov_b64 exec, -1
main_kernel_sg6:
main_kernel_ce00:
s_add_u32 s24, s53, 114688
s_mov_b32 m0, s24
s_add_u32 s25, s54, 114688
buffer_load_dwordx4 v1, s[8:11], s25 offen offset:0 lds
buffer_load_dwordx4 v1, s[8:11], s25 offen offset:1024 lds
buffer_load_dwordx4 v1, s[8:11], s25 offen offset:2048 lds
buffer_load_dwordx4 v1, s[8:11], s25 offen offset:3072 lds
s_add_u32 s24, s53, 118784
s_mov_b32 m0, s24
s_add_u32 s25, s54, 118784
buffer_load_dwordx4 v1, s[8:11], s25 offen offset:0 lds
buffer_load_dwordx4 v1, s[8:11], s25 offen offset:1024 lds
buffer_load_dwordx4 v1, s[8:11], s25 offen offset:2048 lds
s_mul_i32 s30, s49, 896
s_add_u32 s30, s30, 29425664
s_mov_b32 m0, 143360
s_nop 0
buffer_load_dwordx4 v1, s[8:11], s30 offen offset:0 lds
s_mul_i32 s21, s48, 28672
s_add_u32 s21, s21, 2097152
s_mul_i32 s27, s48, 3584
s_add_u32 s27, s27, 29753344
s_mul_i32 s28, s48, 112
s_mul_i32 s29, s49, 7
s_add_u32 s28, s28, s29
s_lshl_b32 s28, s28, 10
s_add_u32 s28, s28, 22020096
s_add_u32 s29, s28, 4096
v_lshrrev_b32 v13, 5, v0
v_lshlrev_b32 v13, 6, v13
v_add_u32 v13, 143360, v13
s_lshr_b32 s12, s48, 2
s_lshl_b32 s13, s12, 7
s_add_u32 s13, s13, 30019584
s_cmp_lg_u32 s3, 0
s_cbranch_scc1 main_kernel_wt7x
s_mov_b32 s60, 0
v_mov_b32 v5, 0
main_kernel_wt7:
buffer_load_dword v4, v5, s[8:11], s13 offen sc1
s_add_u32 s60, s60, 1
s_waitcnt vmcnt(0)
v_readfirstlane_b32 s61, v4
s_cmp_ge_u32 s61, 14
s_cbranch_scc1 main_kernel_wt7x
s_cmp_gt_u32 s60, 40000
s_cbranch_scc1 main_kernel_end
s_sleep 1
s_branch main_kernel_wt7
main_kernel_wt7x:
s_waitcnt vmcnt(0)
s_barrier
s_add_u32 s26, s21, 0
buffer_load_dwordx4 a[0:3], v1, s[8:11], s26 offen offset:0 sc1
buffer_load_dwordx4 a[4:7], v1, s[8:11], s26 offen offset:1024 sc1
buffer_load_dwordx4 a[8:11], v1, s[8:11], s26 offen offset:2048 sc1
buffer_load_dwordx4 a[12:15], v1, s[8:11], s26 offen offset:3072 sc1
s_add_u32 s26, s21, 4096
buffer_load_dwordx4 a[16:19], v1, s[8:11], s26 offen offset:0 sc1
buffer_load_dwordx4 a[20:23], v1, s[8:11], s26 offen offset:1024 sc1
buffer_load_dwordx4 a[24:27], v1, s[8:11], s26 offen offset:2048 sc1
buffer_load_dwordx4 a[28:31], v1, s[8:11], s26 offen offset:3072 sc1
s_add_u32 s26, s21, 8192
buffer_load_dwordx4 a[32:35], v1, s[8:11], s26 offen offset:0 sc1
buffer_load_dwordx4 a[36:39], v1, s[8:11], s26 offen offset:1024 sc1
buffer_load_dwordx4 a[40:43], v1, s[8:11], s26 offen offset:2048 sc1
buffer_load_dwordx4 a[44:47], v1, s[8:11], s26 offen offset:3072 sc1
s_add_u32 s26, s21, 12288
buffer_load_dwordx4 a[48:51], v1, s[8:11], s26 offen offset:0 sc1
buffer_load_dwordx4 a[52:55], v1, s[8:11], s26 offen offset:1024 sc1
buffer_load_dwordx4 a[56:59], v1, s[8:11], s26 offen offset:2048 sc1
buffer_load_dwordx4 a[60:63], v1, s[8:11], s26 offen offset:3072 sc1
ds_read_b128 v[128:131], v1 offset:0
ds_read_b128 v[132:135], v1 offset:1024
ds_read_b128 v[136:139], v1 offset:2048
ds_read_b128 v[140:143], v1 offset:3072
ds_read_b128 v[144:147], v1 offset:4096
ds_read_b128 v[148:151], v1 offset:5120
s_waitcnt vmcnt(12)
s_waitcnt lgkmcnt(3)
v_mfma_f32_32x32x16_bf16 v[16:31], v[128:131], a[0:3], 0
ds_read_b128 v[152:155], v1 offset:6144
ds_read_b128 v[156:159], v1 offset:7168
ds_read_b128 v[160:163], v1 offset:8192
s_add_u32 s26, s21, 16384
buffer_load_dwordx4 a[64:67], v1, s[8:11], s26 offen offset:0 sc1
v_mfma_f32_32x32x16_bf16 v[32:47], v[132:135], a[0:3], 0
v_mfma_f32_32x32x16_bf16 v[48:63], v[136:139], a[0:3], 0
buffer_load_dwordx4 a[68:71], v1, s[8:11], s26 offen offset:1024 sc1
s_waitcnt lgkmcnt(3)
v_mfma_f32_32x32x16_bf16 v[16:31], v[140:143], a[4:7], v[16:31]
ds_read_b128 v[128:131], v1 offset:9216
ds_read_b128 v[132:135], v1 offset:10240
ds_read_b128 v[136:139], v1 offset:11264
v_mfma_f32_32x32x16_bf16 v[32:47], v[144:147], a[4:7], v[32:47]
v_mfma_f32_32x32x16_bf16 v[48:63], v[148:151], a[4:7], v[48:63]
buffer_load_dwordx4 a[72:75], v1, s[8:11], s26 offen offset:2048 sc1
s_waitcnt lgkmcnt(3)
v_mfma_f32_32x32x16_bf16 v[16:31], v[152:155], a[8:11], v[16:31]
ds_read_b128 v[140:143], v1 offset:12288
ds_read_b128 v[144:147], v1 offset:13312
ds_read_b128 v[148:151], v1 offset:14336
v_mfma_f32_32x32x16_bf16 v[32:47], v[156:159], a[8:11], v[32:47]
v_mfma_f32_32x32x16_bf16 v[48:63], v[160:163], a[8:11], v[48:63]
buffer_load_dwordx4 a[76:79], v1, s[8:11], s26 offen offset:3072 sc1
s_waitcnt lgkmcnt(3)
v_mfma_f32_32x32x16_bf16 v[16:31], v[128:131], a[12:15], v[16:31]
ds_read_b128 v[152:155], v1 offset:15360
ds_read_b128 v[156:159], v1 offset:16384
ds_read_b128 v[160:163], v1 offset:17408
v_mfma_f32_32x32x16_bf16 v[32:47], v[132:135], a[12:15], v[32:47]
v_mfma_f32_32x32x16_bf16 v[48:63], v[136:139], a[12:15], v[48:63]
s_waitcnt vmcnt(12)
s_waitcnt lgkmcnt(3)
v_mfma_f32_32x32x16_bf16 v[16:31], v[140:143], a[16:19], v[16:31]
ds_read_b128 v[128:131], v1 offset:18432
ds_read_b128 v[132:135], v1 offset:19456
ds_read_b128 v[136:139], v1 offset:20480
s_add_u32 s26, s21, 20480
buffer_load_dwordx4 a[80:83], v1, s[8:11], s26 offen offset:0 sc1
v_mfma_f32_32x32x16_bf16 v[32:47], v[144:147], a[16:19], v[32:47]
v_mfma_f32_32x32x16_bf16 v[48:63], v[148:151], a[16:19], v[48:63]
buffer_load_dwordx4 a[84:87], v1, s[8:11], s26 offen offset:1024 sc1
s_waitcnt lgkmcnt(3)
v_mfma_f32_32x32x16_bf16 v[16:31], v[152:155], a[20:23], v[16:31]
ds_read_b128 v[140:143], v1 offset:21504
ds_read_b128 v[144:147], v1 offset:22528
ds_read_b128 v[148:151], v1 offset:23552
v_mfma_f32_32x32x16_bf16 v[32:47], v[156:159], a[20:23], v[32:47]
v_mfma_f32_32x32x16_bf16 v[48:63], v[160:163], a[20:23], v[48:63]
buffer_load_dwordx4 a[88:91], v1, s[8:11], s26 offen offset:2048 sc1
s_waitcnt lgkmcnt(3)
v_mfma_f32_32x32x16_bf16 v[16:31], v[128:131], a[24:27], v[16:31]
ds_read_b128 v[152:155], v1 offset:24576
ds_read_b128 v[156:159], v1 offset:25600
ds_read_b128 v[160:163], v1 offset:26624
v_mfma_f32_32x32x16_bf16 v[32:47], v[132:135], a[24:27], v[32:47]
v_mfma_f32_32x32x16_bf16 v[48:63], v[136:139], a[24:27], v[48:63]
buffer_load_dwordx4 a[92:95], v1, s[8:11], s26 offen offset:3072 sc1
s_waitcnt lgkmcnt(3)
v_mfma_f32_32x32x16_bf16 v[16:31], v[140:143], a[28:31], v[16:31]
ds_read_b128 v[128:131], v1 offset:27648
ds_read_b128 v[132:135], v1 offset:28672
ds_read_b128 v[136:139], v1 offset:29696
v_mfma_f32_32x32x16_bf16 v[32:47], v[144:147], a[28:31], v[32:47]
v_mfma_f32_32x32x16_bf16 v[48:63], v[148:151], a[28:31], v[48:63]
s_waitcnt vmcnt(12)
s_waitcnt lgkmcnt(3)
v_mfma_f32_32x32x16_bf16 v[16:31], v[152:155], a[32:35], v[16:31]
ds_read_b128 v[140:143], v1 offset:30720
ds_read_b128 v[144:147], v1 offset:31744
ds_read_b128 v[148:151], v1 offset:32768
s_add_u32 s26, s21, 24576
buffer_load_dwordx4 a[96:99], v1, s[8:11], s26 offen offset:0 sc1
v_mfma_f32_32x32x16_bf16 v[32:47], v[156:159], a[32:35], v[32:47]
v_mfma_f32_32x32x16_bf16 v[48:63], v[160:163], a[32:35], v[48:63]
buffer_load_dwordx4 a[100:103], v1, s[8:11], s26 offen offset:1024 sc1
s_waitcnt lgkmcnt(3)
v_mfma_f32_32x32x16_bf16 v[16:31], v[128:131], a[36:39], v[16:31]
ds_read_b128 v[152:155], v1 offset:33792
ds_read_b128 v[156:159], v1 offset:34816
ds_read_b128 v[160:163], v1 offset:35840
v_mfma_f32_32x32x16_bf16 v[32:47], v[132:135], a[36:39], v[32:47]
v_mfma_f32_32x32x16_bf16 v[48:63], v[136:139], a[36:39], v[48:63]
buffer_load_dwordx4 a[104:107], v1, s[8:11], s26 offen offset:2048 sc1
s_waitcnt lgkmcnt(3)
v_mfma_f32_32x32x16_bf16 v[16:31], v[140:143], a[40:43], v[16:31]
ds_read_b128 v[128:131], v1 offset:36864
ds_read_b128 v[132:135], v1 offset:37888
ds_read_b128 v[136:139], v1 offset:38912
v_mfma_f32_32x32x16_bf16 v[32:47], v[144:147], a[40:43], v[32:47]
v_mfma_f32_32x32x16_bf16 v[48:63], v[148:151], a[40:43], v[48:63]
buffer_load_dwordx4 a[108:111], v1, s[8:11], s26 offen offset:3072 sc1
s_waitcnt lgkmcnt(3)
v_mfma_f32_32x32x16_bf16 v[16:31], v[152:155], a[44:47], v[16:31]
ds_read_b128 v[140:143], v1 offset:39936
ds_read_b128 v[144:147], v1 offset:40960
ds_read_b128 v[148:151], v1 offset:41984
v_mfma_f32_32x32x16_bf16 v[32:47], v[156:159], a[44:47], v[32:47]
v_mfma_f32_32x32x16_bf16 v[48:63], v[160:163], a[44:47], v[48:63]
s_waitcnt vmcnt(12)
s_waitcnt lgkmcnt(3)
v_mfma_f32_32x32x16_bf16 v[16:31], v[128:131], a[48:51], v[16:31]
ds_read_b128 v[152:155], v1 offset:43008
ds_read_b128 v[156:159], v1 offset:44032
ds_read_b128 v[160:163], v1 offset:45056
v_and_b32 v4, 31, v0
v_lshlrev_b32 v4, 3, v4
v_lshrrev_b32 v5, 5, v0
v_mul_u32_u24 v5, 1792, v5
v_add_u32 v4, v4, v5
buffer_load_dwordx2 v[164:165], v4, s[8:11], s27 offen offset:0 sc1
buffer_load_dwordx2 v[166:167], v4, s[8:11], s27 offen offset:256 sc1
buffer_load_dwordx2 v[168:169], v4, s[8:11], s27 offen offset:512 sc1
buffer_load_dwordx2 v[170:171], v4, s[8:11], s27 offen offset:768 sc1
buffer_load_dwordx2 v[172:173], v4, s[8:11], s27 offen offset:1024 sc1
buffer_load_dwordx2 v[174:175], v4, s[8:11], s27 offen offset:1280 sc1
buffer_load_dwordx2 v[176:177], v4, s[8:11], s27 offen offset:1536 sc1
v_mfma_f32_32x32x16_bf16 v[32:47], v[132:135], a[48:51], v[32:47]
v_mfma_f32_32x32x16_bf16 v[48:63], v[136:139], a[48:51], v[48:63]
s_waitcnt lgkmcnt(3)
v_mfma_f32_32x32x16_bf16 v[16:31], v[140:143], a[52:55], v[16:31]
ds_read_b128 v[128:131], v1 offset:46080
ds_read_b128 v[132:135], v1 offset:47104
ds_read_b128 v[136:139], v1 offset:48128
v_mfma_f32_32x32x16_bf16 v[32:47], v[144:147], a[52:55], v[32:47]
v_mfma_f32_32x32x16_bf16 v[48:63], v[148:151], a[52:55], v[48:63]
s_waitcnt lgkmcnt(3)
v_mfma_f32_32x32x16_bf16 v[16:31], v[152:155], a[56:59], v[16:31]
ds_read_b128 v[140:143], v1 offset:49152
ds_read_b128 v[144:147], v1 offset:50176
ds_read_b128 v[148:151], v1 offset:51200
v_mfma_f32_32x32x16_bf16 v[32:47], v[156:159], a[56:59], v[32:47]
v_mfma_f32_32x32x16_bf16 v[48:63], v[160:163], a[56:59], v[48:63]
s_waitcnt lgkmcnt(3)
v_mfma_f32_32x32x16_bf16 v[16:31], v[128:131], a[60:63], v[16:31]
ds_read_b128 v[152:155], v1 offset:52224
ds_read_b128 v[156:159], v1 offset:53248
ds_read_b128 v[160:163], v1 offset:54272
v_mfma_f32_32x32x16_bf16 v[32:47], v[132:135], a[60:63], v[32:47]
v_mfma_f32_32x32x16_bf16 v[48:63], v[136:139], a[60:63], v[48:63]
s_waitcnt vmcnt(15)
s_waitcnt lgkmcnt(3)
v_mfma_f32_32x32x16_bf16 v[16:31], v[140:143], a[64:67], v[16:31]
ds_read_b128 v[128:131], v1 offset:55296
ds_read_b128 v[132:135], v1 offset:56320
ds_read_b128 v[136:139], v1 offset:57344
v_mfma_f32_32x32x16_bf16 v[32:47], v[144:147], a[64:67], v[32:47]
v_mfma_f32_32x32x16_bf16 v[48:63], v[148:151], a[64:67], v[48:63]
s_waitcnt lgkmcnt(3)
v_mfma_f32_32x32x16_bf16 v[16:31], v[152:155], a[68:71], v[16:31]
ds_read_b128 v[140:143], v1 offset:58368
ds_read_b128 v[144:147], v1 offset:59392
ds_read_b128 v[148:151], v1 offset:60416
v_mfma_f32_32x32x16_bf16 v[32:47], v[156:159], a[68:71], v[32:47]
v_mfma_f32_32x32x16_bf16 v[48:63], v[160:163], a[68:71], v[48:63]
s_waitcnt lgkmcnt(3)
v_mfma_f32_32x32x16_bf16 v[16:31], v[128:131], a[72:75], v[16:31]
ds_read_b128 v[152:155], v1 offset:61440
ds_read_b128 v[156:159], v1 offset:62464
ds_read_b128 v[160:163], v1 offset:63488
v_mfma_f32_32x32x16_bf16 v[32:47], v[132:135], a[72:75], v[32:47]
v_mfma_f32_32x32x16_bf16 v[48:63], v[136:139], a[72:75], v[48:63]
s_waitcnt lgkmcnt(3)
v_mfma_f32_32x32x16_bf16 v[16:31], v[140:143], a[76:79], v[16:31]
ds_read_b128 v[128:131], v1 offset:64512
ds_read_b128 v[132:135], v2 offset:0
ds_read_b128 v[136:139], v2 offset:1024
v_mfma_f32_32x32x16_bf16 v[32:47], v[144:147], a[76:79], v[32:47]
v_mfma_f32_32x32x16_bf16 v[48:63], v[148:151], a[76:79], v[48:63]
s_waitcnt vmcnt(11)
s_waitcnt lgkmcnt(3)
v_mfma_f32_32x32x16_bf16 v[16:31], v[152:155], a[80:83], v[16:31]
ds_read_b128 v[140:143], v2 offset:2048
ds_read_b128 v[144:147], v2 offset:3072
ds_read_b128 v[148:151], v2 offset:4096
v_mfma_f32_32x32x16_bf16 v[32:47], v[156:159], a[80:83], v[32:47]
v_mfma_f32_32x32x16_bf16 v[48:63], v[160:163], a[80:83], v[48:63]
s_waitcnt lgkmcnt(3)
v_mfma_f32_32x32x16_bf16 v[16:31], v[128:131], a[84:87], v[16:31]
ds_read_b128 v[152:155], v2 offset:5120
ds_read_b128 v[156:159], v2 offset:6144
ds_read_b128 v[160:163], v2 offset:7168
v_mfma_f32_32x32x16_bf16 v[32:47], v[132:135], a[84:87], v[32:47]
v_mfma_f32_32x32x16_bf16 v[48:63], v[136:139], a[84:87], v[48:63]
s_waitcnt lgkmcnt(3)
v_mfma_f32_32x32x16_bf16 v[16:31], v[140:143], a[88:91], v[16:31]
ds_read_b128 v[128:131], v2 offset:8192
ds_read_b128 v[132:135], v2 offset:9216
ds_read_b128 v[136:139], v2 offset:10240
v_mfma_f32_32x32x16_bf16 v[32:47], v[144:147], a[88:91], v[32:47]
v_mfma_f32_32x32x16_bf16 v[48:63], v[148:151], a[88:91], v[48:63]
s_waitcnt lgkmcnt(3)
v_mfma_f32_32x32x16_bf16 v[16:31], v[152:155], a[92:95], v[16:31]
ds_read_b128 v[140:143], v2 offset:11264
ds_read_b128 v[144:147], v2 offset:12288
ds_read_b128 v[148:151], v2 offset:13312
v_mfma_f32_32x32x16_bf16 v[32:47], v[156:159], a[92:95], v[32:47]
v_mfma_f32_32x32x16_bf16 v[48:63], v[160:163], a[92:95], v[48:63]
s_waitcnt vmcnt(7)
s_waitcnt lgkmcnt(3)
v_mfma_f32_32x32x16_bf16 v[16:31], v[128:131], a[96:99], v[16:31]
ds_read_b128 v[152:155], v2 offset:14336
ds_read_b128 v[156:159], v2 offset:15360
ds_read_b128 v[160:163], v2 offset:16384
v_mfma_f32_32x32x16_bf16 v[32:47], v[132:135], a[96:99], v[32:47]
v_mfma_f32_32x32x16_bf16 v[48:63], v[136:139], a[96:99], v[48:63]
s_waitcnt lgkmcnt(3)
v_mfma_f32_32x32x16_bf16 v[16:31], v[140:143], a[100:103], v[16:31]
ds_read_b128 v[128:131], v2 offset:17408
ds_read_b128 v[132:135], v2 offset:18432
ds_read_b128 v[136:139], v2 offset:19456
v_mfma_f32_32x32x16_bf16 v[32:47], v[144:147], a[100:103], v[32:47]
v_mfma_f32_32x32x16_bf16 v[48:63], v[148:151], a[100:103], v[48:63]
s_waitcnt lgkmcnt(3)
v_mfma_f32_32x32x16_bf16 v[16:31], v[152:155], a[104:107], v[16:31]
v_mfma_f32_32x32x16_bf16 v[32:47], v[156:159], a[104:107], v[32:47]
v_mfma_f32_32x32x16_bf16 v[48:63], v[160:163], a[104:107], v[48:63]
s_waitcnt lgkmcnt(0)
v_mfma_f32_32x32x16_bf16 v[16:31], v[128:131], a[108:111], v[16:31]
s_barrier
ds_read_b128 v[140:143], v2 offset:20480
ds_read_b128 v[144:147], v2 offset:21504
ds_read_b128 v[148:151], v2 offset:22528
ds_read_b128 v[152:155], v2 offset:23552
v_mfma_f32_32x32x16_bf16 v[32:47], v[132:135], a[108:111], v[32:47]
v_mfma_f32_32x32x16_bf16 v[48:63], v[136:139], a[108:111], v[48:63]
s_waitcnt vmcnt(0)
s_waitcnt lgkmcnt(3)
v_mfma_f32_32x32x16_bf16 v[64:79], v[140:143], a[0:3], 0
ds_read_b128 v[156:159], v2 offset:24576
v_add_f32 v164, v164, v166
v_add_f32 v165, v165, v167
v_add_f32 v164, v164, v168
v_add_f32 v165, v165, v169
v_add_f32 v164, v164, v170
s_waitcnt lgkmcnt(3)
v_mfma_f32_32x32x16_bf16 v[64:79], v[144:147], a[4:7], v[64:79]
ds_read_b128 v[160:163], v2 offset:25600
s_add_u32 s24, s53, 0
s_mov_b32 m0, s24
s_add_u32 s25, s54, 143360
buffer_load_dwordx4 v1, s[8:11], s25 offen offset:0 lds
s_waitcnt lgkmcnt(3)
v_mfma_f32_32x32x16_bf16 v[64:79], v[148:151], a[8:11], v[64:79]
ds_read_b128 v[128:131], v2 offset:26624
v_add_f32 v165, v165, v171
v_add_f32 v164, v164, v172
v_add_f32 v165, v165, v173
v_add_f32 v164, v164, v174
v_add_f32 v165, v165, v175
v_add_f32 v164, v164, v176
s_waitcnt lgkmcnt(3)
v_mfma_f32_32x32x16_bf16 v[64:79], v[152:155], a[12:15], v[64:79]
ds_read_b128 v[132:135], v2 offset:27648
v_add_f32 v165, v165, v177
v_mov_b32 v166, v164
v_mov_b32 v167, v165
s_nop 1
v_permlane32_swap_b32 v164, v166
s_waitcnt lgkmcnt(3)
v_mfma_f32_32x32x16_bf16 v[64:79], v[156:159], a[16:19], v[64:79]
ds_read_b128 v[136:139], v2 offset:28672
buffer_load_dwordx4 v1, s[8:11], s25 offen offset:1024 lds
s_waitcnt lgkmcnt(3)
v_mfma_f32_32x32x16_bf16 v[64:79], v[160:163], a[20:23], v[64:79]
ds_read_b128 v[140:143], v2 offset:29696
v_permlane32_swap_b32 v165, v167
s_nop 1
v_add_f32 v164, v164, v166
v_add_f32 v165, v165, v167
v_mul_f32 v10, 0x3b124925, v164
v_mul_f32 v165, 0x3b124925, v165
s_waitcnt lgkmcnt(3)
v_mfma_f32_32x32x16_bf16 v[64:79], v[128:131], a[24:27], v[64:79]
ds_read_b128 v[144:147], v2 offset:30720
v_fma_f32 v165, -v10, v10, v165
v_max_f32 v165, 0, v165
v_add_f32 v165, 0x3727c5ac, v165
v_rsq_f32 v9, v165
s_nop 0
s_waitcnt lgkmcnt(3)
v_mfma_f32_32x32x16_bf16 v[64:79], v[132:135], a[28:31], v[64:79]
ds_read_b128 v[148:151], v2 offset:31744
buffer_load_dwordx4 v1, s[8:11], s25 offen offset:2048 lds
s_waitcnt lgkmcnt(3)
v_mfma_f32_32x32x16_bf16 v[64:79], v[136:139], a[32:35], v[64:79]
ds_read_b128 v[152:155], v2 offset:32768
v_sqrt_f32 v12, v165
v_mul_f32 v11, 0xbfb8aa3b, v9
ds_read_b128 v[180:183], v13 offset:0
ds_read_b128 v[184:187], v13 offset:16
ds_read_b128 v[188:191], v13 offset:32
ds_read_b128 v[192:195], v13 offset:48
s_waitcnt lgkmcnt(0)
v_mfma_f32_32x32x16_bf16 v[64:79], v[140:143], a[36:39], v[64:79]
ds_read_b128 v[156:159], v2 offset:33792
v_fma_f32 v16, -v10, v180, v16
v_fma_f32 v17, -v10, v181, v17
v_fma_f32 v18, -v10, v182, v18
v_fma_f32 v19, -v10, v183, v19
v_mul_f32 v16, v16, v11
v_mfma_f32_32x32x16_bf16 v[64:79], v[144:147], a[40:43], v[64:79]
ds_read_b128 v[160:163], v2 offset:34816
buffer_load_dwordx4 v1, s[8:11], s25 offen offset:3072 lds
v_mfma_f32_32x32x16_bf16 v[64:79], v[148:151], a[44:47], v[64:79]
ds_read_b128 v[128:131], v2 offset:35840
v_mul_f32 v17, v17, v11
v_mul_f32 v18, v18, v11
v_mul_f32 v19, v19, v11
ds_read_b128 v[196:199], v13 offset:128
ds_read_b128 v[200:203], v13 offset:144
ds_read_b128 v[204:207], v13 offset:160
v_mfma_f32_32x32x16_bf16 v[64:79], v[152:155], a[48:51], v[64:79]
ds_read_b128 v[132:135], v2 offset:36864
ds_read_b128 v[208:211], v13 offset:176
v_exp_f32 v16, v16
v_fma_f32 v24, -v10, v188, v24
s_waitcnt lgkmcnt(7)
v_mfma_f32_32x32x16_bf16 v[64:79], v[156:159], a[52:55], v[64:79]
ds_read_b128 v[136:139], v2 offset:37888
s_add_u32 s24, s53, 4096
s_mov_b32 m0, s24
s_add_u32 s25, s54, 147456
buffer_load_dwordx4 v1, s[8:11], s25 offen offset:0 lds
s_waitcnt lgkmcnt(7)
v_mfma_f32_32x32x16_bf16 v[64:79], v[160:163], a[56:59], v[64:79]
ds_read_b128 v[140:143], v2 offset:38912
v_exp_f32 v17, v17
v_fma_f32 v25, -v10, v189, v25
v_exp_f32 v18, v18
v_fma_f32 v26, -v10, v190, v26
s_waitcnt lgkmcnt(7)
v_mfma_f32_32x32x16_bf16 v[64:79], v[128:131], a[60:63], v[64:79]
ds_read_b128 v[144:147], v2 offset:39936
v_exp_f32 v19, v19
v_fma_f32 v27, -v10, v191, v27
v_fma_f32 v16, v16, v12, v12
v_fma_f32 v17, v17, v12, v12
v_fma_f32 v18, v18, v12, v12
s_waitcnt lgkmcnt(4)
v_mfma_f32_32x32x16_bf16 v[64:79], v[132:135], a[64:67], v[64:79]
ds_read_b128 v[148:151], v2 offset:40960
buffer_load_dwordx4 v1, s[8:11], s25 offen offset:1024 lds
s_waitcnt lgkmcnt(3)
v_mfma_f32_32x32x16_bf16 v[64:79], v[136:139], a[68:71], v[64:79]
ds_read_b128 v[152:155], v2 offset:41984
v_fma_f32 v19, v19, v12, v12
v_rcp_f32 v16, v16
v_rcp_f32 v17, v17
s_waitcnt lgkmcnt(3)
v_mfma_f32_32x32x16_bf16 v[64:79], v[140:143], a[72:75], v[64:79]
ds_read_b128 v[156:159], v2 offset:43008
v_rcp_f32 v18, v18
v_rcp_f32 v19, v19
v_mul_f32 v16, v16, v24
v_mul_f32 v17, v17, v25
s_waitcnt lgkmcnt(3)
v_mfma_f32_32x32x16_bf16 v[64:79], v[144:147], a[76:79], v[64:79]
ds_read_b128 v[160:163], v2 offset:44032
buffer_load_dwordx4 v1, s[8:11], s25 offen offset:2048 lds
s_waitcnt lgkmcnt(3)
v_mfma_f32_32x32x16_bf16 v[64:79], v[148:151], a[80:83], v[64:79]
ds_read_b128 v[128:131], v2 offset:45056
v_mul_f32 v18, v18, v26
v_mul_f32 v19, v19, v27
v_fma_f32 v20, -v10, v184, v20
v_fma_f32 v21, -v10, v185, v21
v_fma_f32 v22, -v10, v186, v22
s_waitcnt lgkmcnt(3)
v_mfma_f32_32x32x16_bf16 v[64:79], v[152:155], a[84:87], v[64:79]
ds_read_b128 v[132:135], v2 offset:46080
v_fma_f32 v23, -v10, v187, v23
v_mul_f32 v20, v20, v11
v_mul_f32 v21, v21, v11
v_mul_f32 v22, v22, v11
v_mul_f32 v23, v23, v11
s_waitcnt lgkmcnt(3)
v_mfma_f32_32x32x16_bf16 v[64:79], v[156:159], a[88:91], v[64:79]
ds_read_b128 v[136:139], v2 offset:47104
v_exp_f32 v20, v20
v_fma_f32 v28, -v10, v192, v28
v_exp_f32 v21, v21
v_fma_f32 v29, -v10, v193, v29
s_waitcnt lgkmcnt(3)
v_mfma_f32_32x32x16_bf16 v[64:79], v[160:163], a[92:95], v[64:79]
ds_read_b128 v[140:143], v2 offset:48128
v_exp_f32 v22, v22
v_fma_f32 v30, -v10, v194, v30
v_exp_f32 v23, v23
v_fma_f32 v31, -v10, v195, v31
s_waitcnt lgkmcnt(3)
v_mfma_f32_32x32x16_bf16 v[64:79], v[128:131], a[96:99], v[64:79]
ds_read_b128 v[144:147], v2 offset:49152
v_fma_f32 v20, v20, v12, v12
v_fma_f32 v21, v21, v12, v12
v_fma_f32 v22, v22, v12, v12
v_fma_f32 v23, v23, v12, v12
s_waitcnt lgkmcnt(3)
v_mfma_f32_32x32x16_bf16 v[64:79], v[132:135], a[100:103], v[64:79]
ds_read_b128 v[148:151], v2 offset:50176
v_rcp_f32 v20, v20
v_rcp_f32 v21, v21
v_rcp_f32 v22, v22
s_waitcnt lgkmcnt(3)
v_mfma_f32_32x32x16_bf16 v[64:79], v[136:139], a[104:107], v[64:79]
ds_read_b128 v[152:155], v2 offset:51200
v_rcp_f32 v23, v23
v_mul_f32 v20, v20, v28
v_mul_f32 v21, v21, v29
v_mul_f32 v22, v22, v30
v_mul_f32 v23, v23, v31
s_waitcnt lgkmcnt(3)
v_mfma_f32_32x32x16_bf16 v[64:79], v[140:143], a[108:111], v[64:79]
ds_read_b128 v[156:159], v2 offset:52224
v_cvt_pk_bf16_f32 v212, v16, v17
v_cvt_pk_bf16_f32 v213, v18, v19
v_cvt_pk_bf16_f32 v214, v20, v21
v_cvt_pk_bf16_f32 v215, v22, v23
s_waitcnt lgkmcnt(3)
v_mfma_f32_32x32x16_bf16 v[80:95], v[144:147], a[0:3], 0
ds_read_b128 v[160:163], v2 offset:53248
buffer_store_dwordx4 v[212:215], v1, s[8:11], s28 offen offset:0 sc1
v_fma_f32 v32, -v10, v196, v32
v_fma_f32 v33, -v10, v197, v33
v_fma_f32 v34, -v10, v198, v34
v_fma_f32 v35, -v10, v199, v35
s_waitcnt lgkmcnt(3)
v_mfma_f32_32x32x16_bf16 v[80:95], v[148:151], a[4:7], v[80:95]
ds_read_b128 v[128:131], v2 offset:54272
s_add_u32 s24, s53, 28672
s_mov_b32 m0, s24
s_add_u32 s25, s54, 172032
buffer_load_dwordx4 v1, s[8:11], s25 offen offset:0 lds
s_waitcnt lgkmcnt(3)
v_mfma_f32_32x32x16_bf16 v[80:95], v[152:155], a[8:11], v[80:95]
ds_read_b128 v[132:135], v2 offset:55296
v_mul_f32 v32, v32, v11
v_mul_f32 v33, v33, v11
v_mul_f32 v34, v34, v11
v_mul_f32 v35, v35, v11
ds_read_b128 v[180:183], v13 offset:256
ds_read_b128 v[184:187], v13 offset:272
s_waitcnt lgkmcnt(5)
v_mfma_f32_32x32x16_bf16 v[80:95], v[156:159], a[12:15], v[80:95]
ds_read_b128 v[136:139], v2 offset:56320
ds_read_b128 v[188:191], v13 offset:288
ds_read_b128 v[192:195], v13 offset:304
v_exp_f32 v32, v32
v_fma_f32 v40, -v10, v204, v40
s_waitcnt lgkmcnt(7)
v_mfma_f32_32x32x16_bf16 v[80:95], v[160:163], a[16:19], v[80:95]
ds_read_b128 v[140:143], v2 offset:57344
buffer_load_dwordx4 v1, s[8:11], s25 offen offset:1024 lds
s_waitcnt lgkmcnt(7)
v_mfma_f32_32x32x16_bf16 v[80:95], v[128:131], a[20:23], v[80:95]
ds_read_b128 v[144:147], v2 offset:58368
v_exp_f32 v33, v33
v_fma_f32 v41, -v10, v205, v41
v_exp_f32 v34, v34
v_fma_f32 v42, -v10, v206, v42
s_waitcnt lgkmcnt(7)
v_mfma_f32_32x32x16_bf16 v[80:95], v[132:135], a[24:27], v[80:95]
ds_read_b128 v[148:151], v2 offset:59392
v_exp_f32 v35, v35
v_fma_f32 v43, -v10, v207, v43
v_fma_f32 v32, v32, v12, v12
v_fma_f32 v33, v33, v12, v12
s_waitcnt lgkmcnt(5)
v_mfma_f32_32x32x16_bf16 v[80:95], v[136:139], a[28:31], v[80:95]
ds_read_b128 v[152:155], v2 offset:60416
buffer_load_dwordx4 v1, s[8:11], s25 offen offset:2048 lds
s_waitcnt lgkmcnt(3)
v_mfma_f32_32x32x16_bf16 v[80:95], v[140:143], a[32:35], v[80:95]
ds_read_b128 v[156:159], v2 offset:61440
v_fma_f32 v34, v34, v12, v12
v_fma_f32 v35, v35, v12, v12
v_rcp_f32 v32, v32
v_rcp_f32 v33, v33
s_waitcnt lgkmcnt(3)
v_mfma_f32_32x32x16_bf16 v[80:95], v[144:147], a[36:39], v[80:95]
ds_read_b128 v[160:163], v2 offset:62464
v_rcp_f32 v34, v34
v_rcp_f32 v35, v35
v_mul_f32 v32, v32, v40
s_waitcnt lgkmcnt(3)
v_mfma_f32_32x32x16_bf16 v[80:95], v[148:151], a[40:43], v[80:95]
ds_read_b128 v[128:131], v2 offset:63488
buffer_load_dwordx4 v1, s[8:11], s25 offen offset:3072 lds
s_waitcnt lgkmcnt(3)
v_mfma_f32_32x32x16_bf16 v[80:95], v[152:155], a[44:47], v[80:95]
ds_read_b128 v[132:135], v2 offset:64512
v_mul_f32 v33, v33, v41
v_mul_f32 v34, v34, v42
v_mul_f32 v35, v35, v43
v_fma_f32 v36, -v10, v200, v36
v_fma_f32 v37, -v10, v201, v37
v_fma_f32 v38, -v10, v202, v38
s_waitcnt lgkmcnt(3)
v_mfma_f32_32x32x16_bf16 v[80:95], v[156:159], a[48:51], v[80:95]
ds_read_b128 v[136:139], v3 offset:0
v_fma_f32 v39, -v10, v203, v39
v_mul_f32 v36, v36, v11
v_mul_f32 v37, v37, v11
v_mul_f32 v38, v38, v11
v_mul_f32 v39, v39, v11
s_waitcnt lgkmcnt(3)
v_mfma_f32_32x32x16_bf16 v[80:95], v[160:163], a[52:55], v[80:95]
ds_read_b128 v[140:143], v3 offset:1024
s_add_u32 s24, s53, 32768
s_mov_b32 m0, s24
s_add_u32 s25, s54, 176128
buffer_load_dwordx4 v1, s[8:11], s25 offen offset:0 lds
s_waitcnt lgkmcnt(3)
v_mfma_f32_32x32x16_bf16 v[80:95], v[128:131], a[56:59], v[80:95]
ds_read_b128 v[144:147], v3 offset:2048
v_exp_f32 v36, v36
v_fma_f32 v44, -v10, v208, v44
v_exp_f32 v37, v37
v_fma_f32 v45, -v10, v209, v45
s_waitcnt lgkmcnt(3)
v_mfma_f32_32x32x16_bf16 v[80:95], v[132:135], a[60:63], v[80:95]
ds_read_b128 v[148:151], v3 offset:3072
v_exp_f32 v38, v38
v_fma_f32 v46, -v10, v210, v46
v_exp_f32 v39, v39
s_waitcnt lgkmcnt(3)
v_mfma_f32_32x32x16_bf16 v[80:95], v[136:139], a[64:67], v[80:95]
ds_read_b128 v[152:155], v3 offset:4096
buffer_load_dwordx4 v1, s[8:11], s25 offen offset:1024 lds
s_waitcnt lgkmcnt(3)
v_mfma_f32_32x32x16_bf16 v[80:95], v[140:143], a[68:71], v[80:95]
ds_read_b128 v[156:159], v3 offset:5120
v_fma_f32 v47, -v10, v211, v47
v_fma_f32 v36, v36, v12, v12
v_fma_f32 v37, v37, v12, v12
v_fma_f32 v38, v38, v12, v12
v_fma_f32 v39, v39, v12, v12
s_waitcnt lgkmcnt(3)
v_mfma_f32_32x32x16_bf16 v[80:95], v[144:147], a[72:75], v[80:95]
ds_read_b128 v[160:163], v3 offset:6144
v_rcp_f32 v36, v36
v_rcp_f32 v37, v37
v_rcp_f32 v38, v38
s_waitcnt lgkmcnt(3)
v_mfma_f32_32x32x16_bf16 v[80:95], v[148:151], a[76:79], v[80:95]
ds_read_b128 v[128:131], v3 offset:7168
buffer_load_dwordx4 v1, s[8:11], s25 offen offset:2048 lds
s_waitcnt lgkmcnt(3)
v_mfma_f32_32x32x16_bf16 v[80:95], v[152:155], a[80:83], v[80:95]
ds_read_b128 v[132:135], v3 offset:8192
v_rcp_f32 v39, v39
v_mul_f32 v36, v36, v44
v_mul_f32 v37, v37, v45
v_mul_f32 v38, v38, v46
v_mul_f32 v39, v39, v47
s_waitcnt lgkmcnt(3)
v_mfma_f32_32x32x16_bf16 v[80:95], v[156:159], a[84:87], v[80:95]
ds_read_b128 v[136:139], v3 offset:9216
v_cvt_pk_bf16_f32 v216, v32, v33
v_cvt_pk_bf16_f32 v217, v34, v35
v_cvt_pk_bf16_f32 v218, v36, v37
v_cvt_pk_bf16_f32 v219, v38, v39
s_waitcnt lgkmcnt(3)
v_mfma_f32_32x32x16_bf16 v[80:95], v[160:163], a[88:91], v[80:95]
ds_read_b128 v[140:143], v3 offset:10240
buffer_store_dwordx4 v[216:219], v1, s[8:11], s28 offen offset:1024 sc1
v_fma_f32 v48, -v10, v180, v48
v_fma_f32 v49, -v10, v181, v49
v_fma_f32 v50, -v10, v182, v50
v_fma_f32 v51, -v10, v183, v51
s_waitcnt lgkmcnt(3)
v_mfma_f32_32x32x16_bf16 v[80:95], v[128:131], a[92:95], v[80:95]
ds_read_b128 v[144:147], v3 offset:11264
v_mul_f32 v48, v48, v11
v_mul_f32 v49, v49, v11
v_mul_f32 v50, v50, v11
v_mul_f32 v51, v51, v11
ds_read_b128 v[196:199], v13 offset:384
ds_read_b128 v[200:203], v13 offset:400
s_waitcnt lgkmcnt(5)
v_mfma_f32_32x32x16_bf16 v[80:95], v[132:135], a[96:99], v[80:95]
s_waitcnt vmcnt(9)
s_barrier
ds_read_b128 v[148:151], v1 offset:0
ds_read_b128 v[204:207], v13 offset:416
ds_read_b128 v[208:211], v13 offset:432
v_exp_f32 v48, v48
v_fma_f32 v56, -v10, v188, v56
s_waitcnt lgkmcnt(7)
v_mfma_f32_32x32x16_bf16 v[80:95], v[136:139], a[100:103], v[80:95]
ds_read_b128 v[152:155], v1 offset:1024
v_exp_f32 v49, v49
v_fma_f32 v57, -v10, v189, v57
v_exp_f32 v50, v50
v_fma_f32 v58, -v10, v190, v58
s_waitcnt lgkmcnt(7)
v_mfma_f32_32x32x16_bf16 v[80:95], v[140:143], a[104:107], v[80:95]
ds_read_b128 v[156:159], v1 offset:2048
v_exp_f32 v51, v51
v_fma_f32 v59, -v10, v191, v59
v_fma_f32 v48, v48, v12, v12
v_fma_f32 v49, v49, v12, v12
s_waitcnt lgkmcnt(7)
v_mfma_f32_32x32x16_bf16 v[80:95], v[144:147], a[108:111], v[80:95]
ds_read_b128 v[160:163], v1 offset:3072
v_fma_f32 v50, v50, v12, v12
v_fma_f32 v51, v51, v12, v12
v_rcp_f32 v48, v48
v_rcp_f32 v49, v49
s_waitcnt lgkmcnt(5)
v_mfma_f32_32x32x16_bf16 v[96:111], v[148:151], a[0:3], 0
ds_read_b128 v[128:131], v1 offset:4096
v_rcp_f32 v50, v50
v_rcp_f32 v51, v51
v_mul_f32 v48, v48, v56
s_waitcnt lgkmcnt(3)
v_mfma_f32_32x32x16_bf16 v[96:111], v[152:155], a[4:7], v[96:111]
ds_read_b128 v[132:135], v1 offset:5120
v_mul_f32 v49, v49, v57
v_mul_f32 v50, v50, v58
v_mul_f32 v51, v51, v59
v_fma_f32 v52, -v10, v184, v52
v_fma_f32 v53, -v10, v185, v53
v_fma_f32 v54, -v10, v186, v54
s_waitcnt lgkmcnt(3)
v_mfma_f32_32x32x16_bf16 v[96:111], v[156:159], a[8:11], v[96:111]
ds_read_b128 v[136:139], v1 offset:6144
v_fma_f32 v55, -v10, v187, v55
v_mul_f32 v52, v52, v11
v_mul_f32 v53, v53, v11
v_mul_f32 v54, v54, v11
v_mul_f32 v55, v55, v11
s_waitcnt lgkmcnt(3)
v_mfma_f32_32x32x16_bf16 v[96:111], v[160:163], a[12:15], v[96:111]
ds_read_b128 v[140:143], v1 offset:7168
v_exp_f32 v52, v52
v_fma_f32 v60, -v10, v192, v60
v_exp_f32 v53, v53
v_fma_f32 v61, -v10, v193, v61
s_waitcnt lgkmcnt(3)
v_mfma_f32_32x32x16_bf16 v[96:111], v[128:131], a[16:19], v[96:111]
ds_read_b128 v[144:147], v1 offset:8192
v_exp_f32 v54, v54
v_fma_f32 v62, -v10, v194, v62
v_exp_f32 v55, v55
s_waitcnt lgkmcnt(3)
v_mfma_f32_32x32x16_bf16 v[96:111], v[132:135], a[20:23], v[96:111]
ds_read_b128 v[148:151], v1 offset:9216
v_fma_f32 v63, -v10, v195, v63
v_fma_f32 v52, v52, v12, v12
v_fma_f32 v53, v53, v12, v12
v_fma_f32 v54, v54, v12, v12
v_fma_f32 v55, v55, v12, v12
s_waitcnt lgkmcnt(3)
v_mfma_f32_32x32x16_bf16 v[96:111], v[136:139], a[24:27], v[96:111]
ds_read_b128 v[152:155], v1 offset:10240
v_rcp_f32 v52, v52
v_rcp_f32 v53, v53
v_rcp_f32 v54, v54
s_waitcnt lgkmcnt(3)
v_mfma_f32_32x32x16_bf16 v[96:111], v[140:143], a[28:31], v[96:111]
ds_read_b128 v[156:159], v1 offset:11264
v_rcp_f32 v55, v55
v_mul_f32 v52, v52, v60
v_mul_f32 v53, v53, v61
v_mul_f32 v54, v54, v62
v_mul_f32 v55, v55, v63
s_waitcnt lgkmcnt(3)
v_mfma_f32_32x32x16_bf16 v[96:111], v[144:147], a[32:35], v[96:111]
ds_read_b128 v[160:163], v1 offset:12288
v_cvt_pk_bf16_f32 v212, v48, v49
v_cvt_pk_bf16_f32 v213, v50, v51
v_cvt_pk_bf16_f32 v214, v52, v53
v_cvt_pk_bf16_f32 v215, v54, v55
s_waitcnt lgkmcnt(3)
v_mfma_f32_32x32x16_bf16 v[96:111], v[148:151], a[36:39], v[96:111]
ds_read_b128 v[128:131], v1 offset:13312
buffer_store_dwordx4 v[212:215], v1, s[8:11], s28 offen offset:2048 sc1
v_fma_f32 v64, -v10, v196, v64
v_fma_f32 v65, -v10, v197, v65
v_fma_f32 v66, -v10, v198, v66
v_fma_f32 v67, -v10, v199, v67
s_waitcnt lgkmcnt(3)
v_mfma_f32_32x32x16_bf16 v[96:111], v[152:155], a[40:43], v[96:111]
ds_read_b128 v[132:135], v1 offset:14336
v_mul_f32 v64, v64, v11
v_mul_f32 v65, v65, v11
v_mul_f32 v66, v66, v11
v_mul_f32 v67, v67, v11
ds_read_b128 v[180:183], v13 offset:512
ds_read_b128 v[184:187], v13 offset:528
s_waitcnt lgkmcnt(5)
v_mfma_f32_32x32x16_bf16 v[96:111], v[156:159], a[44:47], v[96:111]
ds_read_b128 v[136:139], v1 offset:15360
ds_read_b128 v[188:191], v13 offset:544
ds_read_b128 v[192:195], v13 offset:560
v_exp_f32 v64, v64
v_fma_f32 v72, -v10, v204, v72
s_waitcnt lgkmcnt(7)
v_mfma_f32_32x32x16_bf16 v[96:111], v[160:163], a[48:51], v[96:111]
ds_read_b128 v[140:143], v1 offset:16384
v_exp_f32 v65, v65
v_fma_f32 v73, -v10, v205, v73
v_exp_f32 v66, v66
v_fma_f32 v74, -v10, v206, v74
s_waitcnt lgkmcnt(7)
v_mfma_f32_32x32x16_bf16 v[96:111], v[128:131], a[52:55], v[96:111]
ds_read_b128 v[144:147], v1 offset:17408
v_exp_f32 v67, v67
v_fma_f32 v75, -v10, v207, v75
v_fma_f32 v64, v64, v12, v12
v_fma_f32 v65, v65, v12, v12
s_waitcnt lgkmcnt(7)
v_mfma_f32_32x32x16_bf16 v[96:111], v[132:135], a[56:59], v[96:111]
ds_read_b128 v[148:151], v1 offset:18432
v_fma_f32 v66, v66, v12, v12
v_fma_f32 v67, v67, v12, v12
v_rcp_f32 v64, v64
v_rcp_f32 v65, v65
s_waitcnt lgkmcnt(5)
v_mfma_f32_32x32x16_bf16 v[96:111], v[136:139], a[60:63], v[96:111]
ds_read_b128 v[152:155], v1 offset:19456
v_rcp_f32 v66, v66
v_rcp_f32 v67, v67
v_mul_f32 v64, v64, v72
s_waitcnt lgkmcnt(3)
v_mfma_f32_32x32x16_bf16 v[96:111], v[140:143], a[64:67], v[96:111]
ds_read_b128 v[156:159], v1 offset:20480
v_mul_f32 v65, v65, v73
v_mul_f32 v66, v66, v74
v_mul_f32 v67, v67, v75
v_fma_f32 v68, -v10, v200, v68
v_fma_f32 v69, -v10, v201, v69
v_fma_f32 v70, -v10, v202, v70
s_waitcnt lgkmcnt(3)
v_mfma_f32_32x32x16_bf16 v[96:111], v[144:147], a[68:71], v[96:111]
ds_read_b128 v[160:163], v1 offset:21504
v_fma_f32 v71, -v10, v203, v71
v_mul_f32 v68, v68, v11
v_mul_f32 v69, v69, v11
v_mul_f32 v70, v70, v11
v_mul_f32 v71, v71, v11
s_waitcnt lgkmcnt(3)
v_mfma_f32_32x32x16_bf16 v[96:111], v[148:151], a[72:75], v[96:111]
ds_read_b128 v[128:131], v1 offset:22528
v_exp_f32 v68, v68
v_fma_f32 v76, -v10, v208, v76
v_exp_f32 v69, v69
v_fma_f32 v77, -v10, v209, v77
s_waitcnt lgkmcnt(3)
v_mfma_f32_32x32x16_bf16 v[96:111], v[152:155], a[76:79], v[96:111]
ds_read_b128 v[132:135], v1 offset:23552
v_exp_f32 v70, v70
v_fma_f32 v78, -v10, v210, v78
v_exp_f32 v71, v71
s_waitcnt lgkmcnt(3)
v_mfma_f32_32x32x16_bf16 v[96:111], v[156:159], a[80:83], v[96:111]
ds_read_b128 v[136:139], v1 offset:24576
v_fma_f32 v79, -v10, v211, v79
v_fma_f32 v68, v68, v12, v12
v_fma_f32 v69, v69, v12, v12
v_fma_f32 v70, v70, v12, v12
v_fma_f32 v71, v71, v12, v12
s_waitcnt lgkmcnt(3)
v_mfma_f32_32x32x16_bf16 v[96:111], v[160:163], a[84:87], v[96:111]
ds_read_b128 v[140:143], v1 offset:25600
v_rcp_f32 v68, v68
v_rcp_f32 v69, v69
v_rcp_f32 v70, v70
s_waitcnt lgkmcnt(3)
v_mfma_f32_32x32x16_bf16 v[96:111], v[128:131], a[88:91], v[96:111]
ds_read_b128 v[144:147], v1 offset:26624
v_rcp_f32 v71, v71
v_mul_f32 v68, v68, v76
v_mul_f32 v69, v69, v77
v_mul_f32 v70, v70, v78
v_mul_f32 v71, v71, v79
s_waitcnt lgkmcnt(3)
v_mfma_f32_32x32x16_bf16 v[96:111], v[132:135], a[92:95], v[96:111]
ds_read_b128 v[148:151], v1 offset:27648
v_cvt_pk_bf16_f32 v216, v64, v65
v_cvt_pk_bf16_f32 v217, v66, v67
v_cvt_pk_bf16_f32 v218, v68, v69
v_cvt_pk_bf16_f32 v219, v70, v71
s_waitcnt lgkmcnt(3)
v_mfma_f32_32x32x16_bf16 v[96:111], v[136:139], a[96:99], v[96:111]
s_waitcnt vmcnt(2)
s_barrier
ds_read_b128 v[152:155], v1 offset:28672
buffer_store_dwordx4 v[216:219], v1, s[8:11], s28 offen offset:3072 sc1
v_fma_f32 v80, -v10, v180, v80
v_fma_f32 v81, -v10, v181, v81
v_fma_f32 v82, -v10, v182, v82
v_fma_f32 v83, -v10, v183, v83
s_waitcnt lgkmcnt(3)
v_mfma_f32_32x32x16_bf16 v[96:111], v[140:143], a[100:103], v[96:111]
ds_read_b128 v[156:159], v1 offset:29696
v_mul_f32 v80, v80, v11
v_mul_f32 v81, v81, v11
v_mul_f32 v82, v82, v11
v_mul_f32 v83, v83, v11
ds_read_b128 v[196:199], v13 offset:640
ds_read_b128 v[200:203], v13 offset:656
s_waitcnt lgkmcnt(5)
v_mfma_f32_32x32x16_bf16 v[96:111], v[144:147], a[104:107], v[96:111]
ds_read_b128 v[160:163], v1 offset:30720
ds_read_b128 v[204:207], v13 offset:672
ds_read_b128 v[208:211], v13 offset:688
v_exp_f32 v80, v80
v_fma_f32 v88, -v10, v188, v88
s_waitcnt lgkmcnt(7)
v_mfma_f32_32x32x16_bf16 v[96:111], v[148:151], a[108:111], v[96:111]
ds_read_b128 v[128:131], v1 offset:31744
v_exp_f32 v81, v81
v_fma_f32 v89, -v10, v189, v89
v_exp_f32 v82, v82
v_fma_f32 v90, -v10, v190, v90
s_waitcnt lgkmcnt(7)
v_mfma_f32_32x32x16_bf16 v[112:127], v[152:155], a[0:3], 0
ds_read_b128 v[132:135], v1 offset:32768
v_exp_f32 v83, v83
v_fma_f32 v91, -v10, v191, v91
v_fma_f32 v80, v80, v12, v12
v_fma_f32 v81, v81, v12, v12
s_waitcnt lgkmcnt(7)
v_mfma_f32_32x32x16_bf16 v[112:127], v[156:159], a[4:7], v[112:127]
ds_read_b128 v[136:139], v1 offset:33792
v_fma_f32 v82, v82, v12, v12
v_fma_f32 v83, v83, v12, v12
v_rcp_f32 v80, v80
v_rcp_f32 v81, v81
s_waitcnt lgkmcnt(5)
v_mfma_f32_32x32x16_bf16 v[112:127], v[160:163], a[8:11], v[112:127]
ds_read_b128 v[140:143], v1 offset:34816
v_rcp_f32 v82, v82
v_rcp_f32 v83, v83
v_mul_f32 v80, v80, v88
s_waitcnt lgkmcnt(3)
v_mfma_f32_32x32x16_bf16 v[112:127], v[128:131], a[12:15], v[112:127]
ds_read_b128 v[144:147], v1 offset:35840
v_mul_f32 v81, v81, v89
v_mul_f32 v82, v82, v90
v_mul_f32 v83, v83, v91
v_fma_f32 v84, -v10, v184, v84
v_fma_f32 v85, -v10, v185, v85
v_fma_f32 v86, -v10, v186, v86
s_waitcnt lgkmcnt(3)
v_mfma_f32_32x32x16_bf16 v[112:127], v[132:135], a[16:19], v[112:127]
ds_read_b128 v[148:151], v1 offset:36864
v_fma_f32 v87, -v10, v187, v87
v_mul_f32 v84, v84, v11
v_mul_f32 v85, v85, v11
v_mul_f32 v86, v86, v11
v_mul_f32 v87, v87, v11
s_waitcnt lgkmcnt(3)
v_mfma_f32_32x32x16_bf16 v[112:127], v[136:139], a[20:23], v[112:127]
ds_read_b128 v[152:155], v1 offset:37888
v_exp_f32 v84, v84
v_fma_f32 v92, -v10, v192, v92
v_exp_f32 v85, v85
v_fma_f32 v93, -v10, v193, v93
s_waitcnt lgkmcnt(3)
v_mfma_f32_32x32x16_bf16 v[112:127], v[140:143], a[24:27], v[112:127]
ds_read_b128 v[156:159], v1 offset:38912
v_exp_f32 v86, v86
v_fma_f32 v94, -v10, v194, v94
v_exp_f32 v87, v87
s_waitcnt lgkmcnt(3)
v_mfma_f32_32x32x16_bf16 v[112:127], v[144:147], a[28:31], v[112:127]
ds_read_b128 v[160:163], v1 offset:39936
v_fma_f32 v95, -v10, v195, v95
v_fma_f32 v84, v84, v12, v12
v_fma_f32 v85, v85, v12, v12
v_fma_f32 v86, v86, v12, v12
v_fma_f32 v87, v87, v12, v12
s_waitcnt lgkmcnt(3)
v_mfma_f32_32x32x16_bf16 v[112:127], v[148:151], a[32:35], v[112:127]
ds_read_b128 v[128:131], v1 offset:40960
v_rcp_f32 v84, v84
v_rcp_f32 v85, v85
v_rcp_f32 v86, v86
s_waitcnt lgkmcnt(3)
v_mfma_f32_32x32x16_bf16 v[112:127], v[152:155], a[36:39], v[112:127]
ds_read_b128 v[132:135], v1 offset:41984
v_rcp_f32 v87, v87
v_mul_f32 v84, v84, v92
v_mul_f32 v85, v85, v93
v_mul_f32 v86, v86, v94
v_mul_f32 v87, v87, v95
s_waitcnt lgkmcnt(3)
v_mfma_f32_32x32x16_bf16 v[112:127], v[156:159], a[40:43], v[112:127]
ds_read_b128 v[136:139], v1 offset:43008
v_cvt_pk_bf16_f32 v212, v80, v81
v_cvt_pk_bf16_f32 v213, v82, v83
v_cvt_pk_bf16_f32 v214, v84, v85
v_cvt_pk_bf16_f32 v215, v86, v87
s_waitcnt lgkmcnt(3)
v_mfma_f32_32x32x16_bf16 v[112:127], v[160:163], a[44:47], v[112:127]
ds_read_b128 v[140:143], v1 offset:44032
buffer_store_dwordx4 v[212:215], v1, s[8:11], s29 offen offset:0 sc1
v_fma_f32 v96, -v10, v196, v96
v_fma_f32 v97, -v10, v197, v97
v_fma_f32 v98, -v10, v198, v98
v_fma_f32 v99, -v10, v199, v99
s_waitcnt lgkmcnt(3)
v_mfma_f32_32x32x16_bf16 v[112:127], v[128:131], a[48:51], v[112:127]
ds_read_b128 v[144:147], v1 offset:45056
v_mul_f32 v96, v96, v11
v_mul_f32 v97, v97, v11
v_mul_f32 v98, v98, v11
v_mul_f32 v99, v99, v11
ds_read_b128 v[180:183], v13 offset:768
ds_read_b128 v[184:187], v13 offset:784
s_waitcnt lgkmcnt(5)
v_mfma_f32_32x32x16_bf16 v[112:127], v[132:135], a[52:55], v[112:127]
ds_read_b128 v[148:151], v1 offset:46080
ds_read_b128 v[188:191], v13 offset:800
ds_read_b128 v[192:195], v13 offset:816
v_exp_f32 v96, v96
v_fma_f32 v104, -v10, v204, v104
s_waitcnt lgkmcnt(7)
v_mfma_f32_32x32x16_bf16 v[112:127], v[136:139], a[56:59], v[112:127]
ds_read_b128 v[152:155], v1 offset:47104
v_exp_f32 v97, v97
v_fma_f32 v105, -v10, v205, v105
v_exp_f32 v98, v98
v_fma_f32 v106, -v10, v206, v106
s_waitcnt lgkmcnt(7)
v_mfma_f32_32x32x16_bf16 v[112:127], v[140:143], a[60:63], v[112:127]
ds_read_b128 v[156:159], v1 offset:48128
v_exp_f32 v99, v99
v_fma_f32 v107, -v10, v207, v107
v_fma_f32 v96, v96, v12, v12
v_fma_f32 v97, v97, v12, v12
s_waitcnt lgkmcnt(7)
v_mfma_f32_32x32x16_bf16 v[112:127], v[144:147], a[64:67], v[112:127]
ds_read_b128 v[160:163], v1 offset:49152
v_fma_f32 v98, v98, v12, v12
v_fma_f32 v99, v99, v12, v12
v_rcp_f32 v96, v96
v_rcp_f32 v97, v97
s_waitcnt lgkmcnt(5)
v_mfma_f32_32x32x16_bf16 v[112:127], v[148:151], a[68:71], v[112:127]
ds_read_b128 v[128:131], v1 offset:50176
v_rcp_f32 v98, v98
v_rcp_f32 v99, v99
v_mul_f32 v96, v96, v104
s_waitcnt lgkmcnt(3)
v_mfma_f32_32x32x16_bf16 v[112:127], v[152:155], a[72:75], v[112:127]
ds_read_b128 v[132:135], v1 offset:51200
v_mul_f32 v97, v97, v105
v_mul_f32 v98, v98, v106
v_mul_f32 v99, v99, v107
v_fma_f32 v100, -v10, v200, v100
v_fma_f32 v101, -v10, v201, v101
v_fma_f32 v102, -v10, v202, v102
s_waitcnt lgkmcnt(3)
v_mfma_f32_32x32x16_bf16 v[112:127], v[156:159], a[76:79], v[112:127]
ds_read_b128 v[136:139], v1 offset:52224
v_fma_f32 v103, -v10, v203, v103
v_mul_f32 v100, v100, v11
v_mul_f32 v101, v101, v11
v_mul_f32 v102, v102, v11
v_mul_f32 v103, v103, v11
s_waitcnt lgkmcnt(3)
v_mfma_f32_32x32x16_bf16 v[112:127], v[160:163], a[80:83], v[112:127]
ds_read_b128 v[140:143], v1 offset:53248
v_exp_f32 v100, v100
v_fma_f32 v108, -v10, v208, v108
v_exp_f32 v101, v101
v_fma_f32 v109, -v10, v209, v109
s_waitcnt lgkmcnt(3)
v_mfma_f32_32x32x16_bf16 v[112:127], v[128:131], a[84:87], v[112:127]
ds_read_b128 v[144:147], v1 offset:54272
v_exp_f32 v102, v102
v_fma_f32 v110, -v10, v210, v110
v_exp_f32 v103, v103
s_waitcnt lgkmcnt(3)
v_mfma_f32_32x32x16_bf16 v[112:127], v[132:135], a[88:91], v[112:127]
ds_read_b128 v[148:151], v1 offset:55296
v_fma_f32 v111, -v10, v211, v111
v_fma_f32 v100, v100, v12, v12
v_fma_f32 v101, v101, v12, v12
v_fma_f32 v102, v102, v12, v12
v_fma_f32 v103, v103, v12, v12
s_waitcnt lgkmcnt(3)
v_mfma_f32_32x32x16_bf16 v[112:127], v[136:139], a[92:95], v[112:127]
ds_read_b128 v[152:155], v1 offset:56320
v_rcp_f32 v100, v100
v_rcp_f32 v101, v101
v_rcp_f32 v102, v102
s_waitcnt lgkmcnt(3)
v_mfma_f32_32x32x16_bf16 v[112:127], v[140:143], a[96:99], v[112:127]
v_rcp_f32 v103, v103
v_mul_f32 v100, v100, v108
v_mul_f32 v101, v101, v109
v_mul_f32 v102, v102, v110
v_mul_f32 v103, v103, v111
s_waitcnt lgkmcnt(2)
v_mfma_f32_32x32x16_bf16 v[112:127], v[144:147], a[100:103], v[112:127]
v_cvt_pk_bf16_f32 v216, v96, v97
v_cvt_pk_bf16_f32 v217, v98, v99
v_cvt_pk_bf16_f32 v218, v100, v101
v_cvt_pk_bf16_f32 v219, v102, v103
s_waitcnt lgkmcnt(1)
v_mfma_f32_32x32x16_bf16 v[112:127], v[148:151], a[104:107], v[112:127]
buffer_store_dwordx4 v[216:219], v1, s[8:11], s29 offen offset:1024 sc1
s_waitcnt lgkmcnt(0)
v_mfma_f32_32x32x16_bf16 v[112:127], v[152:155], a[108:111], v[112:127]
s_nop 11
v_fma_f32 v112, -v10, v180, v112
v_fma_f32 v113, -v10, v181, v113
v_fma_f32 v114, -v10, v182, v114
v_fma_f32 v115, -v10, v183, v115
v_mul_f32 v112, v112, v11
v_mul_f32 v113, v113, v11
v_mul_f32 v114, v114, v11
v_mul_f32 v115, v115, v11
v_exp_f32 v112, v112
v_fma_f32 v120, -v10, v188, v120
v_exp_f32 v113, v113
v_fma_f32 v121, -v10, v189, v121
v_exp_f32 v114, v114
v_fma_f32 v122, -v10, v190, v122
v_exp_f32 v115, v115
v_fma_f32 v123, -v10, v191, v123
v_fma_f32 v112, v112, v12, v12
v_fma_f32 v113, v113, v12, v12
v_fma_f32 v114, v114, v12, v12
v_fma_f32 v115, v115, v12, v12
v_rcp_f32 v112, v112
v_rcp_f32 v113, v113
v_rcp_f32 v114, v114
v_rcp_f32 v115, v115
v_mul_f32 v112, v112, v120
v_mul_f32 v113, v113, v121
v_mul_f32 v114, v114, v122
v_mul_f32 v115, v115, v123
v_fma_f32 v116, -v10, v184, v116
v_fma_f32 v117, -v10, v185, v117
v_fma_f32 v118, -v10, v186, v118
v_fma_f32 v119, -v10, v187, v119
v_mul_f32 v116, v116, v11
v_mul_f32 v117, v117, v11
v_mul_f32 v118, v118, v11
v_mul_f32 v119, v119, v11
v_exp_f32 v116, v116
v_fma_f32 v124, -v10, v192, v124
v_exp_f32 v117, v117
v_fma_f32 v125, -v10, v193, v125
v_exp_f32 v118, v118
v_fma_f32 v126, -v10, v194, v126
v_exp_f32 v119, v119
v_fma_f32 v127, -v10, v195, v127
v_fma_f32 v116, v116, v12, v12
v_fma_f32 v117, v117, v12, v12
v_fma_f32 v118, v118, v12, v12
v_fma_f32 v119, v119, v12, v12
v_rcp_f32 v116, v116
v_rcp_f32 v117, v117
v_rcp_f32 v118, v118
v_rcp_f32 v119, v119
v_mul_f32 v116, v116, v124
v_mul_f32 v117, v117, v125
v_mul_f32 v118, v118, v126
v_mul_f32 v119, v119, v127
v_cvt_pk_bf16_f32 v212, v112, v113
v_cvt_pk_bf16_f32 v213, v114, v115
v_cvt_pk_bf16_f32 v214, v116, v117
v_cvt_pk_bf16_f32 v215, v118, v119
buffer_store_dwordx4 v[212:215], v1, s[8:11], s29 offen offset:2048 sc1
s_lshl_b32 s13, s12, 7
s_add_u32 s13, s13, 30021632
s_waitcnt vmcnt(0)
s_barrier
s_cmp_lg_u32 s3, 0
s_cbranch_scc1 main_kernel_sg8
v_mov_b32 v4, 1
v_mov_b32 v5, 0
s_mov_b64 exec, 1
buffer_atomic_add v4, v5, s[8:11], s13 offen sc1
s_mov_b64 exec, -1
main_kernel_sg8:
s_add_u32 s26, s57, 16384
buffer_load_dwordx4 a[0:3], v1, s[8:11], s26 offen offset:2048
s_add_u32 s26, s58, 16384
buffer_load_dwordx4 a[4:7], v1, s[8:11], s26 offen offset:2048
s_add_u32 s26, s57, 16384
buffer_load_dwordx4 a[8:11], v1, s[8:11], s26 offen offset:3072
s_add_u32 s26, s58, 16384
buffer_load_dwordx4 a[12:15], v1, s[8:11], s26 offen offset:3072
s_add_u32 s26, s57, 20480
buffer_load_dwordx4 a[16:19], v1, s[8:11], s26 offen offset:0
s_add_u32 s26, s58, 20480
buffer_load_dwordx4 a[20:23], v1, s[8:11], s26 offen offset:0
s_add_u32 s26, s57, 20480
buffer_load_dwordx4 a[24:27], v1, s[8:11], s26 offen offset:1024
s_add_u32 s26, s58, 20480
buffer_load_dwordx4 a[28:31], v1, s[8:11], s26 offen offset:1024
s_add_u32 s26, s57, 20480
buffer_load_dwordx4 a[32:35], v1, s[8:11], s26 offen offset:2048
s_add_u32 s26, s58, 20480
buffer_load_dwordx4 a[36:39], v1, s[8:11], s26 offen offset:2048
s_add_u32 s26, s57, 20480
buffer_load_dwordx4 a[40:43], v1, s[8:11], s26 offen offset:3072
s_add_u32 s26, s58, 20480
buffer_load_dwordx4 a[44:47], v1, s[8:11], s26 offen offset:3072
s_add_u32 s26, s57, 24576
buffer_load_dwordx4 a[48:51], v1, s[8:11], s26 offen offset:0
s_add_u32 s26, s58, 24576
buffer_load_dwordx4 a[52:55], v1, s[8:11], s26 offen offset:0
s_add_u32 s26, s57, 24576
buffer_load_dwordx4 a[56:59], v1, s[8:11], s26 offen offset:1024
s_add_u32 s26, s58, 24576
buffer_load_dwordx4 a[60:63], v1, s[8:11], s26 offen offset:1024
s_add_u32 s26, s57, 24576
buffer_load_dwordx4 a[64:67], v1, s[8:11], s26 offen offset:2048
s_add_u32 s26, s58, 24576
buffer_load_dwordx4 a[68:71], v1, s[8:11], s26 offen offset:2048
s_add_u32 s26, s57, 24576
buffer_load_dwordx4 a[72:75], v1, s[8:11], s26 offen offset:3072
s_add_u32 s26, s58, 24576
buffer_load_dwordx4 a[76:79], v1, s[8:11], s26 offen offset:3072
s_cmp_ge_u32 s2, 224
s_cbranch_scc1 main_kernel_ce01
s_mul_i32 s18, s3, 28672
s_mul_i32 s20, s44, 114688
s_add_u32 s20, s20, s18
s_add_u32 s20, s20, 22020096
s_mul_i32 s21, s45, 114688
s_add_u32 s21, s21, s18
s_add_u32 s21, s21, 22020096
s_mul_i32 s24, s44, 28
s_lshl_b32 s25, s46, 1
s_add_u32 s24, s24, s25
s_lshl_b32 s24, s24, 10
s_add_u32 s25, s24, 2097152
s_lshr_b32 s12, s44, 2
s_lshl_b32 s13, s12, 7
s_add_u32 s13, s13, 30021632
s_cmp_lg_u32 s3, 0
s_cbranch_scc1 main_kernel_wt9x
s_mov_b32 s60, 0
v_mov_b32 v5, 0
main_kernel_wt9:
buffer_load_dword v4, v5, s[8:11], s13 offen sc1
s_add_u32 s60, s60, 1
s_waitcnt vmcnt(0)
v_readfirstlane_b32 s61, v4
s_cmp_ge_u32 s61, 16
s_cbranch_scc1 main_kernel_wt9x
s_cmp_gt_u32 s60, 40000
s_cbranch_scc1 main_kernel_end
s_sleep 1
s_branch main_kernel_wt9
main_kernel_wt9x:
s_waitcnt vmcnt(0)
s_barrier
buffer_load_dwordx4 v[80:83], v1, s[8:11], s20 offen offset:0 sc1
buffer_load_dwordx4 v[84:87], v1, s[8:11], s21 offen offset:0 sc1
buffer_load_dwordx4 v[88:91], v1, s[8:11], s20 offen offset:1024 sc1
buffer_load_dwordx4 v[92:95], v1, s[8:11], s21 offen offset:1024 sc1
buffer_load_dwordx4 v[96:99], v1, s[8:11], s20 offen offset:2048 sc1
buffer_load_dwordx4 v[100:103], v1, s[8:11], s21 offen offset:2048 sc1
buffer_load_dwordx4 v[104:107], v1, s[8:11], s20 offen offset:3072 sc1
buffer_load_dwordx4 v[108:111], v1, s[8:11], s21 offen offset:3072 sc1
s_add_u32 s20, s20, 4096
s_add_u32 s21, s21, 4096
buffer_load_dwordx4 v[112:115], v1, s[8:11], s20 offen offset:0 sc1
buffer_load_dwordx4 v[116:119], v1, s[8:11], s21 offen offset:0 sc1
buffer_load_dwordx4 v[120:123], v1, s[8:11], s20 offen offset:1024 sc1
buffer_load_dwordx4 v[124:127], v1, s[8:11], s21 offen offset:1024 sc1
buffer_load_dwordx4 v[128:131], v1, s[8:11], s20 offen offset:2048 sc1
buffer_load_dwordx4 v[132:135], v1, s[8:11], s21 offen offset:2048 sc1
buffer_load_dwordx4 v[136:139], v1, s[8:11], s20 offen offset:3072 sc1
buffer_load_dwordx4 v[140:143], v1, s[8:11], s21 offen offset:3072 sc1
s_waitcnt vmcnt(14)
v_mfma_f32_32x32x16_bf16 v[16:31], a[112:115], v[80:83], 0
s_add_u32 s20, s20, 4096
s_add_u32 s21, s21, 4096
buffer_load_dwordx4 v[144:147], v1, s[8:11], s20 offen offset:0 sc1
buffer_load_dwordx4 v[148:151], v1, s[8:11], s21 offen offset:0 sc1
v_mfma_f32_32x32x16_bf16 v[32:47], a[116:119], v[80:83], 0
v_mfma_f32_32x32x16_bf16 v[48:63], a[112:115], v[84:87], 0
buffer_load_dwordx4 v[152:155], v1, s[8:11], s20 offen offset:1024 sc1
buffer_load_dwordx4 v[156:159], v1, s[8:11], s21 offen offset:1024 sc1
v_mfma_f32_32x32x16_bf16 v[64:79], a[116:119], v[84:87], 0
s_waitcnt vmcnt(16)
v_mfma_f32_32x32x16_bf16 v[16:31], a[120:123], v[88:91], v[16:31]
buffer_load_dwordx4 v[160:163], v1, s[8:11], s20 offen offset:2048 sc1
buffer_load_dwordx4 v[164:167], v1, s[8:11], s21 offen offset:2048 sc1
v_mfma_f32_32x32x16_bf16 v[32:47], a[124:127], v[88:91], v[32:47]
v_mfma_f32_32x32x16_bf16 v[48:63], a[120:123], v[92:95], v[48:63]
buffer_load_dwordx4 v[168:171], v1, s[8:11], s20 offen offset:3072 sc1
buffer_load_dwordx4 v[172:175], v1, s[8:11], s21 offen offset:3072 sc1
v_mfma_f32_32x32x16_bf16 v[64:79], a[124:127], v[92:95], v[64:79]
s_waitcnt vmcnt(18)
v_mfma_f32_32x32x16_bf16 v[16:31], a[128:131], v[96:99], v[16:31]
s_add_u32 s20, s20, 4096
s_add_u32 s21, s21, 4096
buffer_load_dwordx4 v[176:179], v1, s[8:11], s20 offen offset:0 sc1
buffer_load_dwordx4 v[180:183], v1, s[8:11], s21 offen offset:0 sc1
v_mfma_f32_32x32x16_bf16 v[32:47], a[132:135], v[96:99], v[32:47]
v_mfma_f32_32x32x16_bf16 v[48:63], a[128:131], v[100:103], v[48:63]
buffer_load_dwordx4 v[184:187], v1, s[8:11], s20 offen offset:1024 sc1
buffer_load_dwordx4 v[188:191], v1, s[8:11], s21 offen offset:1024 sc1
v_mfma_f32_32x32x16_bf16 v[64:79], a[132:135], v[100:103], v[64:79]
s_waitcnt vmcnt(20)
v_mfma_f32_32x32x16_bf16 v[16:31], a[136:139], v[104:107], v[16:31]
buffer_load_dwordx4 v[80:83], v1, s[8:11], s20 offen offset:2048 sc1
buffer_load_dwordx4 v[84:87], v1, s[8:11], s21 offen offset:2048 sc1
v_mfma_f32_32x32x16_bf16 v[32:47], a[140:143], v[104:107], v[32:47]
v_mfma_f32_32x32x16_bf16 v[48:63], a[136:139], v[108:111], v[48:63]
buffer_load_dwordx4 v[88:91], v1, s[8:11], s20 offen offset:3072 sc1
buffer_load_dwordx4 v[92:95], v1, s[8:11], s21 offen offset:3072 sc1
v_mfma_f32_32x32x16_bf16 v[64:79], a[140:143], v[108:111], v[64:79]
s_waitcnt vmcnt(22)
v_mfma_f32_32x32x16_bf16 v[16:31], a[144:147], v[112:115], v[16:31]
s_add_u32 s20, s20, 4096
s_add_u32 s21, s21, 4096
buffer_load_dwordx4 v[96:99], v1, s[8:11], s20 offen offset:0 sc1
buffer_load_dwordx4 v[100:103], v1, s[8:11], s21 offen offset:0 sc1
v_mfma_f32_32x32x16_bf16 v[32:47], a[148:151], v[112:115], v[32:47]
v_mfma_f32_32x32x16_bf16 v[48:63], a[144:147], v[116:119], v[48:63]
buffer_load_dwordx4 v[104:107], v1, s[8:11], s20 offen offset:1024 sc1
buffer_load_dwordx4 v[108:111], v1, s[8:11], s21 offen offset:1024 sc1
v_mfma_f32_32x32x16_bf16 v[64:79], a[148:151], v[116:119], v[64:79]
s_waitcnt vmcnt(24)
v_mfma_f32_32x32x16_bf16 v[16:31], a[152:155], v[120:123], v[16:31]
buffer_load_dwordx4 v[112:115], v1, s[8:11], s20 offen offset:2048 sc1
buffer_load_dwordx4 v[116:119], v1, s[8:11], s21 offen offset:2048 sc1
v_mfma_f32_32x32x16_bf16 v[32:47], a[156:159], v[120:123], v[32:47]
v_mfma_f32_32x32x16_bf16 v[48:63], a[152:155], v[124:127], v[48:63]
v_mfma_f32_32x32x16_bf16 v[64:79], a[156:159], v[124:127], v[64:79]
s_waitcnt vmcnt(24)
v_mfma_f32_32x32x16_bf16 v[16:31], a[160:163], v[128:131], v[16:31]
buffer_load_dwordx4 v[120:123], v1, s[8:11], s20 offen offset:3072 sc1
buffer_load_dwordx4 v[124:127], v1, s[8:11], s21 offen offset:3072 sc1
v_mfma_f32_32x32x16_bf16 v[32:47], a[164:167], v[128:131], v[32:47]
v_mfma_f32_32x32x16_bf16 v[48:63], a[160:163], v[132:135], v[48:63]
v_mfma_f32_32x32x16_bf16 v[64:79], a[164:167], v[132:135], v[64:79]
s_waitcnt vmcnt(24)
v_mfma_f32_32x32x16_bf16 v[16:31], a[168:171], v[136:139], v[16:31]
s_add_u32 s20, s20, 4096
s_add_u32 s21, s21, 4096
buffer_load_dwordx4 v[128:131], v1, s[8:11], s20 offen offset:0 sc1
buffer_load_dwordx4 v[132:135], v1, s[8:11], s21 offen offset:0 sc1
v_mfma_f32_32x32x16_bf16 v[32:47], a[172:175], v[136:139], v[32:47]
v_mfma_f32_32x32x16_bf16 v[48:63], a[168:171], v[140:143], v[48:63]
v_mfma_f32_32x32x16_bf16 v[64:79], a[172:175], v[140:143], v[64:79]
s_waitcnt vmcnt(24)
v_mfma_f32_32x32x16_bf16 v[16:31], a[176:179], v[144:147], v[16:31]
buffer_load_dwordx4 v[136:139], v1, s[8:11], s20 offen offset:1024 sc1
buffer_load_dwordx4 v[140:143], v1, s[8:11], s21 offen offset:1024 sc1
v_mfma_f32_32x32x16_bf16 v[32:47], a[180:183], v[144:147], v[32:47]
v_mfma_f32_32x32x16_bf16 v[48:63], a[176:179], v[148:151], v[48:63]
v_mfma_f32_32x32x16_bf16 v[64:79], a[180:183], v[148:151], v[64:79]
s_waitcnt vmcnt(24)
v_mfma_f32_32x32x16_bf16 v[16:31], a[184:187], v[152:155], v[16:31]
buffer_load_dwordx4 v[144:147], v1, s[8:11], s20 offen offset:2048 sc1
buffer_load_dwordx4 v[148:151], v1, s[8:11], s21 offen offset:2048 sc1
v_mfma_f32_32x32x16_bf16 v[32:47], a[188:191], v[152:155], v[32:47]
v_mfma_f32_32x32x16_bf16 v[48:63], a[184:187], v[156:159], v[48:63]
v_mfma_f32_32x32x16_bf16 v[64:79], a[188:191], v[156:159], v[64:79]
s_waitcnt vmcnt(24)
v_mfma_f32_32x32x16_bf16 v[16:31], a[192:195], v[160:163], v[16:31]
buffer_load_dwordx4 v[152:155], v1, s[8:11], s20 offen offset:3072 sc1
buffer_load_dwordx4 v[156:159], v1, s[8:11], s21 offen offset:3072 sc1
v_mfma_f32_32x32x16_bf16 v[32:47], a[196:199], v[160:163], v[32:47]
v_mfma_f32_32x32x16_bf16 v[48:63], a[192:195], v[164:167], v[48:63]
v_mfma_f32_32x32x16_bf16 v[64:79], a[196:199], v[164:167], v[64:79]
s_waitcnt vmcnt(24)
v_mfma_f32_32x32x16_bf16 v[16:31], a[200:203], v[168:171], v[16:31]
s_add_u32 s20, s20, 4096
s_add_u32 s21, s21, 4096
buffer_load_dwordx4 v[160:163], v1, s[8:11], s20 offen offset:0 sc1
buffer_load_dwordx4 v[164:167], v1, s[8:11], s21 offen offset:0 sc1
v_mfma_f32_32x32x16_bf16 v[32:47], a[204:207], v[168:171], v[32:47]
v_mfma_f32_32x32x16_bf16 v[48:63], a[200:203], v[172:175], v[48:63]
v_mfma_f32_32x32x16_bf16 v[64:79], a[204:207], v[172:175], v[64:79]
s_waitcnt vmcnt(24)
v_mfma_f32_32x32x16_bf16 v[16:31], a[208:211], v[176:179], v[16:31]
buffer_load_dwordx4 v[168:171], v1, s[8:11], s20 offen offset:1024 sc1
buffer_load_dwordx4 v[172:175], v1, s[8:11], s21 offen offset:1024 sc1
v_mfma_f32_32x32x16_bf16 v[32:47], a[212:215], v[176:179], v[32:47]
v_mfma_f32_32x32x16_bf16 v[48:63], a[208:211], v[180:183], v[48:63]
v_mfma_f32_32x32x16_bf16 v[64:79], a[212:215], v[180:183], v[64:79]
s_waitcnt vmcnt(24)
v_mfma_f32_32x32x16_bf16 v[16:31], a[216:219], v[184:187], v[16:31]
buffer_load_dwordx4 v[176:179], v1, s[8:11], s20 offen offset:2048 sc1
buffer_load_dwordx4 v[180:183], v1, s[8:11], s21 offen offset:2048 sc1
v_mfma_f32_32x32x16_bf16 v[32:47], a[220:223], v[184:187], v[32:47]
v_mfma_f32_32x32x16_bf16 v[48:63], a[216:219], v[188:191], v[48:63]
v_mfma_f32_32x32x16_bf16 v[64:79], a[220:223], v[188:191], v[64:79]
s_waitcnt vmcnt(24)
v_mfma_f32_32x32x16_bf16 v[16:31], a[224:227], v[80:83], v[16:31]
buffer_load_dwordx4 v[184:187], v1, s[8:11], s20 offen offset:3072 sc1
buffer_load_dwordx4 v[188:191], v1, s[8:11], s21 offen offset:3072 sc1
v_mfma_f32_32x32x16_bf16 v[32:47], a[228:231], v[80:83], v[32:47]
v_mfma_f32_32x32x16_bf16 v[48:63], a[224:227], v[84:87], v[48:63]
v_mfma_f32_32x32x16_bf16 v[64:79], a[228:231], v[84:87], v[64:79]
s_waitcnt vmcnt(24)
v_mfma_f32_32x32x16_bf16 v[16:31], a[232:235], v[88:91], v[16:31]
v_mfma_f32_32x32x16_bf16 v[32:47], a[236:239], v[88:91], v[32:47]
v_mfma_f32_32x32x16_bf16 v[48:63], a[232:235], v[92:95], v[48:63]
v_mfma_f32_32x32x16_bf16 v[64:79], a[236:239], v[92:95], v[64:79]
s_waitcnt vmcnt(22)
v_mfma_f32_32x32x16_bf16 v[16:31], a[240:243], v[96:99], v[16:31]
v_mfma_f32_32x32x16_bf16 v[32:47], a[244:247], v[96:99], v[32:47]
v_mfma_f32_32x32x16_bf16 v[48:63], a[240:243], v[100:103], v[48:63]
v_mfma_f32_32x32x16_bf16 v[64:79], a[244:247], v[100:103], v[64:79]
s_waitcnt vmcnt(20)
v_mfma_f32_32x32x16_bf16 v[16:31], a[248:251], v[104:107], v[16:31]
v_mfma_f32_32x32x16_bf16 v[32:47], a[252:255], v[104:107], v[32:47]
v_mfma_f32_32x32x16_bf16 v[48:63], a[248:251], v[108:111], v[48:63]
v_mfma_f32_32x32x16_bf16 v[64:79], a[252:255], v[108:111], v[64:79]
s_waitcnt vmcnt(18)
v_mfma_f32_32x32x16_bf16 v[16:31], a[0:3], v[112:115], v[16:31]
v_mfma_f32_32x32x16_bf16 v[32:47], a[4:7], v[112:115], v[32:47]
v_mfma_f32_32x32x16_bf16 v[48:63], a[0:3], v[116:119], v[48:63]
v_mfma_f32_32x32x16_bf16 v[64:79], a[4:7], v[116:119], v[64:79]
s_waitcnt vmcnt(16)
v_mfma_f32_32x32x16_bf16 v[16:31], a[8:11], v[120:123], v[16:31]
v_mfma_f32_32x32x16_bf16 v[32:47], a[12:15], v[120:123], v[32:47]
v_mfma_f32_32x32x16_bf16 v[48:63], a[8:11], v[124:127], v[48:63]
v_mfma_f32_32x32x16_bf16 v[64:79], a[12:15], v[124:127], v[64:79]
s_waitcnt vmcnt(14)
v_mfma_f32_32x32x16_bf16 v[16:31], a[16:19], v[128:131], v[16:31]
v_mfma_f32_32x32x16_bf16 v[32:47], a[20:23], v[128:131], v[32:47]
v_mfma_f32_32x32x16_bf16 v[48:63], a[16:19], v[132:135], v[48:63]
v_mfma_f32_32x32x16_bf16 v[64:79], a[20:23], v[132:135], v[64:79]
s_waitcnt vmcnt(12)
v_mfma_f32_32x32x16_bf16 v[16:31], a[24:27], v[136:139], v[16:31]
v_mfma_f32_32x32x16_bf16 v[32:47], a[28:31], v[136:139], v[32:47]
v_mfma_f32_32x32x16_bf16 v[48:63], a[24:27], v[140:143], v[48:63]
v_mfma_f32_32x32x16_bf16 v[64:79], a[28:31], v[140:143], v[64:79]
s_waitcnt vmcnt(10)
v_mfma_f32_32x32x16_bf16 v[16:31], a[32:35], v[144:147], v[16:31]
v_mfma_f32_32x32x16_bf16 v[32:47], a[36:39], v[144:147], v[32:47]
v_mfma_f32_32x32x16_bf16 v[48:63], a[32:35], v[148:151], v[48:63]
v_mfma_f32_32x32x16_bf16 v[64:79], a[36:39], v[148:151], v[64:79]
buffer_load_dwordx4 v[208:211], v1, s[8:11], s25 offen offset:0 sc1
buffer_load_dwordx4 v[212:215], v1, s[8:11], s25 offen offset:1024 sc1
s_waitcnt vmcnt(10)
v_mfma_f32_32x32x16_bf16 v[16:31], a[40:43], v[152:155], v[16:31]
v_mfma_f32_32x32x16_bf16 v[32:47], a[44:47], v[152:155], v[32:47]
v_mfma_f32_32x32x16_bf16 v[48:63], a[40:43], v[156:159], v[48:63]
v_mfma_f32_32x32x16_bf16 v[64:79], a[44:47], v[156:159], v[64:79]
s_waitcnt vmcnt(8)
v_mfma_f32_32x32x16_bf16 v[16:31], a[48:51], v[160:163], v[16:31]
v_mfma_f32_32x32x16_bf16 v[32:47], a[52:55], v[160:163], v[32:47]
v_mfma_f32_32x32x16_bf16 v[48:63], a[48:51], v[164:167], v[48:63]
v_mfma_f32_32x32x16_bf16 v[64:79], a[52:55], v[164:167], v[64:79]
s_waitcnt vmcnt(6)
v_mfma_f32_32x32x16_bf16 v[16:31], a[56:59], v[168:171], v[16:31]
v_mfma_f32_32x32x16_bf16 v[32:47], a[60:63], v[168:171], v[32:47]
v_mfma_f32_32x32x16_bf16 v[48:63], a[56:59], v[172:175], v[48:63]
v_mfma_f32_32x32x16_bf16 v[64:79], a[60:63], v[172:175], v[64:79]
s_waitcnt vmcnt(4)
v_mfma_f32_32x32x16_bf16 v[16:31], a[64:67], v[176:179], v[16:31]
v_mfma_f32_32x32x16_bf16 v[32:47], a[68:71], v[176:179], v[32:47]
v_mfma_f32_32x32x16_bf16 v[48:63], a[64:67], v[180:183], v[48:63]
v_mfma_f32_32x32x16_bf16 v[64:79], a[68:71], v[180:183], v[64:79]
s_waitcnt vmcnt(2)
v_mfma_f32_32x32x16_bf16 v[16:31], a[72:75], v[184:187], v[16:31]
v_mfma_f32_32x32x16_bf16 v[32:47], a[76:79], v[184:187], v[32:47]
v_mfma_f32_32x32x16_bf16 v[48:63], a[72:75], v[188:191], v[48:63]
v_mfma_f32_32x32x16_bf16 v[64:79], a[76:79], v[188:191], v[64:79]
s_xor_b32 s26, s3, 1
s_mul_i32 s26, s26, 12288
s_add_u32 s26, s26, 114688
v_add_u32 v12, s26, v1
s_xor_b32 s26, s3, 2
s_mul_i32 s26, s26, 12288
s_add_u32 s26, s26, 118784
v_add_u32 v13, s26, v1
s_xor_b32 s26, s3, 3
s_mul_i32 s26, s26, 12288
s_add_u32 s26, s26, 122880
v_add_u32 v14, s26, v1
s_mul_i32 s26, s3, 12288
s_add_u32 s26, s26, 114688
v_add_u32 v5, s26, v1
ds_write_b128 v12, v[32:35] offset:0
ds_write_b128 v12, v[36:39] offset:1024
ds_write_b128 v12, v[40:43] offset:2048
ds_write_b128 v12, v[44:47] offset:3072
ds_write_b128 v13, v[48:51] offset:0
ds_write_b128 v13, v[52:55] offset:1024
ds_write_b128 v13, v[56:59] offset:2048
ds_write_b128 v13, v[60:63] offset:3072
ds_write_b128 v14, v[64:67] offset:0
ds_write_b128 v14, v[68:71] offset:1024
ds_write_b128 v14, v[72:75] offset:2048
ds_write_b128 v14, v[76:79] offset:3072
v_and_b32 v6, 31, v0
v_lshrrev_b32 v7, 5, v0
s_waitcnt vmcnt(0)
v_lshlrev_b32 v8, 16, v208
v_and_b32 v9, 0xffff0000, v208
v_add_f32 v16, v16, v8
v_add_f32 v17, v17, v9
v_lshlrev_b32 v8, 16, v209
v_and_b32 v9, 0xffff0000, v209
v_add_f32 v18, v18, v8
v_add_f32 v19, v19, v9
v_lshlrev_b32 v8, 16, v210
v_and_b32 v9, 0xffff0000, v210
v_add_f32 v20, v20, v8
v_add_f32 v21, v21, v9
v_lshlrev_b32 v8, 16, v211
v_and_b32 v9, 0xffff0000, v211
v_add_f32 v22, v22, v8
v_add_f32 v23, v23, v9
v_lshlrev_b32 v8, 16, v212
v_and_b32 v9, 0xffff0000, v212
v_add_f32 v24, v24, v8
v_add_f32 v25, v25, v9
v_lshlrev_b32 v8, 16, v213
v_and_b32 v9, 0xffff0000, v213
v_add_f32 v26, v26, v8
v_add_f32 v27, v27, v9
v_lshlrev_b32 v8, 16, v214
v_and_b32 v9, 0xffff0000, v214
v_add_f32 v28, v28, v8
v_add_f32 v29, v29, v9
v_lshlrev_b32 v8, 16, v215
v_and_b32 v9, 0xffff0000, v215
v_add_f32 v30, v30, v8
v_add_f32 v31, v31, v9
s_waitcnt lgkmcnt(0)
s_barrier
ds_read_b128 v[80:83], v5 offset:0
ds_read_b128 v[84:87], v5 offset:1024
ds_read_b128 v[88:91], v5 offset:2048
ds_read_b128 v[92:95], v5 offset:3072
ds_read_b128 v[96:99], v5 offset:4096
ds_read_b128 v[100:103], v5 offset:5120
ds_read_b128 v[104:107], v5 offset:6144
ds_read_b128 v[108:111], v5 offset:7168
ds_read_b128 v[112:115], v5 offset:8192
ds_read_b128 v[116:119], v5 offset:9216
ds_read_b128 v[120:123], v5 offset:10240
ds_read_b128 v[124:127], v5 offset:11264
s_waitcnt lgkmcnt(8)
v_add_f32 v16, v16, v80
v_add_f32 v17, v17, v81
v_add_f32 v18, v18, v82
v_add_f32 v19, v19, v83
v_add_f32 v20, v20, v84
v_add_f32 v21, v21, v85
v_add_f32 v22, v22, v86
v_add_f32 v23, v23, v87
v_add_f32 v24, v24, v88
v_add_f32 v25, v25, v89
v_add_f32 v26, v26, v90
v_add_f32 v27, v27, v91
v_add_f32 v28, v28, v92
v_add_f32 v29, v29, v93
v_add_f32 v30, v30, v94
v_add_f32 v31, v31, v95
s_waitcnt lgkmcnt(4)
v_add_f32 v16, v16, v96
v_add_f32 v17, v17, v97
v_add_f32 v18, v18, v98
v_add_f32 v19, v19, v99
v_add_f32 v20, v20, v100
v_add_f32 v21, v21, v101
v_add_f32 v22, v22, v102
v_add_f32 v23, v23, v103
v_add_f32 v24, v24, v104
v_add_f32 v25, v25, v105
v_add_f32 v26, v26, v106
v_add_f32 v27, v27, v107
v_add_f32 v28, v28, v108
v_add_f32 v29, v29, v109
v_add_f32 v30, v30, v110
v_add_f32 v31, v31, v111
s_waitcnt lgkmcnt(0)
v_add_f32 v16, v16, v112
v_add_f32 v17, v17, v113
v_add_f32 v18, v18, v114
v_add_f32 v19, v19, v115
v_add_f32 v20, v20, v116
v_add_f32 v21, v21, v117
v_add_f32 v22, v22, v118
v_add_f32 v23, v23, v119
v_add_f32 v24, v24, v120
v_add_f32 v25, v25, v121
v_add_f32 v26, v26, v122
v_add_f32 v27, v27, v123
v_add_f32 v28, v28, v124
v_add_f32 v29, v29, v125
v_add_f32 v30, v30, v126
v_add_f32 v31, v31, v127
v_cvt_pk_bf16_f32 v208, v16, v17
v_cvt_pk_bf16_f32 v209, v18, v19
v_cvt_pk_bf16_f32 v210, v20, v21
v_cvt_pk_bf16_f32 v211, v22, v23
v_cvt_pk_bf16_f32 v212, v24, v25
v_cvt_pk_bf16_f32 v213, v26, v27
v_cvt_pk_bf16_f32 v214, v28, v29
v_cvt_pk_bf16_f32 v215, v30, v31
s_add_u32 s25, s24, 33554432
buffer_store_dwordx4 v[208:211], v1, s[8:11], s25 offen offset:0 sc1
buffer_store_dwordx4 v[212:215], v1, s[8:11], s25 offen offset:1024 sc1
v_lshlrev_b32 v6, 3, v6
v_lshl_add_u32 v6, v7, 2, v6
s_mul_i32 s25, s44, 3584
s_lshl_b32 s26, s46, 8
s_add_u32 s25, s25, s26
s_add_u32 s25, s25, 63045632
s_mov_b32 s27, 0x3f803f80
v_mov_b32 v10, 0
v_mov_b32 v11, 0
v_dot2_f32_bf16 v10, v208, s27, v10
v_dot2_f32_bf16 v11, v208, v208, v11
v_dot2_f32_bf16 v10, v209, s27, v10
v_dot2_f32_bf16 v11, v209, v209, v11
v_dot2_f32_bf16 v10, v210, s27, v10
v_dot2_f32_bf16 v11, v210, v210, v11
v_dot2_f32_bf16 v10, v211, s27, v10
v_dot2_f32_bf16 v11, v211, v211, v11
v_dot2_f32_bf16 v10, v212, s27, v10
v_dot2_f32_bf16 v11, v212, v212, v11
v_dot2_f32_bf16 v10, v213, s27, v10
v_dot2_f32_bf16 v11, v213, v213, v11
v_dot2_f32_bf16 v10, v214, s27, v10
v_dot2_f32_bf16 v11, v214, v214, v11
v_dot2_f32_bf16 v10, v215, s27, v10
v_dot2_f32_bf16 v11, v215, v215, v11
s_nop 3
v_permlane32_swap_b32 v10, v11
s_nop 1
v_add_f32 v10, v10, v11
buffer_store_dword v10, v6, s[8:11], s25 offen sc1
s_lshl_b32 s13, s12, 7
s_add_u32 s13, s13, 30023680
s_waitcnt vmcnt(0)
s_barrier
s_cmp_lg_u32 s3, 0
s_cbranch_scc1 main_kernel_sg10
v_mov_b32 v4, 1
v_mov_b32 v5, 0
s_mov_b64 exec, 1
buffer_atomic_add v4, v5, s[8:11], s13 offen sc1
s_mov_b64 exec, -1
main_kernel_sg10:
main_kernel_ce01:
s_add_u32 s24, s50, 0
s_mov_b32 m0, s24
s_add_u32 s25, s51, 0
buffer_load_dwordx4 v1, s[8:11], s25 offen offset:0 lds
buffer_load_dwordx4 v1, s[8:11], s25 offen offset:1024 lds
buffer_load_dwordx4 v1, s[8:11], s25 offen offset:2048 lds
s_add_u32 s24, s50, 12288
s_mov_b32 m0, s24
s_add_u32 s25, s51, 12288
buffer_load_dwordx4 v1, s[8:11], s25 offen offset:0 lds
buffer_load_dwordx4 v1, s[8:11], s25 offen offset:1024 lds
buffer_load_dwordx4 v1, s[8:11], s25 offen offset:2048 lds
s_add_u32 s24, s50, 24576
s_mov_b32 m0, s24
s_add_u32 s25, s51, 24576
buffer_load_dwordx4 v1, s[8:11], s25 offen offset:0 lds
buffer_load_dwordx4 v1, s[8:11], s25 offen offset:1024 lds
buffer_load_dwordx4 v1, s[8:11], s25 offen offset:2048 lds
s_add_u32 s24, s50, 36864
s_mov_b32 m0, s24
s_add_u32 s25, s51, 36864
buffer_load_dwordx4 v1, s[8:11], s25 offen offset:0 lds
buffer_load_dwordx4 v1, s[8:11], s25 offen offset:1024 lds
buffer_load_dwordx4 v1, s[8:11], s25 offen offset:2048 lds
s_add_u32 s24, s50, 49152
s_mov_b32 m0, s24
s_add_u32 s25, s51, 49152
buffer_load_dwordx4 v1, s[8:11], s25 offen offset:0 lds
buffer_load_dwordx4 v1, s[8:11], s25 offen offset:1024 lds
buffer_load_dwordx4 v1, s[8:11], s25 offen offset:2048 lds
s_add_u32 s24, s50, 61440
s_mov_b32 m0, s24
s_add_u32 s25, s51, 61440
buffer_load_dwordx4 v1, s[8:11], s25 offen offset:0 lds
buffer_load_dwordx4 v1, s[8:11], s25 offen offset:1024 lds
buffer_load_dwordx4 v1, s[8:11], s25 offen offset:2048 lds
s_add_u32 s24, s50, 73728
s_mov_b32 m0, s24
s_add_u32 s25, s51, 73728
buffer_load_dwordx4 v1, s[8:11], s25 offen offset:0 lds
buffer_load_dwordx4 v1, s[8:11], s25 offen offset:1024 lds
buffer_load_dwordx4 v1, s[8:11], s25 offen offset:2048 lds
s_mul_i32 s21, s40, 28672
s_add_u32 s21, s21, 33554432
s_mul_i32 s27, s40, 3584
s_add_u32 s27, s27, 63045632
s_mul_i32 s28, s41, 384
s_add_u32 s28, s28, 29360128
v_lshrrev_b32 v6, 5, v0
v_lshlrev_b32 v6, 6, v6
v_and_b32 v7, 31, v0
v_lshlrev_b32 v7, 2, v7
s_lshr_b32 s12, s40, 2
s_lshl_b32 s13, s12, 7
s_add_u32 s13, s13, 30023680
s_cmp_lg_u32 s3, 0
s_cbranch_scc1 main_kernel_wt11x
s_mov_b32 s60, 0
v_mov_b32 v5, 0
main_kernel_wt11:
buffer_load_dword v4, v5, s[8:11], s13 offen sc1
s_add_u32 s60, s60, 1
s_waitcnt vmcnt(0)
v_readfirstlane_b32 s61, v4
s_cmp_ge_u32 s61, 14
s_cbranch_scc1 main_kernel_wt11x
s_cmp_gt_u32 s60, 40000
s_cbranch_scc1 main_kernel_end
s_sleep 1
s_branch main_kernel_wt11
main_kernel_wt11x:
s_waitcnt vmcnt(0)
s_barrier
s_add_u32 s26, s21, 0
buffer_load_dwordx4 a[0:3], v1, s[8:11], s26 offen offset:0 sc1
buffer_load_dwordx4 a[4:7], v1, s[8:11], s26 offen offset:1024 sc1
buffer_load_dwordx4 a[8:11], v1, s[8:11], s26 offen offset:2048 sc1
buffer_load_dwordx4 a[12:15], v1, s[8:11], s26 offen offset:3072 sc1
s_add_u32 s26, s21, 4096
buffer_load_dwordx4 a[16:19], v1, s[8:11], s26 offen offset:0 sc1
buffer_load_dwordx4 a[20:23], v1, s[8:11], s26 offen offset:1024 sc1
buffer_load_dwordx4 a[24:27], v1, s[8:11], s26 offen offset:2048 sc1
buffer_load_dwordx4 a[28:31], v1, s[8:11], s26 offen offset:3072 sc1
s_add_u32 s26, s21, 8192
buffer_load_dwordx4 a[32:35], v1, s[8:11], s26 offen offset:0 sc1
buffer_load_dwordx4 a[36:39], v1, s[8:11], s26 offen offset:1024 sc1
buffer_load_dwordx4 a[40:43], v1, s[8:11], s26 offen offset:2048 sc1
buffer_load_dwordx4 a[44:47], v1, s[8:11], s26 offen offset:3072 sc1
s_add_u32 s26, s21, 12288
buffer_load_dwordx4 a[48:51], v1, s[8:11], s26 offen offset:0 sc1
buffer_load_dwordx4 a[52:55], v1, s[8:11], s26 offen offset:1024 sc1
buffer_load_dwordx4 a[56:59], v1, s[8:11], s26 offen offset:2048 sc1
buffer_load_dwordx4 a[60:63], v1, s[8:11], s26 offen offset:3072 sc1
ds_read_b128 v[64:67], v1 offset:0
ds_read_b128 v[68:71], v1 offset:1024
ds_read_b128 v[72:75], v1 offset:2048
ds_read_b128 v[76:79], v1 offset:3072
ds_read_b128 v[80:83], v1 offset:4096
ds_read_b128 v[84:87], v1 offset:5120
s_waitcnt vmcnt(12)
s_waitcnt lgkmcnt(3)
v_mfma_f32_32x32x16_bf16 v[16:31], v[64:67], a[0:3], 0
ds_read_b128 v[88:91], v1 offset:6144
ds_read_b128 v[92:95], v1 offset:7168
ds_read_b128 v[96:99], v1 offset:8192
s_add_u32 s26, s21, 16384
buffer_load_dwordx4 a[64:67], v1, s[8:11], s26 offen offset:0 sc1
v_mfma_f32_32x32x16_bf16 v[32:47], v[68:71], a[0:3], 0
v_mfma_f32_32x32x16_bf16 v[48:63], a[0:3], v[72:75], 0
buffer_load_dwordx4 a[68:71], v1, s[8:11], s26 offen offset:1024 sc1
s_waitcnt lgkmcnt(3)
v_mfma_f32_32x32x16_bf16 v[16:31], v[76:79], a[4:7], v[16:31]
ds_read_b128 v[64:67], v1 offset:9216
ds_read_b128 v[68:71], v1 offset:10240
ds_read_b128 v[72:75], v1 offset:11264
v_mfma_f32_32x32x16_bf16 v[32:47], v[80:83], a[4:7], v[32:47]
v_mfma_f32_32x32x16_bf16 v[48:63], a[4:7], v[84:87], v[48:63]
buffer_load_dwordx4 a[72:75], v1, s[8:11], s26 offen offset:2048 sc1
s_waitcnt lgkmcnt(3)
v_mfma_f32_32x32x16_bf16 v[16:31], v[88:91], a[8:11], v[16:31]
ds_read_b128 v[76:79], v1 offset:12288
ds_read_b128 v[80:83], v1 offset:13312
ds_read_b128 v[84:87], v1 offset:14336
v_mfma_f32_32x32x16_bf16 v[32:47], v[92:95], a[8:11], v[32:47]
v_mfma_f32_32x32x16_bf16 v[48:63], a[8:11], v[96:99], v[48:63]
buffer_load_dwordx4 a[76:79], v1, s[8:11], s26 offen offset:3072 sc1
s_waitcnt lgkmcnt(3)
v_mfma_f32_32x32x16_bf16 v[16:31], v[64:67], a[12:15], v[16:31]
ds_read_b128 v[88:91], v1 offset:15360
ds_read_b128 v[92:95], v1 offset:16384
ds_read_b128 v[96:99], v1 offset:17408
v_mfma_f32_32x32x16_bf16 v[32:47], v[68:71], a[12:15], v[32:47]
v_mfma_f32_32x32x16_bf16 v[48:63], a[12:15], v[72:75], v[48:63]
s_waitcnt vmcnt(12)
s_waitcnt lgkmcnt(3)
v_mfma_f32_32x32x16_bf16 v[16:31], v[76:79], a[16:19], v[16:31]
ds_read_b128 v[64:67], v1 offset:18432
ds_read_b128 v[68:71], v1 offset:19456
ds_read_b128 v[72:75], v1 offset:20480
s_add_u32 s26, s21, 20480
buffer_load_dwordx4 a[80:83], v1, s[8:11], s26 offen offset:0 sc1
v_mfma_f32_32x32x16_bf16 v[32:47], v[80:83], a[16:19], v[32:47]
v_mfma_f32_32x32x16_bf16 v[48:63], a[16:19], v[84:87], v[48:63]
buffer_load_dwordx4 a[84:87], v1, s[8:11], s26 offen offset:1024 sc1
s_waitcnt lgkmcnt(3)
v_mfma_f32_32x32x16_bf16 v[16:31], v[88:91], a[20:23], v[16:31]
ds_read_b128 v[76:79], v1 offset:21504
ds_read_b128 v[80:83], v1 offset:22528
ds_read_b128 v[84:87], v1 offset:23552
v_mfma_f32_32x32x16_bf16 v[32:47], v[92:95], a[20:23], v[32:47]
v_mfma_f32_32x32x16_bf16 v[48:63], a[20:23], v[96:99], v[48:63]
buffer_load_dwordx4 a[88:91], v1, s[8:11], s26 offen offset:2048 sc1
s_waitcnt lgkmcnt(3)
v_mfma_f32_32x32x16_bf16 v[16:31], v[64:67], a[24:27], v[16:31]
ds_read_b128 v[88:91], v1 offset:24576
ds_read_b128 v[92:95], v1 offset:25600
ds_read_b128 v[96:99], v1 offset:26624
v_mfma_f32_32x32x16_bf16 v[32:47], v[68:71], a[24:27], v[32:47]
v_mfma_f32_32x32x16_bf16 v[48:63], a[24:27], v[72:75], v[48:63]
buffer_load_dwordx4 a[92:95], v1, s[8:11], s26 offen offset:3072 sc1
s_waitcnt lgkmcnt(3)
v_mfma_f32_32x32x16_bf16 v[16:31], v[76:79], a[28:31], v[16:31]
ds_read_b128 v[64:67], v1 offset:27648
ds_read_b128 v[68:71], v1 offset:28672
ds_read_b128 v[72:75], v1 offset:29696
v_mfma_f32_32x32x16_bf16 v[32:47], v[80:83], a[28:31], v[32:47]
v_mfma_f32_32x32x16_bf16 v[48:63], a[28:31], v[84:87], v[48:63]
s_waitcnt vmcnt(12)
s_waitcnt lgkmcnt(3)
v_mfma_f32_32x32x16_bf16 v[16:31], v[88:91], a[32:35], v[16:31]
ds_read_b128 v[76:79], v1 offset:30720
ds_read_b128 v[80:83], v1 offset:31744
ds_read_b128 v[84:87], v1 offset:32768
s_add_u32 s26, s21, 24576
buffer_load_dwordx4 a[96:99], v1, s[8:11], s26 offen offset:0 sc1
v_mfma_f32_32x32x16_bf16 v[32:47], v[92:95], a[32:35], v[32:47]
v_mfma_f32_32x32x16_bf16 v[48:63], a[32:35], v[96:99], v[48:63]
buffer_load_dwordx4 a[100:103], v1, s[8:11], s26 offen offset:1024 sc1
s_waitcnt lgkmcnt(3)
v_mfma_f32_32x32x16_bf16 v[16:31], v[64:67], a[36:39], v[16:31]
ds_read_b128 v[88:91], v1 offset:33792
ds_read_b128 v[92:95], v1 offset:34816
ds_read_b128 v[96:99], v1 offset:35840
v_mfma_f32_32x32x16_bf16 v[32:47], v[68:71], a[36:39], v[32:47]
v_mfma_f32_32x32x16_bf16 v[48:63], a[36:39], v[72:75], v[48:63]
buffer_load_dwordx4 a[104:107], v1, s[8:11], s26 offen offset:2048 sc1
s_waitcnt lgkmcnt(3)
v_mfma_f32_32x32x16_bf16 v[16:31], v[76:79], a[40:43], v[16:31]
ds_read_b128 v[64:67], v1 offset:36864
ds_read_b128 v[68:71], v1 offset:37888
ds_read_b128 v[72:75], v1 offset:38912
v_mfma_f32_32x32x16_bf16 v[32:47], v[80:83], a[40:43], v[32:47]
v_mfma_f32_32x32x16_bf16 v[48:63], a[40:43], v[84:87], v[48:63]
buffer_load_dwordx4 a[108:111], v1, s[8:11], s26 offen offset:3072 sc1
s_waitcnt lgkmcnt(3)
v_mfma_f32_32x32x16_bf16 v[16:31], v[88:91], a[44:47], v[16:31]
ds_read_b128 v[76:79], v1 offset:39936
ds_read_b128 v[80:83], v1 offset:40960
ds_read_b128 v[84:87], v1 offset:41984
v_mfma_f32_32x32x16_bf16 v[32:47], v[92:95], a[44:47], v[32:47]
v_mfma_f32_32x32x16_bf16 v[48:63], a[44:47], v[96:99], v[48:63]
s_waitcnt vmcnt(12)
s_waitcnt lgkmcnt(3)
v_mfma_f32_32x32x16_bf16 v[16:31], v[64:67], a[48:51], v[16:31]
ds_read_b128 v[88:91], v1 offset:43008
ds_read_b128 v[92:95], v1 offset:44032
ds_read_b128 v[96:99], v1 offset:45056
v_and_b32 v4, 31, v0
v_lshlrev_b32 v4, 3, v4
v_lshrrev_b32 v5, 5, v0
v_mul_u32_u24 v5, 1792, v5
v_add_u32 v4, v4, v5
buffer_load_dwordx2 v[100:101], v4, s[8:11], s27 offen offset:0 sc1
buffer_load_dwordx2 v[102:103], v4, s[8:11], s27 offen offset:256 sc1
buffer_load_dwordx2 v[104:105], v4, s[8:11], s27 offen offset:512 sc1
buffer_load_dwordx2 v[106:107], v4, s[8:11], s27 offen offset:768 sc1
buffer_load_dwordx2 v[108:109], v4, s[8:11], s27 offen offset:1024 sc1
buffer_load_dwordx2 v[110:111], v4, s[8:11], s27 offen offset:1280 sc1
buffer_load_dwordx2 v[112:113], v4, s[8:11], s27 offen offset:1536 sc1
v_mfma_f32_32x32x16_bf16 v[32:47], v[68:71], a[48:51], v[32:47]
buffer_load_dwordx4 v[116:119], v6, s[8:11], s28 offen offset:0 sc1
v_mfma_f32_32x32x16_bf16 v[48:63], a[48:51], v[72:75], v[48:63]
buffer_load_dwordx4 v[120:123], v6, s[8:11], s28 offen offset:16 sc1
s_waitcnt lgkmcnt(3)
v_mfma_f32_32x32x16_bf16 v[16:31], v[76:79], a[52:55], v[16:31]
ds_read_b128 v[64:67], v1 offset:46080
ds_read_b128 v[68:71], v1 offset:47104
ds_read_b128 v[72:75], v1 offset:48128
buffer_load_dwordx4 v[124:127], v6, s[8:11], s28 offen offset:32 sc1
v_mfma_f32_32x32x16_bf16 v[32:47], v[80:83], a[52:55], v[32:47]
buffer_load_dwordx4 v[128:131], v6, s[8:11], s28 offen offset:48 sc1
v_mfma_f32_32x32x16_bf16 v[48:63], a[52:55], v[84:87], v[48:63]
buffer_load_dwordx4 v[132:135], v6, s[8:11], s28 offen offset:128 sc1
s_waitcnt lgkmcnt(3)
v_mfma_f32_32x32x16_bf16 v[16:31], v[88:91], a[56:59], v[16:31]
ds_read_b128 v[76:79], v1 offset:49152
ds_read_b128 v[80:83], v1 offset:50176
ds_read_b128 v[84:87], v1 offset:51200
buffer_load_dwordx4 v[136:139], v6, s[8:11], s28 offen offset:144 sc1
v_mfma_f32_32x32x16_bf16 v[32:47], v[92:95], a[56:59], v[32:47]
buffer_load_dwordx4 v[140:143], v6, s[8:11], s28 offen offset:160 sc1
v_mfma_f32_32x32x16_bf16 v[48:63], a[56:59], v[96:99], v[48:63]
buffer_load_dwordx4 v[144:147], v6, s[8:11], s28 offen offset:176 sc1
s_waitcnt lgkmcnt(3)
v_mfma_f32_32x32x16_bf16 v[16:31], v[64:67], a[60:63], v[16:31]
ds_read_b128 v[88:91], v1 offset:52224
ds_read_b128 v[92:95], v1 offset:53248
ds_read_b128 v[96:99], v1 offset:54272
buffer_load_dword v8, v7, s[8:11], s28 offen offset:256
v_mfma_f32_32x32x16_bf16 v[32:47], v[68:71], a[60:63], v[32:47]
v_mfma_f32_32x32x16_bf16 v[48:63], a[60:63], v[72:75], v[48:63]
s_waitcnt vmcnt(24)
s_waitcnt lgkmcnt(3)
v_mfma_f32_32x32x16_bf16 v[16:31], v[76:79], a[64:67], v[16:31]
ds_read_b128 v[64:67], v1 offset:55296
ds_read_b128 v[68:71], v1 offset:56320
ds_read_b128 v[72:75], v1 offset:57344
v_mfma_f32_32x32x16_bf16 v[32:47], v[80:83], a[64:67], v[32:47]
v_mfma_f32_32x32x16_bf16 v[48:63], a[64:67], v[84:87], v[48:63]
s_waitcnt lgkmcnt(3)
v_mfma_f32_32x32x16_bf16 v[16:31], v[88:91], a[68:71], v[16:31]
ds_read_b128 v[76:79], v1 offset:58368
ds_read_b128 v[80:83], v1 offset:59392
ds_read_b128 v[84:87], v1 offset:60416
v_mfma_f32_32x32x16_bf16 v[32:47], v[92:95], a[68:71], v[32:47]
v_mfma_f32_32x32x16_bf16 v[48:63], a[68:71], v[96:99], v[48:63]
s_waitcnt lgkmcnt(3)
v_mfma_f32_32x32x16_bf16 v[16:31], v[64:67], a[72:75], v[16:31]
ds_read_b128 v[88:91], v1 offset:61440
ds_read_b128 v[92:95], v1 offset:62464
ds_read_b128 v[96:99], v1 offset:63488
v_mfma_f32_32x32x16_bf16 v[32:47], v[68:71], a[72:75], v[32:47]
v_mfma_f32_32x32x16_bf16 v[48:63], a[72:75], v[72:75], v[48:63]
s_waitcnt lgkmcnt(3)
v_mfma_f32_32x32x16_bf16 v[16:31], v[76:79], a[76:79], v[16:31]
ds_read_b128 v[64:67], v1 offset:64512
ds_read_b128 v[68:71], v2 offset:0
ds_read_b128 v[72:75], v2 offset:1024
v_mfma_f32_32x32x16_bf16 v[32:47], v[80:83], a[76:79], v[32:47]
v_mfma_f32_32x32x16_bf16 v[48:63], a[76:79], v[84:87], v[48:63]
s_waitcnt vmcnt(20)
s_waitcnt lgkmcnt(3)
v_mfma_f32_32x32x16_bf16 v[16:31], v[88:91], a[80:83], v[16:31]
ds_read_b128 v[76:79], v2 offset:2048
ds_read_b128 v[80:83], v2 offset:3072
ds_read_b128 v[84:87], v2 offset:4096
v_mfma_f32_32x32x16_bf16 v[32:47], v[92:95], a[80:83], v[32:47]
v_mfma_f32_32x32x16_bf16 v[48:63], a[80:83], v[96:99], v[48:63]
s_waitcnt lgkmcnt(3)
v_mfma_f32_32x32x16_bf16 v[16:31], v[64:67], a[84:87], v[16:31]
ds_read_b128 v[88:91], v2 offset:5120
ds_read_b128 v[92:95], v2 offset:6144
ds_read_b128 v[96:99], v2 offset:7168
v_mfma_f32_32x32x16_bf16 v[32:47], v[68:71], a[84:87], v[32:47]
v_mfma_f32_32x32x16_bf16 v[48:63], a[84:87], v[72:75], v[48:63]
s_waitcnt lgkmcnt(3)
v_mfma_f32_32x32x16_bf16 v[16:31], v[76:79], a[88:91], v[16:31]
ds_read_b128 v[64:67], v2 offset:8192
ds_read_b128 v[68:71], v2 offset:9216
ds_read_b128 v[72:75], v2 offset:10240
v_mfma_f32_32x32x16_bf16 v[32:47], v[80:83], a[88:91], v[32:47]
v_mfma_f32_32x32x16_bf16 v[48:63], a[88:91], v[84:87], v[48:63]
s_waitcnt lgkmcnt(3)
v_mfma_f32_32x32x16_bf16 v[16:31], v[88:91], a[92:95], v[16:31]
ds_read_b128 v[76:79], v2 offset:11264
ds_read_b128 v[80:83], v2 offset:12288
ds_read_b128 v[84:87], v2 offset:13312
v_mfma_f32_32x32x16_bf16 v[32:47], v[92:95], a[92:95], v[32:47]
v_mfma_f32_32x32x16_bf16 v[48:63], a[92:95], v[96:99], v[48:63]
s_waitcnt vmcnt(16)
s_waitcnt lgkmcnt(3)
v_mfma_f32_32x32x16_bf16 v[16:31], v[64:67], a[96:99], v[16:31]
ds_read_b128 v[88:91], v2 offset:14336
ds_read_b128 v[92:95], v2 offset:15360
ds_read_b128 v[96:99], v2 offset:16384
v_mfma_f32_32x32x16_bf16 v[32:47], v[68:71], a[96:99], v[32:47]
v_mfma_f32_32x32x16_bf16 v[48:63], a[96:99], v[72:75], v[48:63]
s_waitcnt lgkmcnt(3)
v_mfma_f32_32x32x16_bf16 v[16:31], v[76:79], a[100:103], v[16:31]
ds_read_b128 v[64:67], v2 offset:17408
ds_read_b128 v[68:71], v2 offset:18432
ds_read_b128 v[72:75], v2 offset:19456
v_mfma_f32_32x32x16_bf16 v[32:47], v[80:83], a[100:103], v[32:47]
v_mfma_f32_32x32x16_bf16 v[48:63], a[100:103], v[84:87], v[48:63]
s_waitcnt lgkmcnt(3)
v_mfma_f32_32x32x16_bf16 v[16:31], v[88:91], a[104:107], v[16:31]
v_mfma_f32_32x32x16_bf16 v[32:47], v[92:95], a[104:107], v[32:47]
v_mfma_f32_32x32x16_bf16 v[48:63], a[104:107], v[96:99], v[48:63]
s_waitcnt lgkmcnt(0)
v_mfma_f32_32x32x16_bf16 v[16:31], v[64:67], a[108:111], v[16:31]
v_mfma_f32_32x32x16_bf16 v[32:47], v[68:71], a[108:111], v[32:47]
v_mfma_f32_32x32x16_bf16 v[48:63], a[108:111], v[72:75], v[48:63]
s_waitcnt vmcnt(0)
v_add_f32 v100, v100, v102
v_add_f32 v101, v101, v103
v_add_f32 v100, v100, v104
v_add_f32 v101, v101, v105
v_add_f32 v100, v100, v106
v_add_f32 v101, v101, v107
v_add_f32 v100, v100, v108
v_add_f32 v101, v101, v109
v_add_f32 v100, v100, v110
v_add_f32 v101, v101, v111
v_add_f32 v100, v100, v112
v_add_f32 v101, v101, v113
v_mov_b32 v102, v100
v_mov_b32 v103, v101
s_nop 1
v_permlane32_swap_b32 v100, v102
v_permlane32_swap_b32 v101, v103
s_nop 1
v_add_f32 v100, v100, v102
v_add_f32 v101, v101, v103
v_mul_f32 v9, 0x3b124925, v100
v_mul_f32 v101, 0x3b124925, v101
v_fma_f32 v101, -v9, v9, v101
v_max_f32 v101, 0, v101
v_add_f32 v101, 0x3727c5ac, v101
v_rsq_f32 v10, v101
s_nop 0
v_mul_f32 v11, v9, v10
s_lshl_b32 s29, s3, 8
s_add_u32 s29, s29, 86016
v_lshrrev_b32 v12, 5, v0
v_lshl_add_u32 v13, v12, 7, v7
v_add_u32 v13, s29, v13
s_mov_b32 s30, 0
s_mov_b32 s31, -1
v_cndmask_b32 v14, v10, v11, s[30:31]
ds_write_b32 v13, v14
v_lshl_add_u32 v12, v12, 4, s29
s_waitcnt lgkmcnt(0)
ds_read_b128 v[148:151], v12 offset:0
ds_read_b128 v[164:167], v12 offset:128
ds_read_b128 v[152:155], v12 offset:32
ds_read_b128 v[168:171], v12 offset:160
ds_read_b128 v[156:159], v12 offset:64
ds_read_b128 v[172:175], v12 offset:192
ds_read_b128 v[160:163], v12 offset:96
ds_read_b128 v[176:179], v12 offset:224
v_mul_f32 v12, 0x3e8b97f6, v10
s_lshl_b32 s14, s41, 6
s_add_u32 s14, s14, s40
s_lshl_b32 s15, s14, 11
s_add_u32 s15, s15, 47185920
s_lshl_b32 s16, s14, 12
s_add_u32 s16, s16, 49283072
s_mov_b32 s34, 0x3f803f80
v_mov_b32 v15, s34
s_mov_b32 s32, 0x10000000
s_mov_b32 s33, 0x10000000
v_fma_f32 v32, -v9, v132, v32
v_fma_f32 v33, -v9, v133, v33
v_fma_f32 v34, -v9, v134, v34
v_fma_f32 v35, -v9, v135, v35
v_fma_f32 v36, -v9, v136, v36
v_fma_f32 v37, -v9, v137, v37
v_fma_f32 v38, -v9, v138, v38
v_fma_f32 v39, -v9, v139, v39
v_fma_f32 v40, -v9, v140, v40
v_fma_f32 v41, -v9, v141, v41
v_fma_f32 v42, -v9, v142, v42
v_fma_f32 v43, -v9, v143, v43
v_fma_f32 v44, -v9, v144, v44
v_fma_f32 v45, -v9, v145, v45
v_fma_f32 v46, -v9, v146, v46
v_fma_f32 v47, -v9, v147, v47
v_mul_f32 v32, v32, v10
v_mul_f32 v33, v33, v10
v_mul_f32 v34, v34, v10
v_mul_f32 v35, v35, v10
v_mul_f32 v36, v36, v10
v_mul_f32 v37, v37, v10
v_mul_f32 v38, v38, v10
v_mul_f32 v39, v39, v10
v_mul_f32 v40, v40, v10
v_mul_f32 v41, v41, v10
v_mul_f32 v42, v42, v10
v_mul_f32 v43, v43, v10
v_mul_f32 v44, v44, v10
v_mul_f32 v45, v45, v10
v_mul_f32 v46, v46, v10
v_mul_f32 v47, v47, v10
v_cvt_pk_bf16_f32 v188, v32, v33
v_cvt_pk_bf16_f32 v189, v34, v35
v_cvt_pk_bf16_f32 v190, v36, v37
v_cvt_pk_bf16_f32 v191, v38, v39
v_cvt_pk_bf16_f32 v192, v40, v41
v_cvt_pk_bf16_f32 v193, v42, v43
v_cvt_pk_bf16_f32 v194, v44, v45
v_cvt_pk_bf16_f32 v195, v46, v47
v_cndmask_b32 v194, v194, v15, s[30:31]
buffer_store_dwordx4 v[188:191], v1, s[8:11], s16 offen offset:0 sc1
buffer_store_dwordx4 v[192:195], v1, s[8:11], s16 offen offset:1024 sc1
s_waitcnt lgkmcnt(0)
v_mul_f32 v48, v48, v148
v_mul_f32 v49, v49, v149
v_mul_f32 v50, v50, v150
v_mul_f32 v51, v51, v151
v_mul_f32 v52, v52, v152
v_mul_f32 v53, v53, v153
v_mul_f32 v54, v54, v154
v_mul_f32 v55, v55, v155
v_mul_f32 v56, v56, v156
v_mul_f32 v57, v57, v157
v_mul_f32 v58, v58, v158
v_mul_f32 v59, v59, v159
v_mul_f32 v60, v60, v160
v_mul_f32 v61, v61, v161
v_mul_f32 v62, v62, v162
v_mul_f32 v63, v63, v163
v_fma_f32 v48, -v164, v8, v48
v_fma_f32 v49, -v165, v8, v49
v_fma_f32 v50, -v166, v8, v50
v_fma_f32 v51, -v167, v8, v51
v_fma_f32 v52, -v168, v8, v52
v_fma_f32 v53, -v169, v8, v53
v_fma_f32 v54, -v170, v8, v54
v_fma_f32 v55, -v171, v8, v55
v_fma_f32 v56, -v172, v8, v56
v_fma_f32 v57, -v173, v8, v57
v_fma_f32 v58, -v174, v8, v58
v_fma_f32 v59, -v175, v8, v59
v_fma_f32 v60, -v176, v8, v60
v_fma_f32 v61, -v177, v8, v61
v_fma_f32 v62, -v178, v8, v62
v_fma_f32 v63, -v179, v8, v63
v_cvt_pk_bf16_f32 v196, v48, v49
v_cvt_pk_bf16_f32 v197, v50, v51
v_cvt_pk_bf16_f32 v198, v52, v53
v_cvt_pk_bf16_f32 v199, v54, v55
v_cvt_pk_bf16_f32 v200, v56, v57
v_cvt_pk_bf16_f32 v201, v58, v59
v_cvt_pk_bf16_f32 v202, v60, v61
v_cvt_pk_bf16_f32 v203, v62, v63
v_cndmask_b32 v196, v196, v15, s[32:33]
v_cndmask_b32 v197, v197, v15, s[32:33]
v_cndmask_b32 v198, v198, v15, s[32:33]
v_cndmask_b32 v199, v199, v15, s[32:33]
v_cndmask_b32 v200, v200, v15, s[32:33]
v_cndmask_b32 v201, v201, v15, s[32:33]
v_cndmask_b32 v202, v202, v15, s[32:33]
v_cndmask_b32 v203, v203, v15, s[32:33]
buffer_store_dwordx4 v[196:199], v1, s[8:11], s16 offen offset:2048 sc1
buffer_store_dwordx4 v[200:203], v1, s[8:11], s16 offen offset:3072 sc1
v_fma_f32 v16, -v9, v116, v16
v_fma_f32 v17, -v9, v117, v17
v_fma_f32 v18, -v9, v118, v18
v_fma_f32 v19, -v9, v119, v19
v_fma_f32 v20, -v9, v120, v20
v_fma_f32 v21, -v9, v121, v21
v_fma_f32 v22, -v9, v122, v22
v_fma_f32 v23, -v9, v123, v23
v_fma_f32 v24, -v9, v124, v24
v_fma_f32 v25, -v9, v125, v25
v_fma_f32 v26, -v9, v126, v26
v_fma_f32 v27, -v9, v127, v27
v_fma_f32 v28, -v9, v128, v28
v_fma_f32 v29, -v9, v129, v29
v_fma_f32 v30, -v9, v130, v30
v_fma_f32 v31, -v9, v131, v31
v_mul_f32 v16, v16, v12
v_mul_f32 v17, v17, v12
v_mul_f32 v18, v18, v12
v_mul_f32 v19, v19, v12
v_mul_f32 v20, v20, v12
v_mul_f32 v21, v21, v12
v_mul_f32 v22, v22, v12
v_mul_f32 v23, v23, v12
v_mul_f32 v24, v24, v12
v_mul_f32 v25, v25, v12
v_mul_f32 v26, v26, v12
v_mul_f32 v27, v27, v12
v_mul_f32 v28, v28, v12
v_mul_f32 v29, v29, v12
v_mul_f32 v30, v30, v12
v_mul_f32 v31, v31, v12
v_cvt_pk_bf16_f32 v180, v16, v17
v_cvt_pk_bf16_f32 v181, v18, v19
v_cvt_pk_bf16_f32 v182, v20, v21
v_cvt_pk_bf16_f32 v183, v22, v23
v_cvt_pk_bf16_f32 v184, v24, v25
v_cvt_pk_bf16_f32 v185, v26, v27
v_cvt_pk_bf16_f32 v186, v28, v29
v_cvt_pk_bf16_f32 v187, v30, v31
buffer_store_dwordx4 v[180:183], v1, s[8:11], s15 offen offset:0 sc1
buffer_store_dwordx4 v[184:187], v1, s[8:11], s15 offen offset:1024 sc1
s_lshl_b32 s13, s41, 7
s_add_u32 s13, s13, 30025728
s_waitcnt vmcnt(0)
s_barrier
s_cmp_lg_u32 s3, 0
s_cbranch_scc1 main_kernel_sg12
v_mov_b32 v4, 1
v_mov_b32 v5, 0
s_mov_b64 exec, 1
buffer_atomic_add v4, v5, s[8:11], s13 offen sc1
s_mov_b64 exec, -1
main_kernel_sg12:
s_lshl_b32 s14, s42, 6
s_lshl_b32 s15, s43, 2
s_add_u32 s15, s15, s14
s_lshl_b32 s15, s15, 11
s_add_u32 s15, s15, 47185920
s_add_u32 s16, s15, 4096
s_lshl_b32 s17, s3, 4
s_add_u32 s17, s17, s14
s_lshl_b32 s17, s17, 12
s_add_u32 s17, s17, 49283072
s_mov_b32 s19, 0
s_lshl_b32 s13, s42, 7
s_add_u32 s13, s13, 30025728
s_cmp_lg_u32 s3, 0
s_cbranch_scc1 main_kernel_wt13x
s_mov_b32 s60, 0
v_mov_b32 v5, 0
main_kernel_wt13:
buffer_load_dword v4, v5, s[8:11], s13 offen sc1
s_add_u32 s60, s60, 1
s_waitcnt vmcnt(0)
v_readfirstlane_b32 s61, v4
s_cmp_ge_u32 s61, 16
s_cbranch_scc1 main_kernel_wt13x
s_cmp_gt_u32 s60, 40000
s_cbranch_scc1 main_kernel_end
s_sleep 1
s_branch main_kernel_wt13
main_kernel_wt13x:
s_waitcnt vmcnt(0)
s_barrier
s_add_u32 s18, s17, 0
buffer_load_dwordx4 v[152:155], v1, s[8:11], s18 offen offset:0 sc1
buffer_load_dwordx4 v[16:19], v1, s[8:11], s15 offen offset:0 sc1
buffer_load_dwordx4 v[156:159], v1, s[8:11], s18 offen offset:1024 sc1
buffer_load_dwordx4 v[20:23], v1, s[8:11], s15 offen offset:1024 sc1
buffer_load_dwordx4 v[24:27], v1, s[8:11], s15 offen offset:2048 sc1
buffer_load_dwordx4 v[28:31], v1, s[8:11], s15 offen offset:3072 sc1
buffer_load_dwordx4 v[160:163], v1, s[8:11], s18 offen offset:2048 sc1
buffer_load_dwordx4 v[164:167], v1, s[8:11], s18 offen offset:3072 sc1
buffer_load_dwordx4 v[32:35], v1, s[8:11], s16 offen offset:0 sc1
buffer_load_dwordx4 v[36:39], v1, s[8:11], s16 offen offset:1024 sc1
buffer_load_dwordx4 v[40:43], v1, s[8:11], s16 offen offset:2048 sc1
buffer_load_dwordx4 v[44:47], v1, s[8:11], s16 offen offset:3072 sc1
main_kernel_b1_go:
s_add_u32 s18, s17, 4096
buffer_load_dwordx4 v[168:171], v1, s[8:11], s18 offen offset:0 sc1
buffer_load_dwordx4 v[172:175], v1, s[8:11], s18 offen offset:1024 sc1
buffer_load_dwordx4 v[176:179], v1, s[8:11], s18 offen offset:2048 sc1
buffer_load_dwordx4 v[180:183], v1, s[8:11], s18 offen offset:3072 sc1
s_waitcnt vmcnt(13)
s_waitcnt vmcnt(12)
v_mfma_f32_32x32x16_bf16 v[112:127], v[152:155], v[16:19], 0
v_mfma_f32_32x32x16_bf16 v[112:127], v[156:159], v[20:23], v[112:127]
s_nop 10
s_waitcnt vmcnt(10)
v_mfma_f32_32x32x16_bf16 v[128:143], v[152:155], v[24:27], 0
v_exp_f32 v112, v112
v_exp_f32 v113, v113
v_exp_f32 v114, v114
v_exp_f32 v115, v115
v_cvt_pk_bf16_f32 v144, v112, v113
v_cvt_pk_bf16_f32 v145, v114, v115
v_exp_f32 v116, v116
v_exp_f32 v117, v117
v_exp_f32 v118, v118
v_exp_f32 v119, v119
v_cvt_pk_bf16_f32 v146, v116, v117
v_cvt_pk_bf16_f32 v147, v118, v119
v_mfma_f32_32x32x16_bf16 v[128:143], v[156:159], v[28:31], v[128:143]
s_add_u32 s18, s17, 8192
buffer_load_dwordx4 v[184:187], v1, s[8:11], s18 offen offset:0 sc1
v_exp_f32 v120, v120
v_exp_f32 v121, v121
v_exp_f32 v122, v122
v_exp_f32 v123, v123
v_cvt_pk_bf16_f32 v148, v120, v121
v_cvt_pk_bf16_f32 v149, v122, v123
s_waitcnt vmcnt(9)
v_mfma_f32_32x32x16_bf16 v[48:63], v[160:163], v[144:147], 0
buffer_load_dwordx4 v[188:191], v1, s[8:11], s18 offen offset:1024 sc1
v_exp_f32 v124, v124
v_exp_f32 v125, v125
v_exp_f32 v126, v126
v_exp_f32 v127, v127
v_cvt_pk_bf16_f32 v150, v124, v125
v_cvt_pk_bf16_f32 v151, v126, v127
s_waitcnt vmcnt(8)
v_mfma_f32_32x32x16_bf16 v[112:127], v[152:155], v[32:35], 0
v_exp_f32 v128, v128
v_exp_f32 v129, v129
v_exp_f32 v130, v130
v_exp_f32 v131, v131
v_cvt_pk_bf16_f32 v144, v128, v129
v_cvt_pk_bf16_f32 v145, v130, v131
v_mfma_f32_32x32x16_bf16 v[48:63], v[164:167], v[148:151], v[48:63]
v_exp_f32 v132, v132
v_exp_f32 v133, v133
v_exp_f32 v134, v134
v_exp_f32 v135, v135
v_cvt_pk_bf16_f32 v146, v132, v133
v_cvt_pk_bf16_f32 v147, v134, v135
v_mfma_f32_32x32x16_bf16 v[112:127], v[156:159], v[36:39], v[112:127]
buffer_load_dwordx4 v[192:195], v1, s[8:11], s18 offen offset:2048 sc1
v_exp_f32 v136, v136
v_exp_f32 v137, v137
v_exp_f32 v138, v138
v_exp_f32 v139, v139
v_cvt_pk_bf16_f32 v148, v136, v137
v_cvt_pk_bf16_f32 v149, v138, v139
v_mfma_f32_32x32x16_bf16 v[64:79], v[160:163], v[144:147], 0
buffer_load_dwordx4 v[196:199], v1, s[8:11], s18 offen offset:3072 sc1
v_exp_f32 v140, v140
v_exp_f32 v141, v141
v_exp_f32 v142, v142
v_exp_f32 v143, v143
v_cvt_pk_bf16_f32 v150, v140, v141
v_cvt_pk_bf16_f32 v151, v142, v143
s_waitcnt vmcnt(8)
v_mfma_f32_32x32x16_bf16 v[128:143], v[152:155], v[40:43], 0
v_exp_f32 v112, v112
v_exp_f32 v113, v113
v_exp_f32 v114, v114
v_exp_f32 v115, v115
v_cvt_pk_bf16_f32 v144, v112, v113
v_cvt_pk_bf16_f32 v145, v114, v115
v_mfma_f32_32x32x16_bf16 v[64:79], v[164:167], v[148:151], v[64:79]
v_exp_f32 v116, v116
v_exp_f32 v117, v117
v_exp_f32 v118, v118
v_exp_f32 v119, v119
v_cvt_pk_bf16_f32 v146, v116, v117
v_cvt_pk_bf16_f32 v147, v118, v119
v_mfma_f32_32x32x16_bf16 v[128:143], v[156:159], v[44:47], v[128:143]
s_add_u32 s18, s17, 12288
buffer_load_dwordx4 v[200:203], v1, s[8:11], s18 offen offset:0 sc1
v_exp_f32 v120, v120
v_exp_f32 v121, v121
v_exp_f32 v122, v122
v_exp_f32 v123, v123
v_cvt_pk_bf16_f32 v148, v120, v121
v_cvt_pk_bf16_f32 v149, v122, v123
v_mfma_f32_32x32x16_bf16 v[80:95], v[160:163], v[144:147], 0
buffer_load_dwordx4 v[204:207], v1, s[8:11], s18 offen offset:1024 sc1
v_exp_f32 v124, v124
v_exp_f32 v125, v125
v_exp_f32 v126, v126
v_exp_f32 v127, v127
v_cvt_pk_bf16_f32 v150, v124, v125
v_cvt_pk_bf16_f32 v151, v126, v127
s_waitcnt vmcnt(8)
v_mfma_f32_32x32x16_bf16 v[112:127], v[168:171], v[16:19], 0
v_exp_f32 v128, v128
v_exp_f32 v129, v129
v_exp_f32 v130, v130
v_exp_f32 v131, v131
v_cvt_pk_bf16_f32 v144, v128, v129
v_cvt_pk_bf16_f32 v145, v130, v131
v_mfma_f32_32x32x16_bf16 v[80:95], v[164:167], v[148:151], v[80:95]
v_exp_f32 v132, v132
v_exp_f32 v133, v133
v_exp_f32 v134, v134
v_exp_f32 v135, v135
v_cvt_pk_bf16_f32 v146, v132, v133
v_cvt_pk_bf16_f32 v147, v134, v135
v_mfma_f32_32x32x16_bf16 v[112:127], v[172:175], v[20:23], v[112:127]
buffer_load_dwordx4 v[208:211], v1, s[8:11], s18 offen offset:2048 sc1
v_exp_f32 v136, v136
v_exp_f32 v137, v137
v_exp_f32 v138, v138
v_exp_f32 v139, v139
v_cvt_pk_bf16_f32 v148, v136, v137
v_cvt_pk_bf16_f32 v149, v138, v139
v_mfma_f32_32x32x16_bf16 v[96:111], v[160:163], v[144:147], 0
buffer_load_dwordx4 v[212:215], v1, s[8:11], s18 offen offset:3072 sc1
v_exp_f32 v140, v140
v_exp_f32 v141, v141
v_exp_f32 v142, v142
v_exp_f32 v143, v143
v_cvt_pk_bf16_f32 v150, v140, v141
v_cvt_pk_bf16_f32 v151, v142, v143
v_mfma_f32_32x32x16_bf16 v[128:143], v[168:171], v[24:27], 0
v_exp_f32 v112, v112
v_exp_f32 v113, v113
v_exp_f32 v114, v114
v_exp_f32 v115, v115
v_cvt_pk_bf16_f32 v144, v112, v113
v_cvt_pk_bf16_f32 v145, v114, v115
v_mfma_f32_32x32x16_bf16 v[96:111], v[164:167], v[148:151], v[96:111]
v_exp_f32 v116, v116
v_exp_f32 v117, v117
v_exp_f32 v118, v118
v_exp_f32 v119, v119
v_cvt_pk_bf16_f32 v146, v116, v117
v_cvt_pk_bf16_f32 v147, v118, v119
v_mfma_f32_32x32x16_bf16 v[128:143], v[172:175], v[28:31], v[128:143]
s_add_u32 s18, s17, 16384
buffer_load_dwordx4 v[216:219], v1, s[8:11], s18 offen offset:0 sc1
v_exp_f32 v120, v120
v_exp_f32 v121, v121
v_exp_f32 v122, v122
v_exp_f32 v123, v123
v_cvt_pk_bf16_f32 v148, v120, v121
v_cvt_pk_bf16_f32 v149, v122, v123
s_waitcnt vmcnt(9)
v_mfma_f32_32x32x16_bf16 v[48:63], v[176:179], v[144:147], v[48:63]
buffer_load_dwordx4 v[220:223], v1, s[8:11], s18 offen offset:1024 sc1
v_exp_f32 v124, v124
v_exp_f32 v125, v125
v_exp_f32 v126, v126
v_exp_f32 v127, v127
v_cvt_pk_bf16_f32 v150, v124, v125
v_cvt_pk_bf16_f32 v151, v126, v127
v_mfma_f32_32x32x16_bf16 v[112:127], v[168:171], v[32:35], 0
v_exp_f32 v128, v128
v_exp_f32 v129, v129
v_exp_f32 v130, v130
v_exp_f32 v131, v131
v_cvt_pk_bf16_f32 v144, v128, v129
v_cvt_pk_bf16_f32 v145, v130, v131
v_mfma_f32_32x32x16_bf16 v[48:63], v[180:183], v[148:151], v[48:63]
v_exp_f32 v132, v132
v_exp_f32 v133, v133
v_exp_f32 v134, v134
v_exp_f32 v135, v135
v_cvt_pk_bf16_f32 v146, v132, v133
v_cvt_pk_bf16_f32 v147, v134, v135
v_mfma_f32_32x32x16_bf16 v[112:127], v[172:175], v[36:39], v[112:127]
buffer_load_dwordx4 v[224:227], v1, s[8:11], s18 offen offset:2048 sc1
v_exp_f32 v136, v136
v_exp_f32 v137, v137
v_exp_f32 v138, v138
v_exp_f32 v139, v139
v_cvt_pk_bf16_f32 v148, v136, v137
v_cvt_pk_bf16_f32 v149, v138, v139
v_mfma_f32_32x32x16_bf16 v[64:79], v[176:179], v[144:147], v[64:79]
buffer_load_dwordx4 v[228:231], v1, s[8:11], s18 offen offset:3072 sc1
v_exp_f32 v140, v140
v_exp_f32 v141, v141
v_exp_f32 v142, v142
v_exp_f32 v143, v143
v_cvt_pk_bf16_f32 v150, v140, v141
v_cvt_pk_bf16_f32 v151, v142, v143
v_mfma_f32_32x32x16_bf16 v[128:143], v[168:171], v[40:43], 0
v_exp_f32 v112, v112
v_exp_f32 v113, v113
v_exp_f32 v114, v114
v_exp_f32 v115, v115
v_cvt_pk_bf16_f32 v144, v112, v113
v_cvt_pk_bf16_f32 v145, v114, v115
v_mfma_f32_32x32x16_bf16 v[64:79], v[180:183], v[148:151], v[64:79]
v_exp_f32 v116, v116
v_exp_f32 v117, v117
v_exp_f32 v118, v118
v_exp_f32 v119, v119
v_cvt_pk_bf16_f32 v146, v116, v117
v_cvt_pk_bf16_f32 v147, v118, v119
v_mfma_f32_32x32x16_bf16 v[128:143], v[172:175], v[44:47], v[128:143]
s_add_u32 s18, s17, 20480
buffer_load_dwordx4 v[232:235], v1, s[8:11], s18 offen offset:0 sc1
v_exp_f32 v120, v120
v_exp_f32 v121, v121
v_exp_f32 v122, v122
v_exp_f32 v123, v123
v_cvt_pk_bf16_f32 v148, v120, v121
v_cvt_pk_bf16_f32 v149, v122, v123
v_mfma_f32_32x32x16_bf16 v[80:95], v[176:179], v[144:147], v[80:95]
buffer_load_dwordx4 v[236:239], v1, s[8:11], s18 offen offset:1024 sc1
v_exp_f32 v124, v124
v_exp_f32 v125, v125
v_exp_f32 v126, v126
v_exp_f32 v127, v127
v_cvt_pk_bf16_f32 v150, v124, v125
v_cvt_pk_bf16_f32 v151, v126, v127
s_waitcnt vmcnt(12)
v_mfma_f32_32x32x16_bf16 v[112:127], v[184:187], v[16:19], 0
v_exp_f32 v128, v128
v_exp_f32 v129, v129
v_exp_f32 v130, v130
v_exp_f32 v131, v131
v_cvt_pk_bf16_f32 v144, v128, v129
v_cvt_pk_bf16_f32 v145, v130, v131
v_mfma_f32_32x32x16_bf16 v[80:95], v[180:183], v[148:151], v[80:95]
v_exp_f32 v132, v132
v_exp_f32 v133, v133
v_exp_f32 v134, v134
v_exp_f32 v135, v135
v_cvt_pk_bf16_f32 v146, v132, v133
v_cvt_pk_bf16_f32 v147, v134, v135
v_mfma_f32_32x32x16_bf16 v[112:127], v[188:191], v[20:23], v[112:127]
buffer_load_dwordx4 v[240:243], v1, s[8:11], s18 offen offset:2048 sc1
v_exp_f32 v136, v136
v_exp_f32 v137, v137
v_exp_f32 v138, v138
v_exp_f32 v139, v139
v_cvt_pk_bf16_f32 v148, v136, v137
v_cvt_pk_bf16_f32 v149, v138, v139
v_mfma_f32_32x32x16_bf16 v[96:111], v[176:179], v[144:147], v[96:111]
buffer_load_dwordx4 v[244:247], v1, s[8:11], s18 offen offset:3072 sc1
v_exp_f32 v140, v140
v_exp_f32 v141, v141
v_exp_f32 v142, v142
v_exp_f32 v143, v143
v_cvt_pk_bf16_f32 v150, v140, v141
v_cvt_pk_bf16_f32 v151, v142, v143
v_mfma_f32_32x32x16_bf16 v[128:143], v[184:187], v[24:27], 0
v_exp_f32 v112, v112
v_exp_f32 v113, v113
v_exp_f32 v114, v114
v_exp_f32 v115, v115
v_cvt_pk_bf16_f32 v144, v112, v113
v_cvt_pk_bf16_f32 v145, v114, v115
v_mfma_f32_32x32x16_bf16 v[96:111], v[180:183], v[148:151], v[96:111]
v_exp_f32 v116, v116
v_exp_f32 v117, v117
v_exp_f32 v118, v118
v_exp_f32 v119, v119
v_cvt_pk_bf16_f32 v146, v116, v117
v_cvt_pk_bf16_f32 v147, v118, v119
v_mfma_f32_32x32x16_bf16 v[128:143], v[188:191], v[28:31], v[128:143]
s_add_u32 s18, s17, 24576
buffer_load_dwordx4 v[152:155], v1, s[8:11], s18 offen offset:0 sc1
v_exp_f32 v120, v120
v_exp_f32 v121, v121
v_exp_f32 v122, v122
v_exp_f32 v123, v123
v_cvt_pk_bf16_f32 v148, v120, v121
v_cvt_pk_bf16_f32 v149, v122, v123
s_waitcnt vmcnt(13)
v_mfma_f32_32x32x16_bf16 v[48:63], v[192:195], v[144:147], v[48:63]
buffer_load_dwordx4 v[156:159], v1, s[8:11], s18 offen offset:1024 sc1
v_exp_f32 v124, v124
v_exp_f32 v125, v125
v_exp_f32 v126, v126
v_exp_f32 v127, v127
v_cvt_pk_bf16_f32 v150, v124, v125
v_cvt_pk_bf16_f32 v151, v126, v127
v_mfma_f32_32x32x16_bf16 v[112:127], v[184:187], v[32:35], 0
v_exp_f32 v128, v128
v_exp_f32 v129, v129
v_exp_f32 v130, v130
v_exp_f32 v131, v131
v_cvt_pk_bf16_f32 v144, v128, v129
v_cvt_pk_bf16_f32 v145, v130, v131
v_mfma_f32_32x32x16_bf16 v[48:63], v[196:199], v[148:151], v[48:63]
v_exp_f32 v132, v132
v_exp_f32 v133, v133
v_exp_f32 v134, v134
v_exp_f32 v135, v135
v_cvt_pk_bf16_f32 v146, v132, v133
v_cvt_pk_bf16_f32 v147, v134, v135
v_mfma_f32_32x32x16_bf16 v[112:127], v[188:191], v[36:39], v[112:127]
buffer_load_dwordx4 v[160:163], v1, s[8:11], s18 offen offset:2048 sc1
v_exp_f32 v136, v136
v_exp_f32 v137, v137
v_exp_f32 v138, v138
v_exp_f32 v139, v139
v_cvt_pk_bf16_f32 v148, v136, v137
v_cvt_pk_bf16_f32 v149, v138, v139
v_mfma_f32_32x32x16_bf16 v[64:79], v[192:195], v[144:147], v[64:79]
buffer_load_dwordx4 v[164:167], v1, s[8:11], s18 offen offset:3072 sc1
v_exp_f32 v140, v140
v_exp_f32 v141, v141
v_exp_f32 v142, v142
v_exp_f32 v143, v143
v_cvt_pk_bf16_f32 v150, v140, v141
v_cvt_pk_bf16_f32 v151, v142, v143
v_mfma_f32_32x32x16_bf16 v[128:143], v[184:187], v[40:43], 0
v_exp_f32 v112, v112
v_exp_f32 v113, v113
v_exp_f32 v114, v114
v_exp_f32 v115, v115
v_cvt_pk_bf16_f32 v144, v112, v113
v_cvt_pk_bf16_f32 v145, v114, v115
v_mfma_f32_32x32x16_bf16 v[64:79], v[196:199], v[148:151], v[64:79]
v_exp_f32 v116, v116
v_exp_f32 v117, v117
v_exp_f32 v118, v118
v_exp_f32 v119, v119
v_cvt_pk_bf16_f32 v146, v116, v117
v_cvt_pk_bf16_f32 v147, v118, v119
v_mfma_f32_32x32x16_bf16 v[128:143], v[188:191], v[44:47], v[128:143]
s_add_u32 s18, s17, 28672
buffer_load_dwordx4 v[168:171], v1, s[8:11], s18 offen offset:0 sc1
v_exp_f32 v120, v120
v_exp_f32 v121, v121
v_exp_f32 v122, v122
v_exp_f32 v123, v123
v_cvt_pk_bf16_f32 v148, v120, v121
v_cvt_pk_bf16_f32 v149, v122, v123
v_mfma_f32_32x32x16_bf16 v[80:95], v[192:195], v[144:147], v[80:95]
buffer_load_dwordx4 v[172:175], v1, s[8:11], s18 offen offset:1024 sc1
v_exp_f32 v124, v124
v_exp_f32 v125, v125
v_exp_f32 v126, v126
v_exp_f32 v127, v127
v_cvt_pk_bf16_f32 v150, v124, v125
v_cvt_pk_bf16_f32 v151, v126, v127
s_waitcnt vmcnt(16)
v_mfma_f32_32x32x16_bf16 v[112:127], v[200:203], v[16:19], 0
v_exp_f32 v128, v128
v_exp_f32 v129, v129
v_exp_f32 v130, v130
v_exp_f32 v131, v131
v_cvt_pk_bf16_f32 v144, v128, v129
v_cvt_pk_bf16_f32 v145, v130, v131
v_mfma_f32_32x32x16_bf16 v[80:95], v[196:199], v[148:151], v[80:95]
v_exp_f32 v132, v132
v_exp_f32 v133, v133
v_exp_f32 v134, v134
v_exp_f32 v135, v135
v_cvt_pk_bf16_f32 v146, v132, v133
v_cvt_pk_bf16_f32 v147, v134, v135
v_mfma_f32_32x32x16_bf16 v[112:127], v[204:207], v[20:23], v[112:127]
buffer_load_dwordx4 v[176:179], v1, s[8:11], s18 offen offset:2048 sc1
v_exp_f32 v136, v136
v_exp_f32 v137, v137
v_exp_f32 v138, v138
v_exp_f32 v139, v139
v_cvt_pk_bf16_f32 v148, v136, v137
v_cvt_pk_bf16_f32 v149, v138, v139
v_mfma_f32_32x32x16_bf16 v[96:111], v[192:195], v[144:147], v[96:111]
buffer_load_dwordx4 v[180:183], v1, s[8:11], s18 offen offset:3072 sc1
v_exp_f32 v140, v140
v_exp_f32 v141, v141
v_exp_f32 v142, v142
v_exp_f32 v143, v143
v_cvt_pk_bf16_f32 v150, v140, v141
v_cvt_pk_bf16_f32 v151, v142, v143
v_mfma_f32_32x32x16_bf16 v[128:143], v[200:203], v[24:27], 0
v_exp_f32 v112, v112
v_exp_f32 v113, v113
v_exp_f32 v114, v114
v_exp_f32 v115, v115
v_cvt_pk_bf16_f32 v144, v112, v113
v_cvt_pk_bf16_f32 v145, v114, v115
v_mfma_f32_32x32x16_bf16 v[96:111], v[196:199], v[148:151], v[96:111]
v_exp_f32 v116, v116
v_exp_f32 v117, v117
v_exp_f32 v118, v118
v_exp_f32 v119, v119
v_cvt_pk_bf16_f32 v146, v116, v117
v_cvt_pk_bf16_f32 v147, v118, v119
v_mfma_f32_32x32x16_bf16 v[128:143], v[204:207], v[28:31], v[128:143]
v_exp_f32 v120, v120
v_exp_f32 v121, v121
v_exp_f32 v122, v122
v_exp_f32 v123, v123
v_cvt_pk_bf16_f32 v148, v120, v121
v_cvt_pk_bf16_f32 v149, v122, v123
s_waitcnt vmcnt(16)
v_mfma_f32_32x32x16_bf16 v[48:63], v[208:211], v[144:147], v[48:63]
v_exp_f32 v124, v124
v_exp_f32 v125, v125
v_exp_f32 v126, v126
v_exp_f32 v127, v127
v_cvt_pk_bf16_f32 v150, v124, v125
v_cvt_pk_bf16_f32 v151, v126, v127
v_mfma_f32_32x32x16_bf16 v[112:127], v[200:203], v[32:35], 0
v_exp_f32 v128, v128
v_exp_f32 v129, v129
v_exp_f32 v130, v130
v_exp_f32 v131, v131
v_cvt_pk_bf16_f32 v144, v128, v129
v_cvt_pk_bf16_f32 v145, v130, v131
v_mfma_f32_32x32x16_bf16 v[48:63], v[212:215], v[148:151], v[48:63]
v_exp_f32 v132, v132
v_exp_f32 v133, v133
v_exp_f32 v134, v134
v_exp_f32 v135, v135
v_cvt_pk_bf16_f32 v146, v132, v133
v_cvt_pk_bf16_f32 v147, v134, v135
v_mfma_f32_32x32x16_bf16 v[112:127], v[204:207], v[36:39], v[112:127]
s_add_u32 s18, s17, 32768
buffer_load_dwordx4 v[184:187], v1, s[8:11], s18 offen offset:0 sc1
v_exp_f32 v136, v136
v_exp_f32 v137, v137
v_exp_f32 v138, v138
v_exp_f32 v139, v139
v_cvt_pk_bf16_f32 v148, v136, v137
v_cvt_pk_bf16_f32 v149, v138, v139
v_mfma_f32_32x32x16_bf16 v[64:79], v[208:211], v[144:147], v[64:79]
buffer_load_dwordx4 v[188:191], v1, s[8:11], s18 offen offset:1024 sc1
v_exp_f32 v140, v140
v_exp_f32 v141, v141
v_exp_f32 v142, v142
v_exp_f32 v143, v143
v_cvt_pk_bf16_f32 v150, v140, v141
v_cvt_pk_bf16_f32 v151, v142, v143
v_mfma_f32_32x32x16_bf16 v[128:143], v[200:203], v[40:43], 0
v_exp_f32 v112, v112
v_exp_f32 v113, v113
v_exp_f32 v114, v114
v_exp_f32 v115, v115
v_cvt_pk_bf16_f32 v144, v112, v113
v_cvt_pk_bf16_f32 v145, v114, v115
v_mfma_f32_32x32x16_bf16 v[64:79], v[212:215], v[148:151], v[64:79]
v_exp_f32 v116, v116
v_exp_f32 v117, v117
v_exp_f32 v118, v118
v_exp_f32 v119, v119
v_cvt_pk_bf16_f32 v146, v116, v117
v_cvt_pk_bf16_f32 v147, v118, v119
v_mfma_f32_32x32x16_bf16 v[128:143], v[204:207], v[44:47], v[128:143]
buffer_load_dwordx4 v[192:195], v1, s[8:11], s18 offen offset:2048 sc1
v_exp_f32 v120, v120
v_exp_f32 v121, v121
v_exp_f32 v122, v122
v_exp_f32 v123, v123
v_cvt_pk_bf16_f32 v148, v120, v121
v_cvt_pk_bf16_f32 v149, v122, v123
v_mfma_f32_32x32x16_bf16 v[80:95], v[208:211], v[144:147], v[80:95]
buffer_load_dwordx4 v[196:199], v1, s[8:11], s18 offen offset:3072 sc1
v_exp_f32 v124, v124
v_exp_f32 v125, v125
v_exp_f32 v126, v126
v_exp_f32 v127, v127
v_cvt_pk_bf16_f32 v150, v124, v125
v_cvt_pk_bf16_f32 v151, v126, v127
s_waitcnt vmcnt(18)
v_mfma_f32_32x32x16_bf16 v[112:127], v[216:219], v[16:19], 0
v_exp_f32 v128, v128
v_exp_f32 v129, v129
v_exp_f32 v130, v130
v_exp_f32 v131, v131
v_cvt_pk_bf16_f32 v144, v128, v129
v_cvt_pk_bf16_f32 v145, v130, v131
v_mfma_f32_32x32x16_bf16 v[80:95], v[212:215], v[148:151], v[80:95]
v_exp_f32 v132, v132
v_exp_f32 v133, v133
v_exp_f32 v134, v134
v_exp_f32 v135, v135
v_cvt_pk_bf16_f32 v146, v132, v133
v_cvt_pk_bf16_f32 v147, v134, v135
v_mfma_f32_32x32x16_bf16 v[112:127], v[220:223], v[20:23], v[112:127]
v_exp_f32 v136, v136
v_exp_f32 v137, v137
v_exp_f32 v138, v138
v_exp_f32 v139, v139
v_cvt_pk_bf16_f32 v148, v136, v137
v_cvt_pk_bf16_f32 v149, v138, v139
v_mfma_f32_32x32x16_bf16 v[96:111], v[208:211], v[144:147], v[96:111]
v_exp_f32 v140, v140
v_exp_f32 v141, v141
v_exp_f32 v142, v142
v_exp_f32 v143, v143
v_cvt_pk_bf16_f32 v150, v140, v141
v_cvt_pk_bf16_f32 v151, v142, v143
v_mfma_f32_32x32x16_bf16 v[128:143], v[216:219], v[24:27], 0
v_exp_f32 v112, v112
v_exp_f32 v113, v113
v_exp_f32 v114, v114
v_exp_f32 v115, v115
v_cvt_pk_bf16_f32 v144, v112, v113
v_cvt_pk_bf16_f32 v145, v114, v115
v_mfma_f32_32x32x16_bf16 v[96:111], v[212:215], v[148:151], v[96:111]
s_add_u32 s24, s50, 0
s_mov_b32 m0, s24
s_add_u32 s25, s52, 0
buffer_load_dwordx4 v1, s[8:11], s25 offen offset:0 lds
v_exp_f32 v116, v116
v_exp_f32 v117, v117
v_exp_f32 v118, v118
v_exp_f32 v119, v119
v_cvt_pk_bf16_f32 v146, v116, v117
v_cvt_pk_bf16_f32 v147, v118, v119
v_mfma_f32_32x32x16_bf16 v[128:143], v[220:223], v[28:31], v[128:143]
buffer_load_dwordx4 v1, s[8:11], s25 offen offset:1024 lds
v_exp_f32 v120, v120
v_exp_f32 v121, v121
v_exp_f32 v122, v122
v_exp_f32 v123, v123
v_cvt_pk_bf16_f32 v148, v120, v121
v_cvt_pk_bf16_f32 v149, v122, v123
s_waitcnt vmcnt(18)
v_mfma_f32_32x32x16_bf16 v[48:63], v[224:227], v[144:147], v[48:63]
buffer_load_dwordx4 v1, s[8:11], s25 offen offset:2048 lds
v_exp_f32 v124, v124
v_exp_f32 v125, v125
v_exp_f32 v126, v126
v_exp_f32 v127, v127
v_cvt_pk_bf16_f32 v150, v124, v125
v_cvt_pk_bf16_f32 v151, v126, v127
v_mfma_f32_32x32x16_bf16 v[112:127], v[216:219], v[32:35], 0
v_exp_f32 v128, v128
v_exp_f32 v129, v129
v_exp_f32 v130, v130
v_exp_f32 v131, v131
v_cvt_pk_bf16_f32 v144, v128, v129
v_cvt_pk_bf16_f32 v145, v130, v131
v_mfma_f32_32x32x16_bf16 v[48:63], v[228:231], v[148:151], v[48:63]
s_add_u32 s24, s50, 12288
s_mov_b32 m0, s24
s_add_u32 s25, s52, 12288
buffer_load_dwordx4 v1, s[8:11], s25 offen offset:0 lds
v_exp_f32 v132, v132
v_exp_f32 v133, v133
v_exp_f32 v134, v134
v_exp_f32 v135, v135
v_cvt_pk_bf16_f32 v146, v132, v133
v_cvt_pk_bf16_f32 v147, v134, v135
v_mfma_f32_32x32x16_bf16 v[112:127], v[220:223], v[36:39], v[112:127]
buffer_load_dwordx4 v1, s[8:11], s25 offen offset:1024 lds
v_exp_f32 v136, v136
v_exp_f32 v137, v137
v_exp_f32 v138, v138
v_exp_f32 v139, v139
v_cvt_pk_bf16_f32 v148, v136, v137
v_cvt_pk_bf16_f32 v149, v138, v139
v_mfma_f32_32x32x16_bf16 v[64:79], v[224:227], v[144:147], v[64:79]
s_add_u32 s18, s17, 36864
buffer_load_dwordx4 v[200:203], v1, s[8:11], s18 offen offset:0 sc1
v_exp_f32 v140, v140
v_exp_f32 v141, v141
v_exp_f32 v142, v142
v_exp_f32 v143, v143
v_cvt_pk_bf16_f32 v150, v140, v141
v_cvt_pk_bf16_f32 v151, v142, v143
v_mfma_f32_32x32x16_bf16 v[128:143], v[216:219], v[40:43], 0
v_exp_f32 v112, v112
v_exp_f32 v113, v113
v_exp_f32 v114, v114
v_exp_f32 v115, v115
v_cvt_pk_bf16_f32 v144, v112, v113
v_cvt_pk_bf16_f32 v145, v114, v115
v_mfma_f32_32x32x16_bf16 v[64:79], v[228:231], v[148:151], v[64:79]
buffer_load_dwordx4 v1, s[8:11], s25 offen offset:2048 lds
v_exp_f32 v116, v116
v_exp_f32 v117, v117
v_exp_f32 v118, v118
v_exp_f32 v119, v119
v_cvt_pk_bf16_f32 v146, v116, v117
v_cvt_pk_bf16_f32 v147, v118, v119
v_mfma_f32_32x32x16_bf16 v[128:143], v[220:223], v[44:47], v[128:143]
s_add_u32 s24, s50, 24576
s_mov_b32 m0, s24
s_add_u32 s25, s52, 24576
buffer_load_dwordx4 v1, s[8:11], s25 offen offset:0 lds
v_exp_f32 v120, v120
v_exp_f32 v121, v121
v_exp_f32 v122, v122
v_exp_f32 v123, v123
v_cvt_pk_bf16_f32 v148, v120, v121
v_cvt_pk_bf16_f32 v149, v122, v123
v_mfma_f32_32x32x16_bf16 v[80:95], v[224:227], v[144:147], v[80:95]
buffer_load_dwordx4 v[204:207], v1, s[8:11], s18 offen offset:1024 sc1
v_exp_f32 v124, v124
v_exp_f32 v125, v125
v_exp_f32 v126, v126
v_exp_f32 v127, v127
v_cvt_pk_bf16_f32 v150, v124, v125
v_cvt_pk_bf16_f32 v151, v126, v127
s_waitcnt vmcnt(23)
v_mfma_f32_32x32x16_bf16 v[112:127], v[232:235], v[16:19], 0
v_exp_f32 v128, v128
v_exp_f32 v129, v129
v_exp_f32 v130, v130
v_exp_f32 v131, v131
v_cvt_pk_bf16_f32 v144, v128, v129
v_cvt_pk_bf16_f32 v145, v130, v131
v_mfma_f32_32x32x16_bf16 v[80:95], v[228:231], v[148:151], v[80:95]
buffer_load_dwordx4 v1, s[8:11], s25 offen offset:1024 lds
v_exp_f32 v132, v132
v_exp_f32 v133, v133
v_exp_f32 v134, v134
v_exp_f32 v135, v135
v_cvt_pk_bf16_f32 v146, v132, v133
v_cvt_pk_bf16_f32 v147, v134, v135
v_mfma_f32_32x32x16_bf16 v[112:127], v[236:239], v[20:23], v[112:127]
buffer_load_dwordx4 v1, s[8:11], s25 offen offset:2048 lds
v_exp_f32 v136, v136
v_exp_f32 v137, v137
v_exp_f32 v138, v138
v_exp_f32 v139, v139
v_cvt_pk_bf16_f32 v148, v136, v137
v_cvt_pk_bf16_f32 v149, v138, v139
v_mfma_f32_32x32x16_bf16 v[96:111], v[224:227], v[144:147], v[96:111]
buffer_load_dwordx4 v[208:211], v1, s[8:11], s18 offen offset:2048 sc1
v_exp_f32 v140, v140
v_exp_f32 v141, v141
v_exp_f32 v142, v142
v_exp_f32 v143, v143
v_cvt_pk_bf16_f32 v150, v140, v141
v_cvt_pk_bf16_f32 v151, v142, v143
v_mfma_f32_32x32x16_bf16 v[128:143], v[232:235], v[24:27], 0
v_exp_f32 v112, v112
v_exp_f32 v113, v113
v_exp_f32 v114, v114
v_exp_f32 v115, v115
v_cvt_pk_bf16_f32 v144, v112, v113
v_cvt_pk_bf16_f32 v145, v114, v115
v_mfma_f32_32x32x16_bf16 v[96:111], v[228:231], v[148:151], v[96:111]
s_add_u32 s24, s50, 36864
s_mov_b32 m0, s24
s_add_u32 s25, s52, 36864
buffer_load_dwordx4 v1, s[8:11], s25 offen offset:0 lds
v_exp_f32 v116, v116
v_exp_f32 v117, v117
v_exp_f32 v118, v118
v_exp_f32 v119, v119
v_cvt_pk_bf16_f32 v146, v116, v117
v_cvt_pk_bf16_f32 v147, v118, v119
v_mfma_f32_32x32x16_bf16 v[128:143], v[236:239], v[28:31], v[128:143]
buffer_load_dwordx4 v1, s[8:11], s25 offen offset:1024 lds
v_exp_f32 v120, v120
v_exp_f32 v121, v121
v_exp_f32 v122, v122
v_exp_f32 v123, v123
v_cvt_pk_bf16_f32 v148, v120, v121
v_cvt_pk_bf16_f32 v149, v122, v123
s_waitcnt vmcnt(26)
v_mfma_f32_32x32x16_bf16 v[48:63], v[240:243], v[144:147], v[48:63]
buffer_load_dwordx4 v[212:215], v1, s[8:11], s18 offen offset:3072 sc1
v_exp_f32 v124, v124
v_exp_f32 v125, v125
v_exp_f32 v126, v126
v_exp_f32 v127, v127
v_cvt_pk_bf16_f32 v150, v124, v125
v_cvt_pk_bf16_f32 v151, v126, v127
v_mfma_f32_32x32x16_bf16 v[112:127], v[232:235], v[32:35], 0
v_exp_f32 v128, v128
v_exp_f32 v129, v129
v_exp_f32 v130, v130
v_exp_f32 v131, v131
v_cvt_pk_bf16_f32 v144, v128, v129
v_cvt_pk_bf16_f32 v145, v130, v131
v_mfma_f32_32x32x16_bf16 v[48:63], v[244:247], v[148:151], v[48:63]
buffer_load_dwordx4 v1, s[8:11], s25 offen offset:2048 lds
v_exp_f32 v132, v132
v_exp_f32 v133, v133
v_exp_f32 v134, v134
v_exp_f32 v135, v135
v_cvt_pk_bf16_f32 v146, v132, v133
v_cvt_pk_bf16_f32 v147, v134, v135
v_mfma_f32_32x32x16_bf16 v[112:127], v[236:239], v[36:39], v[112:127]
s_add_u32 s24, s50, 49152
s_mov_b32 m0, s24
s_add_u32 s25, s52, 49152
buffer_load_dwordx4 v1, s[8:11], s25 offen offset:0 lds
v_exp_f32 v136, v136
v_exp_f32 v137, v137
v_exp_f32 v138, v138
v_exp_f32 v139, v139
v_cvt_pk_bf16_f32 v148, v136, v137
v_cvt_pk_bf16_f32 v149, v138, v139
v_mfma_f32_32x32x16_bf16 v[64:79], v[240:243], v[144:147], v[64:79]
s_add_u32 s18, s17, 40960
buffer_load_dwordx4 v[216:219], v1, s[8:11], s18 offen offset:0 sc1
v_exp_f32 v140, v140
v_exp_f32 v141, v141
v_exp_f32 v142, v142
v_exp_f32 v143, v143
v_cvt_pk_bf16_f32 v150, v140, v141
v_cvt_pk_bf16_f32 v151, v142, v143
v_mfma_f32_32x32x16_bf16 v[128:143], v[232:235], v[40:43], 0
v_exp_f32 v112, v112
v_exp_f32 v113, v113
v_exp_f32 v114, v114
v_exp_f32 v115, v115
v_cvt_pk_bf16_f32 v144, v112, v113
v_cvt_pk_bf16_f32 v145, v114, v115
v_mfma_f32_32x32x16_bf16 v[64:79], v[244:247], v[148:151], v[64:79]
buffer_load_dwordx4 v1, s[8:11], s25 offen offset:1024 lds
v_exp_f32 v116, v116
v_exp_f32 v117, v117
v_exp_f32 v118, v118
v_exp_f32 v119, v119
v_cvt_pk_bf16_f32 v146, v116, v117
v_cvt_pk_bf16_f32 v147, v118, v119
v_mfma_f32_32x32x16_bf16 v[128:143], v[236:239], v[44:47], v[128:143]
buffer_load_dwordx4 v1, s[8:11], s25 offen offset:2048 lds
v_exp_f32 v120, v120
v_exp_f32 v121, v121
v_exp_f32 v122, v122
v_exp_f32 v123, v123
v_cvt_pk_bf16_f32 v148, v120, v121
v_cvt_pk_bf16_f32 v149, v122, v123
v_mfma_f32_32x32x16_bf16 v[80:95], v[240:243], v[144:147], v[80:95]
buffer_load_dwordx4 v[220:223], v1, s[8:11], s18 offen offset:1024 sc1
v_exp_f32 v124, v124
v_exp_f32 v125, v125
v_exp_f32 v126, v126
v_exp_f32 v127, v127
v_cvt_pk_bf16_f32 v150, v124, v125
v_cvt_pk_bf16_f32 v151, v126, v127
s_waitcnt vmcnt(31)
v_mfma_f32_32x32x16_bf16 v[112:127], v[152:155], v[16:19], 0
v_exp_f32 v128, v128
v_exp_f32 v129, v129
v_exp_f32 v130, v130
v_exp_f32 v131, v131
v_cvt_pk_bf16_f32 v144, v128, v129
v_cvt_pk_bf16_f32 v145, v130, v131
v_mfma_f32_32x32x16_bf16 v[80:95], v[244:247], v[148:151], v[80:95]
s_add_u32 s24, s50, 61440
s_mov_b32 m0, s24
s_add_u32 s25, s52, 61440
buffer_load_dwordx4 v1, s[8:11], s25 offen offset:0 lds
v_exp_f32 v132, v132
v_exp_f32 v133, v133
v_exp_f32 v134, v134
v_exp_f32 v135, v135
v_cvt_pk_bf16_f32 v146, v132, v133
v_cvt_pk_bf16_f32 v147, v134, v135
v_mfma_f32_32x32x16_bf16 v[112:127], v[156:159], v[20:23], v[112:127]
buffer_load_dwordx4 v1, s[8:11], s25 offen offset:1024 lds
v_exp_f32 v136, v136
v_exp_f32 v137, v137
v_exp_f32 v138, v138
v_exp_f32 v139, v139
v_cvt_pk_bf16_f32 v148, v136, v137
v_cvt_pk_bf16_f32 v149, v138, v139
v_mfma_f32_32x32x16_bf16 v[96:111], v[240:243], v[144:147], v[96:111]
buffer_load_dwordx4 v[224:227], v1, s[8:11], s18 offen offset:2048 sc1
v_exp_f32 v140, v140
v_exp_f32 v141, v141
v_exp_f32 v142, v142
v_exp_f32 v143, v143
v_cvt_pk_bf16_f32 v150, v140, v141
v_cvt_pk_bf16_f32 v151, v142, v143
v_mfma_f32_32x32x16_bf16 v[128:143], v[152:155], v[24:27], 0
v_exp_f32 v112, v112
v_exp_f32 v113, v113
v_exp_f32 v114, v114
v_exp_f32 v115, v115
v_cvt_pk_bf16_f32 v144, v112, v113
v_cvt_pk_bf16_f32 v145, v114, v115
v_mfma_f32_32x32x16_bf16 v[96:111], v[244:247], v[148:151], v[96:111]
buffer_load_dwordx4 v1, s[8:11], s25 offen offset:2048 lds
v_exp_f32 v116, v116
v_exp_f32 v117, v117
v_exp_f32 v118, v118
v_exp_f32 v119, v119
v_cvt_pk_bf16_f32 v146, v116, v117
v_cvt_pk_bf16_f32 v147, v118, v119
v_mfma_f32_32x32x16_bf16 v[128:143], v[156:159], v[28:31], v[128:143]
s_add_u32 s24, s50, 73728
s_mov_b32 m0, s24
s_add_u32 s25, s52, 73728
buffer_load_dwordx4 v1, s[8:11], s25 offen offset:0 lds
v_exp_f32 v120, v120
v_exp_f32 v121, v121
v_exp_f32 v122, v122
v_exp_f32 v123, v123
v_cvt_pk_bf16_f32 v148, v120, v121
v_cvt_pk_bf16_f32 v149, v122, v123
s_waitcnt vmcnt(34)
v_mfma_f32_32x32x16_bf16 v[48:63], v[160:163], v[144:147], v[48:63]
buffer_load_dwordx4 v[228:231], v1, s[8:11], s18 offen offset:3072 sc1
v_exp_f32 v124, v124
v_exp_f32 v125, v125
v_exp_f32 v126, v126
v_exp_f32 v127, v127
v_cvt_pk_bf16_f32 v150, v124, v125
v_cvt_pk_bf16_f32 v151, v126, v127
v_mfma_f32_32x32x16_bf16 v[112:127], v[152:155], v[32:35], 0
v_exp_f32 v128, v128
v_exp_f32 v129, v129
v_exp_f32 v130, v130
v_exp_f32 v131, v131
v_cvt_pk_bf16_f32 v144, v128, v129
v_cvt_pk_bf16_f32 v145, v130, v131
v_mfma_f32_32x32x16_bf16 v[48:63], v[164:167], v[148:151], v[48:63]
buffer_load_dwordx4 v1, s[8:11], s25 offen offset:1024 lds
v_exp_f32 v132, v132
v_exp_f32 v133, v133
v_exp_f32 v134, v134
v_exp_f32 v135, v135
v_cvt_pk_bf16_f32 v146, v132, v133
v_cvt_pk_bf16_f32 v147, v134, v135
v_mfma_f32_32x32x16_bf16 v[112:127], v[156:159], v[36:39], v[112:127]
buffer_load_dwordx4 v1, s[8:11], s25 offen offset:2048 lds
v_exp_f32 v136, v136
v_exp_f32 v137, v137
v_exp_f32 v138, v138
v_exp_f32 v139, v139
v_cvt_pk_bf16_f32 v148, v136, v137
v_cvt_pk_bf16_f32 v149, v138, v139
v_mfma_f32_32x32x16_bf16 v[64:79], v[160:163], v[144:147], v[64:79]
s_add_u32 s18, s17, 45056
buffer_load_dwordx4 v[232:235], v1, s[8:11], s18 offen offset:0 sc1
v_exp_f32 v140, v140
v_exp_f32 v141, v141
v_exp_f32 v142, v142
v_exp_f32 v143, v143
v_cvt_pk_bf16_f32 v150, v140, v141
v_cvt_pk_bf16_f32 v151, v142, v143
v_mfma_f32_32x32x16_bf16 v[128:143], v[152:155], v[40:43], 0
v_exp_f32 v112, v112
v_exp_f32 v113, v113
v_exp_f32 v114, v114
v_exp_f32 v115, v115
v_cvt_pk_bf16_f32 v144, v112, v113
v_cvt_pk_bf16_f32 v145, v114, v115
v_mfma_f32_32x32x16_bf16 v[64:79], v[164:167], v[148:151], v[64:79]
s_add_u32 s26, s55, 0
buffer_load_dwordx4 a[0:3], v1, s[8:11], s26 offen offset:0
v_exp_f32 v116, v116
v_exp_f32 v117, v117
v_exp_f32 v118, v118
v_exp_f32 v119, v119
v_cvt_pk_bf16_f32 v146, v116, v117
v_cvt_pk_bf16_f32 v147, v118, v119
v_mfma_f32_32x32x16_bf16 v[128:143], v[156:159], v[44:47], v[128:143]
s_add_u32 s26, s56, 0
buffer_load_dwordx4 a[4:7], v1, s[8:11], s26 offen offset:0
v_exp_f32 v120, v120
v_exp_f32 v121, v121
v_exp_f32 v122, v122
v_exp_f32 v123, v123
v_cvt_pk_bf16_f32 v148, v120, v121
v_cvt_pk_bf16_f32 v149, v122, v123
v_mfma_f32_32x32x16_bf16 v[80:95], v[160:163], v[144:147], v[80:95]
buffer_load_dwordx4 v[236:239], v1, s[8:11], s18 offen offset:1024 sc1
v_exp_f32 v124, v124
v_exp_f32 v125, v125
v_exp_f32 v126, v126
v_exp_f32 v127, v127
v_cvt_pk_bf16_f32 v150, v124, v125
v_cvt_pk_bf16_f32 v151, v126, v127
s_waitcnt vmcnt(39)
v_mfma_f32_32x32x16_bf16 v[112:127], v[168:171], v[16:19], 0
v_exp_f32 v128, v128
v_exp_f32 v129, v129
v_exp_f32 v130, v130
v_exp_f32 v131, v131
v_cvt_pk_bf16_f32 v144, v128, v129
v_cvt_pk_bf16_f32 v145, v130, v131
v_mfma_f32_32x32x16_bf16 v[80:95], v[164:167], v[148:151], v[80:95]
s_add_u32 s26, s55, 0
buffer_load_dwordx4 a[8:11], v1, s[8:11], s26 offen offset:1024
v_exp_f32 v132, v132
v_exp_f32 v133, v133
v_exp_f32 v134, v134
v_exp_f32 v135, v135
v_cvt_pk_bf16_f32 v146, v132, v133
v_cvt_pk_bf16_f32 v147, v134, v135
v_mfma_f32_32x32x16_bf16 v[112:127], v[172:175], v[20:23], v[112:127]
s_add_u32 s26, s56, 0
buffer_load_dwordx4 a[12:15], v1, s[8:11], s26 offen offset:1024
v_exp_f32 v136, v136
v_exp_f32 v137, v137
v_exp_f32 v138, v138
v_exp_f32 v139, v139
v_cvt_pk_bf16_f32 v148, v136, v137
v_cvt_pk_bf16_f32 v149, v138, v139
v_mfma_f32_32x32x16_bf16 v[96:111], v[160:163], v[144:147], v[96:111]
buffer_load_dwordx4 v[240:243], v1, s[8:11], s18 offen offset:2048 sc1
v_exp_f32 v140, v140
v_exp_f32 v141, v141
v_exp_f32 v142, v142
v_exp_f32 v143, v143
v_cvt_pk_bf16_f32 v150, v140, v141
v_cvt_pk_bf16_f32 v151, v142, v143
v_mfma_f32_32x32x16_bf16 v[128:143], v[168:171], v[24:27], 0
v_exp_f32 v112, v112
v_exp_f32 v113, v113
v_exp_f32 v114, v114
v_exp_f32 v115, v115
v_cvt_pk_bf16_f32 v144, v112, v113
v_cvt_pk_bf16_f32 v145, v114, v115
v_mfma_f32_32x32x16_bf16 v[96:111], v[164:167], v[148:151], v[96:111]
s_add_u32 s26, s55, 0
buffer_load_dwordx4 a[16:19], v1, s[8:11], s26 offen offset:2048
v_exp_f32 v116, v116
v_exp_f32 v117, v117
v_exp_f32 v118, v118
v_exp_f32 v119, v119
v_cvt_pk_bf16_f32 v146, v116, v117
v_cvt_pk_bf16_f32 v147, v118, v119
v_mfma_f32_32x32x16_bf16 v[128:143], v[172:175], v[28:31], v[128:143]
s_add_u32 s26, s56, 0
buffer_load_dwordx4 a[20:23], v1, s[8:11], s26 offen offset:2048
v_exp_f32 v120, v120
v_exp_f32 v121, v121
v_exp_f32 v122, v122
v_exp_f32 v123, v123
v_cvt_pk_bf16_f32 v148, v120, v121
v_cvt_pk_bf16_f32 v149, v122, v123
s_waitcnt vmcnt(42)
v_mfma_f32_32x32x16_bf16 v[48:63], v[176:179], v[144:147], v[48:63]
buffer_load_dwordx4 v[244:247], v1, s[8:11], s18 offen offset:3072 sc1
v_exp_f32 v124, v124
v_exp_f32 v125, v125
v_exp_f32 v126, v126
v_exp_f32 v127, v127
v_cvt_pk_bf16_f32 v150, v124, v125
v_cvt_pk_bf16_f32 v151, v126, v127
v_mfma_f32_32x32x16_bf16 v[112:127], v[168:171], v[32:35], 0
v_exp_f32 v128, v128
v_exp_f32 v129, v129
v_exp_f32 v130, v130
v_exp_f32 v131, v131
v_cvt_pk_bf16_f32 v144, v128, v129
v_cvt_pk_bf16_f32 v145, v130, v131
v_mfma_f32_32x32x16_bf16 v[48:63], v[180:183], v[148:151], v[48:63]
s_add_u32 s26, s55, 0
buffer_load_dwordx4 a[24:27], v1, s[8:11], s26 offen offset:3072
v_exp_f32 v132, v132
v_exp_f32 v133, v133
v_exp_f32 v134, v134
v_exp_f32 v135, v135
v_cvt_pk_bf16_f32 v146, v132, v133
v_cvt_pk_bf16_f32 v147, v134, v135
v_mfma_f32_32x32x16_bf16 v[112:127], v[172:175], v[36:39], v[112:127]
s_add_u32 s26, s56, 0
buffer_load_dwordx4 a[28:31], v1, s[8:11], s26 offen offset:3072
v_exp_f32 v136, v136
v_exp_f32 v137, v137
v_exp_f32 v138, v138
v_exp_f32 v139, v139
v_cvt_pk_bf16_f32 v148, v136, v137
v_cvt_pk_bf16_f32 v149, v138, v139
v_mfma_f32_32x32x16_bf16 v[64:79], v[176:179], v[144:147], v[64:79]
s_add_u32 s18, s17, 49152
buffer_load_dwordx4 v[152:155], v1, s[8:11], s18 offen offset:0 sc1
v_exp_f32 v140, v140
v_exp_f32 v141, v141
v_exp_f32 v142, v142
v_exp_f32 v143, v143
v_cvt_pk_bf16_f32 v150, v140, v141
v_cvt_pk_bf16_f32 v151, v142, v143
v_mfma_f32_32x32x16_bf16 v[128:143], v[168:171], v[40:43], 0
v_exp_f32 v112, v112
v_exp_f32 v113, v113
v_exp_f32 v114, v114
v_exp_f32 v115, v115
v_cvt_pk_bf16_f32 v144, v112, v113
v_cvt_pk_bf16_f32 v145, v114, v115
v_mfma_f32_32x32x16_bf16 v[64:79], v[180:183], v[148:151], v[64:79]
s_add_u32 s26, s55, 4096
buffer_load_dwordx4 a[32:35], v1, s[8:11], s26 offen offset:0
v_exp_f32 v116, v116
v_exp_f32 v117, v117
v_exp_f32 v118, v118
v_exp_f32 v119, v119
v_cvt_pk_bf16_f32 v146, v116, v117
v_cvt_pk_bf16_f32 v147, v118, v119
v_mfma_f32_32x32x16_bf16 v[128:143], v[172:175], v[44:47], v[128:143]
s_add_u32 s26, s56, 4096
buffer_load_dwordx4 a[36:39], v1, s[8:11], s26 offen offset:0
v_exp_f32 v120, v120
v_exp_f32 v121, v121
v_exp_f32 v122, v122
v_exp_f32 v123, v123
v_cvt_pk_bf16_f32 v148, v120, v121
v_cvt_pk_bf16_f32 v149, v122, v123
v_mfma_f32_32x32x16_bf16 v[80:95], v[176:179], v[144:147], v[80:95]
buffer_load_dwordx4 v[156:159], v1, s[8:11], s18 offen offset:1024 sc1
v_exp_f32 v124, v124
v_exp_f32 v125, v125
v_exp_f32 v126, v126
v_exp_f32 v127, v127
v_cvt_pk_bf16_f32 v150, v124, v125
v_cvt_pk_bf16_f32 v151, v126, v127
s_waitcnt vmcnt(47)
v_mfma_f32_32x32x16_bf16 v[112:127], v[184:187], v[16:19], 0
v_exp_f32 v128, v128
v_exp_f32 v129, v129
v_exp_f32 v130, v130
v_exp_f32 v131, v131
v_cvt_pk_bf16_f32 v144, v128, v129
v_cvt_pk_bf16_f32 v145, v130, v131
v_mfma_f32_32x32x16_bf16 v[80:95], v[180:183], v[148:151], v[80:95]
s_add_u32 s26, s55, 4096
buffer_load_dwordx4 a[40:43], v1, s[8:11], s26 offen offset:1024
v_exp_f32 v132, v132
v_exp_f32 v133, v133
v_exp_f32 v134, v134
v_exp_f32 v135, v135
v_cvt_pk_bf16_f32 v146, v132, v133
v_cvt_pk_bf16_f32 v147, v134, v135
v_mfma_f32_32x32x16_bf16 v[112:127], v[188:191], v[20:23], v[112:127]
s_add_u32 s26, s56, 4096
buffer_load_dwordx4 a[44:47], v1, s[8:11], s26 offen offset:1024
v_exp_f32 v136, v136
v_exp_f32 v137, v137
v_exp_f32 v138, v138
v_exp_f32 v139, v139
v_cvt_pk_bf16_f32 v148, v136, v137
v_cvt_pk_bf16_f32 v149, v138, v139
v_mfma_f32_32x32x16_bf16 v[96:111], v[176:179], v[144:147], v[96:111]
buffer_load_dwordx4 v[160:163], v1, s[8:11], s18 offen offset:2048 sc1
v_exp_f32 v140, v140
v_exp_f32 v141, v141
v_exp_f32 v142, v142
v_exp_f32 v143, v143
v_cvt_pk_bf16_f32 v150, v140, v141
v_cvt_pk_bf16_f32 v151, v142, v143
v_mfma_f32_32x32x16_bf16 v[128:143], v[184:187], v[24:27], 0
v_exp_f32 v112, v112
v_exp_f32 v113, v113
v_exp_f32 v114, v114
v_exp_f32 v115, v115
v_cvt_pk_bf16_f32 v144, v112, v113
v_cvt_pk_bf16_f32 v145, v114, v115
v_mfma_f32_32x32x16_bf16 v[96:111], v[180:183], v[148:151], v[96:111]
s_add_u32 s26, s55, 4096
buffer_load_dwordx4 a[48:51], v1, s[8:11], s26 offen offset:2048
v_exp_f32 v116, v116
v_exp_f32 v117, v117
v_exp_f32 v118, v118
v_exp_f32 v119, v119
v_cvt_pk_bf16_f32 v146, v116, v117
v_cvt_pk_bf16_f32 v147, v118, v119
v_mfma_f32_32x32x16_bf16 v[128:143], v[188:191], v[28:31], v[128:143]
s_add_u32 s26, s56, 4096
buffer_load_dwordx4 a[52:55], v1, s[8:11], s26 offen offset:2048
v_exp_f32 v120, v120
v_exp_f32 v121, v121
v_exp_f32 v122, v122
v_exp_f32 v123, v123
v_cvt_pk_bf16_f32 v148, v120, v121
v_cvt_pk_bf16_f32 v149, v122, v123
s_waitcnt vmcnt(50)
v_mfma_f32_32x32x16_bf16 v[48:63], v[192:195], v[144:147], v[48:63]
buffer_load_dwordx4 v[164:167], v1, s[8:11], s18 offen offset:3072 sc1
v_exp_f32 v124, v124
v_exp_f32 v125, v125
v_exp_f32 v126, v126
v_exp_f32 v127, v127
v_cvt_pk_bf16_f32 v150, v124, v125
v_cvt_pk_bf16_f32 v151, v126, v127
v_mfma_f32_32x32x16_bf16 v[112:127], v[184:187], v[32:35], 0
v_exp_f32 v128, v128
v_exp_f32 v129, v129
v_exp_f32 v130, v130
v_exp_f32 v131, v131
v_cvt_pk_bf16_f32 v144, v128, v129
v_cvt_pk_bf16_f32 v145, v130, v131
v_mfma_f32_32x32x16_bf16 v[48:63], v[196:199], v[148:151], v[48:63]
s_add_u32 s26, s55, 4096
buffer_load_dwordx4 a[56:59], v1, s[8:11], s26 offen offset:3072
v_exp_f32 v132, v132
v_exp_f32 v133, v133
v_exp_f32 v134, v134
v_exp_f32 v135, v135
v_cvt_pk_bf16_f32 v146, v132, v133
v_cvt_pk_bf16_f32 v147, v134, v135
v_mfma_f32_32x32x16_bf16 v[112:127], v[188:191], v[36:39], v[112:127]
s_add_u32 s26, s56, 4096
buffer_load_dwordx4 a[60:63], v1, s[8:11], s26 offen offset:3072
v_exp_f32 v136, v136
v_exp_f32 v137, v137
v_exp_f32 v138, v138
v_exp_f32 v139, v139
v_cvt_pk_bf16_f32 v148, v136, v137
v_cvt_pk_bf16_f32 v149, v138, v139
v_mfma_f32_32x32x16_bf16 v[64:79], v[192:195], v[144:147], v[64:79]
s_add_u32 s18, s17, 53248
buffer_load_dwordx4 v[168:171], v1, s[8:11], s18 offen offset:0 sc1
v_exp_f32 v140, v140
v_exp_f32 v141, v141
v_exp_f32 v142, v142
v_exp_f32 v143, v143
v_cvt_pk_bf16_f32 v150, v140, v141
v_cvt_pk_bf16_f32 v151, v142, v143
v_mfma_f32_32x32x16_bf16 v[128:143], v[184:187], v[40:43], 0
v_exp_f32 v112, v112
v_exp_f32 v113, v113
v_exp_f32 v114, v114
v_exp_f32 v115, v115
v_cvt_pk_bf16_f32 v144, v112, v113
v_cvt_pk_bf16_f32 v145, v114, v115
v_mfma_f32_32x32x16_bf16 v[64:79], v[196:199], v[148:151], v[64:79]
s_add_u32 s26, s57, 0
buffer_load_dwordx4 a[112:115], v1, s[8:11], s26 offen offset:0
v_exp_f32 v116, v116
v_exp_f32 v117, v117
v_exp_f32 v118, v118
v_exp_f32 v119, v119
v_cvt_pk_bf16_f32 v146, v116, v117
v_cvt_pk_bf16_f32 v147, v118, v119
v_mfma_f32_32x32x16_bf16 v[128:143], v[188:191], v[44:47], v[128:143]
s_add_u32 s26, s58, 0
buffer_load_dwordx4 a[116:119], v1, s[8:11], s26 offen offset:0
v_exp_f32 v120, v120
v_exp_f32 v121, v121
v_exp_f32 v122, v122
v_exp_f32 v123, v123
v_cvt_pk_bf16_f32 v148, v120, v121
v_cvt_pk_bf16_f32 v149, v122, v123
v_mfma_f32_32x32x16_bf16 v[80:95], v[192:195], v[144:147], v[80:95]
buffer_load_dwordx4 v[172:175], v1, s[8:11], s18 offen offset:1024 sc1
v_exp_f32 v124, v124
v_exp_f32 v125, v125
v_exp_f32 v126, v126
v_exp_f32 v127, v127
v_cvt_pk_bf16_f32 v150, v124, v125
v_cvt_pk_bf16_f32 v151, v126, v127
s_waitcnt vmcnt(48)
v_mfma_f32_32x32x16_bf16 v[112:127], v[200:203], v[16:19], 0
v_exp_f32 v128, v128
v_exp_f32 v129, v129
v_exp_f32 v130, v130
v_exp_f32 v131, v131
v_cvt_pk_bf16_f32 v144, v128, v129
v_cvt_pk_bf16_f32 v145, v130, v131
v_mfma_f32_32x32x16_bf16 v[80:95], v[196:199], v[148:151], v[80:95]
s_add_u32 s26, s57, 0
buffer_load_dwordx4 a[120:123], v1, s[8:11], s26 offen offset:1024
v_exp_f32 v132, v132
v_exp_f32 v133, v133
v_exp_f32 v134, v134
v_exp_f32 v135, v135
v_cvt_pk_bf16_f32 v146, v132, v133
v_cvt_pk_bf16_f32 v147, v134, v135
v_mfma_f32_32x32x16_bf16 v[112:127], v[204:207], v[20:23], v[112:127]
s_add_u32 s26, s58, 0
buffer_load_dwordx4 a[124:127], v1, s[8:11], s26 offen offset:1024
v_exp_f32 v136, v136
v_exp_f32 v137, v137
v_exp_f32 v138, v138
v_exp_f32 v139, v139
v_cvt_pk_bf16_f32 v148, v136, v137
v_cvt_pk_bf16_f32 v149, v138, v139
v_mfma_f32_32x32x16_bf16 v[96:111], v[192:195], v[144:147], v[96:111]
buffer_load_dwordx4 v[176:179], v1, s[8:11], s18 offen offset:2048 sc1
v_exp_f32 v140, v140
v_exp_f32 v141, v141
v_exp_f32 v142, v142
v_exp_f32 v143, v143
v_cvt_pk_bf16_f32 v150, v140, v141
v_cvt_pk_bf16_f32 v151, v142, v143
v_mfma_f32_32x32x16_bf16 v[128:143], v[200:203], v[24:27], 0
v_exp_f32 v112, v112
v_exp_f32 v113, v113
v_exp_f32 v114, v114
v_exp_f32 v115, v115
v_cvt_pk_bf16_f32 v144, v112, v113
v_cvt_pk_bf16_f32 v145, v114, v115
v_mfma_f32_32x32x16_bf16 v[96:111], v[196:199], v[148:151], v[96:111]
s_add_u32 s26, s57, 0
buffer_load_dwordx4 a[128:131], v1, s[8:11], s26 offen offset:2048
v_exp_f32 v116, v116
v_exp_f32 v117, v117
v_exp_f32 v118, v118
v_exp_f32 v119, v119
v_cvt_pk_bf16_f32 v146, v116, v117
v_cvt_pk_bf16_f32 v147, v118, v119
v_mfma_f32_32x32x16_bf16 v[128:143], v[204:207], v[28:31], v[128:143]
s_add_u32 s26, s58, 0
buffer_load_dwordx4 a[132:135], v1, s[8:11], s26 offen offset:2048
v_exp_f32 v120, v120
v_exp_f32 v121, v121
v_exp_f32 v122, v122
v_exp_f32 v123, v123
v_cvt_pk_bf16_f32 v148, v120, v121
v_cvt_pk_bf16_f32 v149, v122, v123
s_waitcnt vmcnt(47)
v_mfma_f32_32x32x16_bf16 v[48:63], v[208:211], v[144:147], v[48:63]
buffer_load_dwordx4 v[180:183], v1, s[8:11], s18 offen offset:3072 sc1
v_exp_f32 v124, v124
v_exp_f32 v125, v125
v_exp_f32 v126, v126
v_exp_f32 v127, v127
v_cvt_pk_bf16_f32 v150, v124, v125
v_cvt_pk_bf16_f32 v151, v126, v127
v_mfma_f32_32x32x16_bf16 v[112:127], v[200:203], v[32:35], 0
v_exp_f32 v128, v128
v_exp_f32 v129, v129
v_exp_f32 v130, v130
v_exp_f32 v131, v131
v_cvt_pk_bf16_f32 v144, v128, v129
v_cvt_pk_bf16_f32 v145, v130, v131
v_mfma_f32_32x32x16_bf16 v[48:63], v[212:215], v[148:151], v[48:63]
s_add_u32 s26, s57, 0
buffer_load_dwordx4 a[136:139], v1, s[8:11], s26 offen offset:3072
v_exp_f32 v132, v132
v_exp_f32 v133, v133
v_exp_f32 v134, v134
v_exp_f32 v135, v135
v_cvt_pk_bf16_f32 v146, v132, v133
v_cvt_pk_bf16_f32 v147, v134, v135
v_mfma_f32_32x32x16_bf16 v[112:127], v[204:207], v[36:39], v[112:127]
s_add_u32 s26, s58, 0
buffer_load_dwordx4 a[140:143], v1, s[8:11], s26 offen offset:3072
v_exp_f32 v136, v136
v_exp_f32 v137, v137
v_exp_f32 v138, v138
v_exp_f32 v139, v139
v_cvt_pk_bf16_f32 v148, v136, v137
v_cvt_pk_bf16_f32 v149, v138, v139
v_mfma_f32_32x32x16_bf16 v[64:79], v[208:211], v[144:147], v[64:79]
s_add_u32 s18, s17, 57344
buffer_load_dwordx4 v[184:187], v1, s[8:11], s18 offen offset:0 sc1
v_exp_f32 v140, v140
v_exp_f32 v141, v141
v_exp_f32 v142, v142
v_exp_f32 v143, v143
v_cvt_pk_bf16_f32 v150, v140, v141
v_cvt_pk_bf16_f32 v151, v142, v143
v_mfma_f32_32x32x16_bf16 v[128:143], v[200:203], v[40:43], 0
v_exp_f32 v112, v112
v_exp_f32 v113, v113
v_exp_f32 v114, v114
v_exp_f32 v115, v115
v_cvt_pk_bf16_f32 v144, v112, v113
v_cvt_pk_bf16_f32 v145, v114, v115
v_mfma_f32_32x32x16_bf16 v[64:79], v[212:215], v[148:151], v[64:79]
s_add_u32 s26, s57, 4096
buffer_load_dwordx4 a[144:147], v1, s[8:11], s26 offen offset:0
v_exp_f32 v116, v116
v_exp_f32 v117, v117
v_exp_f32 v118, v118
v_exp_f32 v119, v119
v_cvt_pk_bf16_f32 v146, v116, v117
v_cvt_pk_bf16_f32 v147, v118, v119
v_mfma_f32_32x32x16_bf16 v[128:143], v[204:207], v[44:47], v[128:143]
s_add_u32 s26, s58, 4096
buffer_load_dwordx4 a[148:151], v1, s[8:11], s26 offen offset:0
v_exp_f32 v120, v120
v_exp_f32 v121, v121
v_exp_f32 v122, v122
v_exp_f32 v123, v123
v_cvt_pk_bf16_f32 v148, v120, v121
v_cvt_pk_bf16_f32 v149, v122, v123
v_mfma_f32_32x32x16_bf16 v[80:95], v[208:211], v[144:147], v[80:95]
buffer_load_dwordx4 v[188:191], v1, s[8:11], s18 offen offset:1024 sc1
v_exp_f32 v124, v124
v_exp_f32 v125, v125
v_exp_f32 v126, v126
v_exp_f32 v127, v127
v_cvt_pk_bf16_f32 v150, v124, v125
v_cvt_pk_bf16_f32 v151, v126, v127
s_waitcnt vmcnt(48)
v_mfma_f32_32x32x16_bf16 v[112:127], v[216:219], v[16:19], 0
v_exp_f32 v128, v128
v_exp_f32 v129, v129
v_exp_f32 v130, v130
v_exp_f32 v131, v131
v_cvt_pk_bf16_f32 v144, v128, v129
v_cvt_pk_bf16_f32 v145, v130, v131
v_mfma_f32_32x32x16_bf16 v[80:95], v[212:215], v[148:151], v[80:95]
s_add_u32 s26, s57, 4096
buffer_load_dwordx4 a[152:155], v1, s[8:11], s26 offen offset:1024
v_exp_f32 v132, v132
v_exp_f32 v133, v133
v_exp_f32 v134, v134
v_exp_f32 v135, v135
v_cvt_pk_bf16_f32 v146, v132, v133
v_cvt_pk_bf16_f32 v147, v134, v135
v_mfma_f32_32x32x16_bf16 v[112:127], v[220:223], v[20:23], v[112:127]
s_add_u32 s26, s58, 4096
buffer_load_dwordx4 a[156:159], v1, s[8:11], s26 offen offset:1024
v_exp_f32 v136, v136
v_exp_f32 v137, v137
v_exp_f32 v138, v138
v_exp_f32 v139, v139
v_cvt_pk_bf16_f32 v148, v136, v137
v_cvt_pk_bf16_f32 v149, v138, v139
v_mfma_f32_32x32x16_bf16 v[96:111], v[208:211], v[144:147], v[96:111]
buffer_load_dwordx4 v[192:195], v1, s[8:11], s18 offen offset:2048 sc1
v_exp_f32 v140, v140
v_exp_f32 v141, v141
v_exp_f32 v142, v142
v_exp_f32 v143, v143
v_cvt_pk_bf16_f32 v150, v140, v141
v_cvt_pk_bf16_f32 v151, v142, v143
v_mfma_f32_32x32x16_bf16 v[128:143], v[216:219], v[24:27], 0
v_exp_f32 v112, v112
v_exp_f32 v113, v113
v_exp_f32 v114, v114
v_exp_f32 v115, v115
v_cvt_pk_bf16_f32 v144, v112, v113
v_cvt_pk_bf16_f32 v145, v114, v115
v_mfma_f32_32x32x16_bf16 v[96:111], v[212:215], v[148:151], v[96:111]
v_exp_f32 v116, v116
v_exp_f32 v117, v117
v_exp_f32 v118, v118
v_exp_f32 v119, v119
v_cvt_pk_bf16_f32 v146, v116, v117
v_cvt_pk_bf16_f32 v147, v118, v119
v_mfma_f32_32x32x16_bf16 v[128:143], v[220:223], v[28:31], v[128:143]
s_add_u32 s26, s57, 4096
buffer_load_dwordx4 a[160:163], v1, s[8:11], s26 offen offset:2048
v_exp_f32 v120, v120
v_exp_f32 v121, v121
v_exp_f32 v122, v122
v_exp_f32 v123, v123
v_cvt_pk_bf16_f32 v148, v120, v121
v_cvt_pk_bf16_f32 v149, v122, v123
s_waitcnt vmcnt(46)
v_mfma_f32_32x32x16_bf16 v[48:63], v[224:227], v[144:147], v[48:63]
buffer_load_dwordx4 v[196:199], v1, s[8:11], s18 offen offset:3072 sc1
v_exp_f32 v124, v124
v_exp_f32 v125, v125
v_exp_f32 v126, v126
v_exp_f32 v127, v127
v_cvt_pk_bf16_f32 v150, v124, v125
v_cvt_pk_bf16_f32 v151, v126, v127
v_mfma_f32_32x32x16_bf16 v[112:127], v[216:219], v[32:35], 0
v_exp_f32 v128, v128
v_exp_f32 v129, v129
v_exp_f32 v130, v130
v_exp_f32 v131, v131
v_cvt_pk_bf16_f32 v144, v128, v129
v_cvt_pk_bf16_f32 v145, v130, v131
v_mfma_f32_32x32x16_bf16 v[48:63], v[228:231], v[148:151], v[48:63]
v_exp_f32 v132, v132
v_exp_f32 v133, v133
v_exp_f32 v134, v134
v_exp_f32 v135, v135
v_cvt_pk_bf16_f32 v146, v132, v133
v_cvt_pk_bf16_f32 v147, v134, v135
v_mfma_f32_32x32x16_bf16 v[112:127], v[220:223], v[36:39], v[112:127]
s_add_u32 s26, s58, 4096
buffer_load_dwordx4 a[164:167], v1, s[8:11], s26 offen offset:2048
v_exp_f32 v136, v136
v_exp_f32 v137, v137
v_exp_f32 v138, v138
v_exp_f32 v139, v139
v_cvt_pk_bf16_f32 v148, v136, v137
v_cvt_pk_bf16_f32 v149, v138, v139
v_mfma_f32_32x32x16_bf16 v[64:79], v[224:227], v[144:147], v[64:79]
s_add_u32 s18, s17, 61440
buffer_load_dwordx4 v[200:203], v1, s[8:11], s18 offen offset:0 sc1
v_exp_f32 v140, v140
v_exp_f32 v141, v141
v_exp_f32 v142, v142
v_exp_f32 v143, v143
v_cvt_pk_bf16_f32 v150, v140, v141
v_cvt_pk_bf16_f32 v151, v142, v143
v_mfma_f32_32x32x16_bf16 v[128:143], v[216:219], v[40:43], 0
v_exp_f32 v112, v112
v_exp_f32 v113, v113
v_exp_f32 v114, v114
v_exp_f32 v115, v115
v_cvt_pk_bf16_f32 v144, v112, v113
v_cvt_pk_bf16_f32 v145, v114, v115
v_mfma_f32_32x32x16_bf16 v[64:79], v[228:231], v[148:151], v[64:79]
v_exp_f32 v116, v116
v_exp_f32 v117, v117
v_exp_f32 v118, v118
v_exp_f32 v119, v119
v_cvt_pk_bf16_f32 v146, v116, v117
v_cvt_pk_bf16_f32 v147, v118, v119
v_mfma_f32_32x32x16_bf16 v[128:143], v[220:223], v[44:47], v[128:143]
s_add_u32 s26, s57, 4096
buffer_load_dwordx4 a[168:171], v1, s[8:11], s26 offen offset:3072
v_exp_f32 v120, v120
v_exp_f32 v121, v121
v_exp_f32 v122, v122
v_exp_f32 v123, v123
v_cvt_pk_bf16_f32 v148, v120, v121
v_cvt_pk_bf16_f32 v149, v122, v123
v_mfma_f32_32x32x16_bf16 v[80:95], v[224:227], v[144:147], v[80:95]
buffer_load_dwordx4 v[204:207], v1, s[8:11], s18 offen offset:1024 sc1
v_exp_f32 v124, v124
v_exp_f32 v125, v125
v_exp_f32 v126, v126
v_exp_f32 v127, v127
v_cvt_pk_bf16_f32 v150, v124, v125
v_cvt_pk_bf16_f32 v151, v126, v127
s_waitcnt vmcnt(45)
v_mfma_f32_32x32x16_bf16 v[112:127], v[232:235], v[16:19], 0
v_exp_f32 v128, v128
v_exp_f32 v129, v129
v_exp_f32 v130, v130
v_exp_f32 v131, v131
v_cvt_pk_bf16_f32 v144, v128, v129
v_cvt_pk_bf16_f32 v145, v130, v131
v_mfma_f32_32x32x16_bf16 v[80:95], v[228:231], v[148:151], v[80:95]
v_exp_f32 v132, v132
v_exp_f32 v133, v133
v_exp_f32 v134, v134
v_exp_f32 v135, v135
v_cvt_pk_bf16_f32 v146, v132, v133
v_cvt_pk_bf16_f32 v147, v134, v135
v_mfma_f32_32x32x16_bf16 v[112:127], v[236:239], v[20:23], v[112:127]
s_add_u32 s26, s58, 4096
buffer_load_dwordx4 a[172:175], v1, s[8:11], s26 offen offset:3072
v_exp_f32 v136, v136
v_exp_f32 v137, v137
v_exp_f32 v138, v138
v_exp_f32 v139, v139
v_cvt_pk_bf16_f32 v148, v136, v137
v_cvt_pk_bf16_f32 v149, v138, v139
v_mfma_f32_32x32x16_bf16 v[96:111], v[224:227], v[144:147], v[96:111]
buffer_load_dwordx4 v[208:211], v1, s[8:11], s18 offen offset:2048 sc1
v_exp_f32 v140, v140
v_exp_f32 v141, v141
v_exp_f32 v142, v142
v_exp_f32 v143, v143
v_cvt_pk_bf16_f32 v150, v140, v141
v_cvt_pk_bf16_f32 v151, v142, v143
v_mfma_f32_32x32x16_bf16 v[128:143], v[232:235], v[24:27], 0
v_exp_f32 v112, v112
v_exp_f32 v113, v113
v_exp_f32 v114, v114
v_exp_f32 v115, v115
v_cvt_pk_bf16_f32 v144, v112, v113
v_cvt_pk_bf16_f32 v145, v114, v115
v_mfma_f32_32x32x16_bf16 v[96:111], v[228:231], v[148:151], v[96:111]
v_exp_f32 v116, v116
v_exp_f32 v117, v117
v_exp_f32 v118, v118
v_exp_f32 v119, v119
v_cvt_pk_bf16_f32 v146, v116, v117
v_cvt_pk_bf16_f32 v147, v118, v119
v_mfma_f32_32x32x16_bf16 v[128:143], v[236:239], v[28:31], v[128:143]
s_add_u32 s26, s57, 8192
buffer_load_dwordx4 a[176:179], v1, s[8:11], s26 offen offset:0
v_exp_f32 v120, v120
v_exp_f32 v121, v121
v_exp_f32 v122, v122
v_exp_f32 v123, v123
v_cvt_pk_bf16_f32 v148, v120, v121
v_cvt_pk_bf16_f32 v149, v122, v123
s_waitcnt vmcnt(42)
v_mfma_f32_32x32x16_bf16 v[48:63], v[240:243], v[144:147], v[48:63]
buffer_load_dwordx4 v[212:215], v1, s[8:11], s18 offen offset:3072 sc1
v_exp_f32 v124, v124
v_exp_f32 v125, v125
v_exp_f32 v126, v126
v_exp_f32 v127, v127
v_cvt_pk_bf16_f32 v150, v124, v125
v_cvt_pk_bf16_f32 v151, v126, v127
v_mfma_f32_32x32x16_bf16 v[112:127], v[232:235], v[32:35], 0
v_exp_f32 v128, v128
v_exp_f32 v129, v129
v_exp_f32 v130, v130
v_exp_f32 v131, v131
v_cvt_pk_bf16_f32 v144, v128, v129
v_cvt_pk_bf16_f32 v145, v130, v131
v_mfma_f32_32x32x16_bf16 v[48:63], v[244:247], v[148:151], v[48:63]
v_exp_f32 v132, v132
v_exp_f32 v133, v133
v_exp_f32 v134, v134
v_exp_f32 v135, v135
v_cvt_pk_bf16_f32 v146, v132, v133
v_cvt_pk_bf16_f32 v147, v134, v135
v_mfma_f32_32x32x16_bf16 v[112:127], v[236:239], v[36:39], v[112:127]
s_add_u32 s26, s58, 8192
buffer_load_dwordx4 a[180:183], v1, s[8:11], s26 offen offset:0
v_exp_f32 v136, v136
v_exp_f32 v137, v137
v_exp_f32 v138, v138
v_exp_f32 v139, v139
v_cvt_pk_bf16_f32 v148, v136, v137
v_cvt_pk_bf16_f32 v149, v138, v139
v_mfma_f32_32x32x16_bf16 v[64:79], v[240:243], v[144:147], v[64:79]
s_add_u32 s26, s57, 8192
buffer_load_dwordx4 a[184:187], v1, s[8:11], s26 offen offset:1024
v_exp_f32 v140, v140
v_exp_f32 v141, v141
v_exp_f32 v142, v142
v_exp_f32 v143, v143
v_cvt_pk_bf16_f32 v150, v140, v141
v_cvt_pk_bf16_f32 v151, v142, v143
v_mfma_f32_32x32x16_bf16 v[128:143], v[232:235], v[40:43], 0
v_exp_f32 v112, v112
v_exp_f32 v113, v113
v_exp_f32 v114, v114
v_exp_f32 v115, v115
v_cvt_pk_bf16_f32 v144, v112, v113
v_cvt_pk_bf16_f32 v145, v114, v115
v_mfma_f32_32x32x16_bf16 v[64:79], v[244:247], v[148:151], v[64:79]
v_exp_f32 v116, v116
v_exp_f32 v117, v117
v_exp_f32 v118, v118
v_exp_f32 v119, v119
v_cvt_pk_bf16_f32 v146, v116, v117
v_cvt_pk_bf16_f32 v147, v118, v119
v_mfma_f32_32x32x16_bf16 v[128:143], v[236:239], v[44:47], v[128:143]
s_add_u32 s26, s58, 8192
buffer_load_dwordx4 a[188:191], v1, s[8:11], s26 offen offset:1024
v_exp_f32 v120, v120
v_exp_f32 v121, v121
v_exp_f32 v122, v122
v_exp_f32 v123, v123
v_cvt_pk_bf16_f32 v148, v120, v121
v_cvt_pk_bf16_f32 v149, v122, v123
v_mfma_f32_32x32x16_bf16 v[80:95], v[240:243], v[144:147], v[80:95]
s_add_u32 s26, s57, 8192
buffer_load_dwordx4 a[192:195], v1, s[8:11], s26 offen offset:2048
v_exp_f32 v124, v124
v_exp_f32 v125, v125
v_exp_f32 v126, v126
v_exp_f32 v127, v127
v_cvt_pk_bf16_f32 v150, v124, v125
v_cvt_pk_bf16_f32 v151, v126, v127
s_waitcnt vmcnt(41)
v_mfma_f32_32x32x16_bf16 v[112:127], v[152:155], v[16:19], 0
v_exp_f32 v128, v128
v_exp_f32 v129, v129
v_exp_f32 v130, v130
v_exp_f32 v131, v131
v_cvt_pk_bf16_f32 v144, v128, v129
v_cvt_pk_bf16_f32 v145, v130, v131
v_mfma_f32_32x32x16_bf16 v[80:95], v[244:247], v[148:151], v[80:95]
v_exp_f32 v132, v132
v_exp_f32 v133, v133
v_exp_f32 v134, v134
v_exp_f32 v135, v135
v_cvt_pk_bf16_f32 v146, v132, v133
v_cvt_pk_bf16_f32 v147, v134, v135
v_mfma_f32_32x32x16_bf16 v[112:127], v[156:159], v[20:23], v[112:127]
s_add_u32 s26, s58, 8192
buffer_load_dwordx4 a[196:199], v1, s[8:11], s26 offen offset:2048
v_exp_f32 v136, v136
v_exp_f32 v137, v137
v_exp_f32 v138, v138
v_exp_f32 v139, v139
v_cvt_pk_bf16_f32 v148, v136, v137
v_cvt_pk_bf16_f32 v149, v138, v139
v_mfma_f32_32x32x16_bf16 v[96:111], v[240:243], v[144:147], v[96:111]
s_add_u32 s26, s57, 8192
buffer_load_dwordx4 a[200:203], v1, s[8:11], s26 offen offset:3072
v_exp_f32 v140, v140
v_exp_f32 v141, v141
v_exp_f32 v142, v142
v_exp_f32 v143, v143
v_cvt_pk_bf16_f32 v150, v140, v141
v_cvt_pk_bf16_f32 v151, v142, v143
v_mfma_f32_32x32x16_bf16 v[128:143], v[152:155], v[24:27], 0
v_exp_f32 v112, v112
v_exp_f32 v113, v113
v_exp_f32 v114, v114
v_exp_f32 v115, v115
v_cvt_pk_bf16_f32 v144, v112, v113
v_cvt_pk_bf16_f32 v145, v114, v115
v_mfma_f32_32x32x16_bf16 v[96:111], v[244:247], v[148:151], v[96:111]
v_exp_f32 v116, v116
v_exp_f32 v117, v117
v_exp_f32 v118, v118
v_exp_f32 v119, v119
v_cvt_pk_bf16_f32 v146, v116, v117
v_cvt_pk_bf16_f32 v147, v118, v119
v_mfma_f32_32x32x16_bf16 v[128:143], v[156:159], v[28:31], v[128:143]
s_add_u32 s26, s58, 8192
buffer_load_dwordx4 a[204:207], v1, s[8:11], s26 offen offset:3072
v_exp_f32 v120, v120
v_exp_f32 v121, v121
v_exp_f32 v122, v122
v_exp_f32 v123, v123
v_cvt_pk_bf16_f32 v148, v120, v121
v_cvt_pk_bf16_f32 v149, v122, v123
s_waitcnt vmcnt(38)
v_mfma_f32_32x32x16_bf16 v[48:63], v[160:163], v[144:147], v[48:63]
s_add_u32 s26, s57, 12288
buffer_load_dwordx4 a[208:211], v1, s[8:11], s26 offen offset:0
v_exp_f32 v124, v124
v_exp_f32 v125, v125
v_exp_f32 v126, v126
v_exp_f32 v127, v127
v_cvt_pk_bf16_f32 v150, v124, v125
v_cvt_pk_bf16_f32 v151, v126, v127
v_mfma_f32_32x32x16_bf16 v[112:127], v[152:155], v[32:35], 0
v_exp_f32 v128, v128
v_exp_f32 v129, v129
v_exp_f32 v130, v130
v_exp_f32 v131, v131
v_cvt_pk_bf16_f32 v144, v128, v129
v_cvt_pk_bf16_f32 v145, v130, v131
v_mfma_f32_32x32x16_bf16 v[48:63], v[164:167], v[148:151], v[48:63]
v_exp_f32 v132, v132
v_exp_f32 v133, v133
v_exp_f32 v134, v134
v_exp_f32 v135, v135
v_cvt_pk_bf16_f32 v146, v132, v133
v_cvt_pk_bf16_f32 v147, v134, v135
v_mfma_f32_32x32x16_bf16 v[112:127], v[156:159], v[36:39], v[112:127]
s_add_u32 s26, s58, 12288
buffer_load_dwordx4 a[212:215], v1, s[8:11], s26 offen offset:0
v_exp_f32 v136, v136
v_exp_f32 v137, v137
v_exp_f32 v138, v138
v_exp_f32 v139, v139
v_cvt_pk_bf16_f32 v148, v136, v137
v_cvt_pk_bf16_f32 v149, v138, v139
v_mfma_f32_32x32x16_bf16 v[64:79], v[160:163], v[144:147], v[64:79]
s_add_u32 s26, s57, 12288
buffer_load_dwordx4 a[216:219], v1, s[8:11], s26 offen offset:1024
v_exp_f32 v140, v140
v_exp_f32 v141, v141
v_exp_f32 v142, v142
v_exp_f32 v143, v143
v_cvt_pk_bf16_f32 v150, v140, v141
v_cvt_pk_bf16_f32 v151, v142, v143
v_mfma_f32_32x32x16_bf16 v[128:143], v[152:155], v[40:43], 0
v_exp_f32 v112, v112
v_exp_f32 v113, v113
v_exp_f32 v114, v114
v_exp_f32 v115, v115
v_cvt_pk_bf16_f32 v144, v112, v113
v_cvt_pk_bf16_f32 v145, v114, v115
v_mfma_f32_32x32x16_bf16 v[64:79], v[164:167], v[148:151], v[64:79]
v_exp_f32 v116, v116
v_exp_f32 v117, v117
v_exp_f32 v118, v118
v_exp_f32 v119, v119
v_cvt_pk_bf16_f32 v146, v116, v117
v_cvt_pk_bf16_f32 v147, v118, v119
v_mfma_f32_32x32x16_bf16 v[128:143], v[156:159], v[44:47], v[128:143]
s_add_u32 s26, s58, 12288
buffer_load_dwordx4 a[220:223], v1, s[8:11], s26 offen offset:1024
v_exp_f32 v120, v120
v_exp_f32 v121, v121
v_exp_f32 v122, v122
v_exp_f32 v123, v123
v_cvt_pk_bf16_f32 v148, v120, v121
v_cvt_pk_bf16_f32 v149, v122, v123
v_mfma_f32_32x32x16_bf16 v[80:95], v[160:163], v[144:147], v[80:95]
s_add_u32 s26, s57, 12288
buffer_load_dwordx4 a[224:227], v1, s[8:11], s26 offen offset:2048
v_exp_f32 v124, v124
v_exp_f32 v125, v125
v_exp_f32 v126, v126
v_exp_f32 v127, v127
v_cvt_pk_bf16_f32 v150, v124, v125
v_cvt_pk_bf16_f32 v151, v126, v127
s_waitcnt vmcnt(37)
v_mfma_f32_32x32x16_bf16 v[112:127], v[168:171], v[16:19], 0
v_exp_f32 v128, v128
v_exp_f32 v129, v129
v_exp_f32 v130, v130
v_exp_f32 v131, v131
v_cvt_pk_bf16_f32 v144, v128, v129
v_cvt_pk_bf16_f32 v145, v130, v131
v_mfma_f32_32x32x16_bf16 v[80:95], v[164:167], v[148:151], v[80:95]
v_exp_f32 v132, v132
v_exp_f32 v133, v133
v_exp_f32 v134, v134
v_exp_f32 v135, v135
v_cvt_pk_bf16_f32 v146, v132, v133
v_cvt_pk_bf16_f32 v147, v134, v135
v_mfma_f32_32x32x16_bf16 v[112:127], v[172:175], v[20:23], v[112:127]
s_add_u32 s26, s58, 12288
buffer_load_dwordx4 a[228:231], v1, s[8:11], s26 offen offset:2048
v_exp_f32 v136, v136
v_exp_f32 v137, v137
v_exp_f32 v138, v138
v_exp_f32 v139, v139
v_cvt_pk_bf16_f32 v148, v136, v137
v_cvt_pk_bf16_f32 v149, v138, v139
v_mfma_f32_32x32x16_bf16 v[96:111], v[160:163], v[144:147], v[96:111]
s_add_u32 s26, s57, 12288
buffer_load_dwordx4 a[232:235], v1, s[8:11], s26 offen offset:3072
v_exp_f32 v140, v140
v_exp_f32 v141, v141
v_exp_f32 v142, v142
v_exp_f32 v143, v143
v_cvt_pk_bf16_f32 v150, v140, v141
v_cvt_pk_bf16_f32 v151, v142, v143
v_mfma_f32_32x32x16_bf16 v[128:143], v[168:171], v[24:27], 0
v_exp_f32 v112, v112
v_exp_f32 v113, v113
v_exp_f32 v114, v114
v_exp_f32 v115, v115
v_cvt_pk_bf16_f32 v144, v112, v113
v_cvt_pk_bf16_f32 v145, v114, v115
v_mfma_f32_32x32x16_bf16 v[96:111], v[164:167], v[148:151], v[96:111]
v_exp_f32 v116, v116
v_exp_f32 v117, v117
v_exp_f32 v118, v118
v_exp_f32 v119, v119
v_cvt_pk_bf16_f32 v146, v116, v117
v_cvt_pk_bf16_f32 v147, v118, v119
v_mfma_f32_32x32x16_bf16 v[128:143], v[172:175], v[28:31], v[128:143]
s_add_u32 s26, s58, 12288
buffer_load_dwordx4 a[236:239], v1, s[8:11], s26 offen offset:3072
v_exp_f32 v120, v120
v_exp_f32 v121, v121
v_exp_f32 v122, v122
v_exp_f32 v123, v123
v_cvt_pk_bf16_f32 v148, v120, v121
v_cvt_pk_bf16_f32 v149, v122, v123
s_waitcnt vmcnt(34)
v_mfma_f32_32x32x16_bf16 v[48:63], v[176:179], v[144:147], v[48:63]
s_add_u32 s26, s57, 16384
buffer_load_dwordx4 a[240:243], v1, s[8:11], s26 offen offset:0
v_exp_f32 v124, v124
v_exp_f32 v125, v125
v_exp_f32 v126, v126
v_exp_f32 v127, v127
v_cvt_pk_bf16_f32 v150, v124, v125
v_cvt_pk_bf16_f32 v151, v126, v127
v_mfma_f32_32x32x16_bf16 v[112:127], v[168:171], v[32:35], 0
v_exp_f32 v128, v128
v_exp_f32 v129, v129
v_exp_f32 v130, v130
v_exp_f32 v131, v131
v_cvt_pk_bf16_f32 v144, v128, v129
v_cvt_pk_bf16_f32 v145, v130, v131
v_mfma_f32_32x32x16_bf16 v[48:63], v[180:183], v[148:151], v[48:63]
v_exp_f32 v132, v132
v_exp_f32 v133, v133
v_exp_f32 v134, v134
v_exp_f32 v135, v135
v_cvt_pk_bf16_f32 v146, v132, v133
v_cvt_pk_bf16_f32 v147, v134, v135
v_mfma_f32_32x32x16_bf16 v[112:127], v[172:175], v[36:39], v[112:127]
s_add_u32 s26, s58, 16384
buffer_load_dwordx4 a[244:247], v1, s[8:11], s26 offen offset:0
v_exp_f32 v136, v136
v_exp_f32 v137, v137
v_exp_f32 v138, v138
v_exp_f32 v139, v139
v_cvt_pk_bf16_f32 v148, v136, v137
v_cvt_pk_bf16_f32 v149, v138, v139
v_mfma_f32_32x32x16_bf16 v[64:79], v[176:179], v[144:147], v[64:79]
s_add_u32 s26, s57, 16384
buffer_load_dwordx4 a[248:251], v1, s[8:11], s26 offen offset:1024
v_exp_f32 v140, v140
v_exp_f32 v141, v141
v_exp_f32 v142, v142
v_exp_f32 v143, v143
v_cvt_pk_bf16_f32 v150, v140, v141
v_cvt_pk_bf16_f32 v151, v142, v143
v_mfma_f32_32x32x16_bf16 v[128:143], v[168:171], v[40:43], 0
v_exp_f32 v112, v112
v_exp_f32 v113, v113
v_exp_f32 v114, v114
v_exp_f32 v115, v115
v_cvt_pk_bf16_f32 v144, v112, v113
v_cvt_pk_bf16_f32 v145, v114, v115
v_mfma_f32_32x32x16_bf16 v[64:79], v[180:183], v[148:151], v[64:79]
v_exp_f32 v116, v116
v_exp_f32 v117, v117
v_exp_f32 v118, v118
v_exp_f32 v119, v119
v_cvt_pk_bf16_f32 v146, v116, v117
v_cvt_pk_bf16_f32 v147, v118, v119
v_mfma_f32_32x32x16_bf16 v[128:143], v[172:175], v[44:47], v[128:143]
s_add_u32 s26, s58, 16384
buffer_load_dwordx4 a[252:255], v1, s[8:11], s26 offen offset:1024
v_exp_f32 v120, v120
v_exp_f32 v121, v121
v_exp_f32 v122, v122
v_exp_f32 v123, v123
v_cvt_pk_bf16_f32 v148, v120, v121
v_cvt_pk_bf16_f32 v149, v122, v123
v_mfma_f32_32x32x16_bf16 v[80:95], v[176:179], v[144:147], v[80:95]
v_exp_f32 v124, v124
v_exp_f32 v125, v125
v_exp_f32 v126, v126
v_exp_f32 v127, v127
v_cvt_pk_bf16_f32 v150, v124, v125
v_cvt_pk_bf16_f32 v151, v126, v127
s_waitcnt vmcnt(32)
v_mfma_f32_32x32x16_bf16 v[112:127], v[184:187], v[16:19], 0
v_exp_f32 v128, v128
v_exp_f32 v129, v129
v_exp_f32 v130, v130
v_exp_f32 v131, v131
v_cvt_pk_bf16_f32 v144, v128, v129
v_cvt_pk_bf16_f32 v145, v130, v131
v_mfma_f32_32x32x16_bf16 v[80:95], v[180:183], v[148:151], v[80:95]
v_exp_f32 v132, v132
v_exp_f32 v133, v133
v_exp_f32 v134, v134
v_exp_f32 v135, v135
v_cvt_pk_bf16_f32 v146, v132, v133
v_cvt_pk_bf16_f32 v147, v134, v135
v_mfma_f32_32x32x16_bf16 v[112:127], v[188:191], v[20:23], v[112:127]
v_exp_f32 v136, v136
v_exp_f32 v137, v137
v_exp_f32 v138, v138
v_exp_f32 v139, v139
v_cvt_pk_bf16_f32 v148, v136, v137
v_cvt_pk_bf16_f32 v149, v138, v139
v_mfma_f32_32x32x16_bf16 v[96:111], v[176:179], v[144:147], v[96:111]
v_exp_f32 v140, v140
v_exp_f32 v141, v141
v_exp_f32 v142, v142
v_exp_f32 v143, v143
v_cvt_pk_bf16_f32 v150, v140, v141
v_cvt_pk_bf16_f32 v151, v142, v143
v_mfma_f32_32x32x16_bf16 v[128:143], v[184:187], v[24:27], 0
v_exp_f32 v112, v112
v_exp_f32 v113, v113
v_exp_f32 v114, v114
v_exp_f32 v115, v115
v_cvt_pk_bf16_f32 v144, v112, v113
v_cvt_pk_bf16_f32 v145, v114, v115
v_mfma_f32_32x32x16_bf16 v[96:111], v[180:183], v[148:151], v[96:111]
v_exp_f32 v116, v116
v_exp_f32 v117, v117
v_exp_f32 v118, v118
v_exp_f32 v119, v119
v_cvt_pk_bf16_f32 v146, v116, v117
v_cvt_pk_bf16_f32 v147, v118, v119
v_mfma_f32_32x32x16_bf16 v[128:143], v[188:191], v[28:31], v[128:143]
v_exp_f32 v120, v120
v_exp_f32 v121, v121
v_exp_f32 v122, v122
v_exp_f32 v123, v123
v_cvt_pk_bf16_f32 v148, v120, v121
v_cvt_pk_bf16_f32 v149, v122, v123
s_waitcnt vmcnt(27)
v_mfma_f32_32x32x16_bf16 v[48:63], v[192:195], v[144:147], v[48:63]
v_exp_f32 v124, v124
v_exp_f32 v125, v125
v_exp_f32 v126, v126
v_exp_f32 v127, v127
v_cvt_pk_bf16_f32 v150, v124, v125
v_cvt_pk_bf16_f32 v151, v126, v127
v_mfma_f32_32x32x16_bf16 v[112:127], v[184:187], v[32:35], 0
v_exp_f32 v128, v128
v_exp_f32 v129, v129
v_exp_f32 v130, v130
v_exp_f32 v131, v131
v_cvt_pk_bf16_f32 v144, v128, v129
v_cvt_pk_bf16_f32 v145, v130, v131
v_mfma_f32_32x32x16_bf16 v[48:63], v[196:199], v[148:151], v[48:63]
v_exp_f32 v132, v132
v_exp_f32 v133, v133
v_exp_f32 v134, v134
v_exp_f32 v135, v135
v_cvt_pk_bf16_f32 v146, v132, v133
v_cvt_pk_bf16_f32 v147, v134, v135
v_mfma_f32_32x32x16_bf16 v[112:127], v[188:191], v[36:39], v[112:127]
v_exp_f32 v136, v136
v_exp_f32 v137, v137
v_exp_f32 v138, v138
v_exp_f32 v139, v139
v_cvt_pk_bf16_f32 v148, v136, v137
v_cvt_pk_bf16_f32 v149, v138, v139
v_mfma_f32_32x32x16_bf16 v[64:79], v[192:195], v[144:147], v[64:79]
v_exp_f32 v140, v140
v_exp_f32 v141, v141
v_exp_f32 v142, v142
v_exp_f32 v143, v143
v_cvt_pk_bf16_f32 v150, v140, v141
v_cvt_pk_bf16_f32 v151, v142, v143
v_mfma_f32_32x32x16_bf16 v[128:143], v[184:187], v[40:43], 0
v_exp_f32 v112, v112
v_exp_f32 v113, v113
v_exp_f32 v114, v114
v_exp_f32 v115, v115
v_cvt_pk_bf16_f32 v144, v112, v113
v_cvt_pk_bf16_f32 v145, v114, v115
v_mfma_f32_32x32x16_bf16 v[64:79], v[196:199], v[148:151], v[64:79]
v_exp_f32 v116, v116
v_exp_f32 v117, v117
v_exp_f32 v118, v118
v_exp_f32 v119, v119
v_cvt_pk_bf16_f32 v146, v116, v117
v_cvt_pk_bf16_f32 v147, v118, v119
v_mfma_f32_32x32x16_bf16 v[128:143], v[188:191], v[44:47], v[128:143]
v_exp_f32 v120, v120
v_exp_f32 v121, v121
v_exp_f32 v122, v122
v_exp_f32 v123, v123
v_cvt_pk_bf16_f32 v148, v120, v121
v_cvt_pk_bf16_f32 v149, v122, v123
v_mfma_f32_32x32x16_bf16 v[80:95], v[192:195], v[144:147], v[80:95]
v_exp_f32 v124, v124
v_exp_f32 v125, v125
v_exp_f32 v126, v126
v_exp_f32 v127, v127
v_cvt_pk_bf16_f32 v150, v124, v125
v_cvt_pk_bf16_f32 v151, v126, v127
s_waitcnt vmcnt(23)
v_mfma_f32_32x32x16_bf16 v[112:127], v[200:203], v[16:19], 0
v_exp_f32 v128, v128
v_exp_f32 v129, v129
v_exp_f32 v130, v130
v_exp_f32 v131, v131
v_cvt_pk_bf16_f32 v144, v128, v129
v_cvt_pk_bf16_f32 v145, v130, v131
v_mfma_f32_32x32x16_bf16 v[80:95], v[196:199], v[148:151], v[80:95]
v_exp_f32 v132, v132
v_exp_f32 v133, v133
v_exp_f32 v134, v134
v_exp_f32 v135, v135
v_cvt_pk_bf16_f32 v146, v132, v133
v_cvt_pk_bf16_f32 v147, v134, v135
v_mfma_f32_32x32x16_bf16 v[112:127], v[204:207], v[20:23], v[112:127]
v_exp_f32 v136, v136
v_exp_f32 v137, v137
v_exp_f32 v138, v138
v_exp_f32 v139, v139
v_cvt_pk_bf16_f32 v148, v136, v137
v_cvt_pk_bf16_f32 v149, v138, v139
v_mfma_f32_32x32x16_bf16 v[96:111], v[192:195], v[144:147], v[96:111]
v_exp_f32 v140, v140
v_exp_f32 v141, v141
v_exp_f32 v142, v142
v_exp_f32 v143, v143
v_cvt_pk_bf16_f32 v150, v140, v141
v_cvt_pk_bf16_f32 v151, v142, v143
v_mfma_f32_32x32x16_bf16 v[128:143], v[200:203], v[24:27], 0
v_exp_f32 v112, v112
v_exp_f32 v113, v113
v_exp_f32 v114, v114
v_exp_f32 v115, v115
v_cvt_pk_bf16_f32 v144, v112, v113
v_cvt_pk_bf16_f32 v145, v114, v115
v_mfma_f32_32x32x16_bf16 v[96:111], v[196:199], v[148:151], v[96:111]
v_exp_f32 v116, v116
v_exp_f32 v117, v117
v_exp_f32 v118, v118
v_exp_f32 v119, v119
v_cvt_pk_bf16_f32 v146, v116, v117
v_cvt_pk_bf16_f32 v147, v118, v119
v_mfma_f32_32x32x16_bf16 v[128:143], v[204:207], v[28:31], v[128:143]
v_exp_f32 v120, v120
v_exp_f32 v121, v121
v_exp_f32 v122, v122
v_exp_f32 v123, v123
v_cvt_pk_bf16_f32 v148, v120, v121
v_cvt_pk_bf16_f32 v149, v122, v123
s_waitcnt vmcnt(19)
v_mfma_f32_32x32x16_bf16 v[48:63], v[208:211], v[144:147], v[48:63]
v_exp_f32 v124, v124
v_exp_f32 v125, v125
v_exp_f32 v126, v126
v_exp_f32 v127, v127
v_cvt_pk_bf16_f32 v150, v124, v125
v_cvt_pk_bf16_f32 v151, v126, v127
v_mfma_f32_32x32x16_bf16 v[112:127], v[200:203], v[32:35], 0
v_exp_f32 v128, v128
v_exp_f32 v129, v129
v_exp_f32 v130, v130
v_exp_f32 v131, v131
v_cvt_pk_bf16_f32 v144, v128, v129
v_cvt_pk_bf16_f32 v145, v130, v131
v_mfma_f32_32x32x16_bf16 v[48:63], v[212:215], v[148:151], v[48:63]
v_exp_f32 v132, v132
v_exp_f32 v133, v133
v_exp_f32 v134, v134
v_exp_f32 v135, v135
v_cvt_pk_bf16_f32 v146, v132, v133
v_cvt_pk_bf16_f32 v147, v134, v135
v_mfma_f32_32x32x16_bf16 v[112:127], v[204:207], v[36:39], v[112:127]
v_exp_f32 v136, v136
v_exp_f32 v137, v137
v_exp_f32 v138, v138
v_exp_f32 v139, v139
v_cvt_pk_bf16_f32 v148, v136, v137
v_cvt_pk_bf16_f32 v149, v138, v139
v_mfma_f32_32x32x16_bf16 v[64:79], v[208:211], v[144:147], v[64:79]
v_exp_f32 v140, v140
v_exp_f32 v141, v141
v_exp_f32 v142, v142
v_exp_f32 v143, v143
v_cvt_pk_bf16_f32 v150, v140, v141
v_cvt_pk_bf16_f32 v151, v142, v143
v_mfma_f32_32x32x16_bf16 v[128:143], v[200:203], v[40:43], 0
v_exp_f32 v112, v112
v_exp_f32 v113, v113
v_exp_f32 v114, v114
v_exp_f32 v115, v115
v_cvt_pk_bf16_f32 v144, v112, v113
v_cvt_pk_bf16_f32 v145, v114, v115
v_mfma_f32_32x32x16_bf16 v[64:79], v[212:215], v[148:151], v[64:79]
v_exp_f32 v116, v116
v_exp_f32 v117, v117
v_exp_f32 v118, v118
v_exp_f32 v119, v119
v_cvt_pk_bf16_f32 v146, v116, v117
v_cvt_pk_bf16_f32 v147, v118, v119
v_mfma_f32_32x32x16_bf16 v[128:143], v[204:207], v[44:47], v[128:143]
v_exp_f32 v120, v120
v_exp_f32 v121, v121
v_exp_f32 v122, v122
v_exp_f32 v123, v123
v_cvt_pk_bf16_f32 v148, v120, v121
v_cvt_pk_bf16_f32 v149, v122, v123
v_mfma_f32_32x32x16_bf16 v[80:95], v[208:211], v[144:147], v[80:95]
v_exp_f32 v124, v124
v_exp_f32 v125, v125
v_exp_f32 v126, v126
v_exp_f32 v127, v127
v_cvt_pk_bf16_f32 v150, v124, v125
v_cvt_pk_bf16_f32 v151, v126, v127
v_exp_f32 v128, v128
v_exp_f32 v129, v129
v_exp_f32 v130, v130
v_exp_f32 v131, v131
v_cvt_pk_bf16_f32 v144, v128, v129
v_cvt_pk_bf16_f32 v145, v130, v131
v_mfma_f32_32x32x16_bf16 v[80:95], v[212:215], v[148:151], v[80:95]
v_exp_f32 v132, v132
v_exp_f32 v133, v133
v_exp_f32 v134, v134
v_exp_f32 v135, v135
v_cvt_pk_bf16_f32 v146, v132, v133
v_cvt_pk_bf16_f32 v147, v134, v135
v_exp_f32 v136, v136
v_exp_f32 v137, v137
v_exp_f32 v138, v138
v_exp_f32 v139, v139
v_cvt_pk_bf16_f32 v148, v136, v137
v_cvt_pk_bf16_f32 v149, v138, v139
v_mfma_f32_32x32x16_bf16 v[96:111], v[208:211], v[144:147], v[96:111]
v_exp_f32 v140, v140
v_exp_f32 v141, v141
v_exp_f32 v142, v142
v_exp_f32 v143, v143
v_cvt_pk_bf16_f32 v150, v140, v141
v_cvt_pk_bf16_f32 v151, v142, v143
s_nop 1
v_mfma_f32_32x32x16_bf16 v[96:111], v[212:215], v[148:151], v[96:111]
s_sub_u32 s20, s3, 1
s_and_b32 s20, s20, 3
s_lshl_b32 s20, s20, 12
s_add_u32 s20, s20, 114688
v_add_u32 v4, s20, v1
s_sub_u32 s20, s3, 2
s_and_b32 s20, s20, 3
s_lshl_b32 s20, s20, 12
s_add_u32 s20, s20, 126976
v_add_u32 v5, s20, v1
s_sub_u32 s20, s3, 3
s_and_b32 s20, s20, 3
s_lshl_b32 s20, s20, 12
s_add_u32 s20, s20, 139264
v_add_u32 v6, s20, v1
s_sub_u32 s20, s3, 4
s_and_b32 s20, s20, 3
s_lshl_b32 s20, s20, 12
s_add_u32 s20, s20, 151552
v_add_u32 v7, s20, v1
s_mul_i32 s20, s3, 12288
s_add_u32 s20, s20, 114688
v_add_u32 v12, s20, v1
s_lshl_b32 s28, s3, 2
s_add_u32 s28, s28, 113664
v_mov_b32 v9, s28
v_mov_b32 v10, 113664
v_mov_b32 v8, 0x1f800000
s_lshl_b32 s25, s43, 2
s_add_u32 s25, s25, s3
s_lshl_b32 s25, s25, 5
s_lshl_b32 s26, s42, 1
s_add_u32 s25, s25, s26
s_lshl_b32 s25, s25, 10
s_add_u32 s25, s25, 53477376
s_cmp_eq_u32 s3, 0
s_cbranch_scc1 main_kernel_b1_own0
ds_write_b128 v4, v[48:51] offset:0
ds_write_b128 v4, v[52:55] offset:1024
ds_write_b128 v4, v[56:59] offset:2048
ds_write_b128 v4, v[60:63] offset:3072
s_branch main_kernel_b1_nx0
main_kernel_b1_own0:
v_mov_b32 v112, v48
v_mov_b32 v113, v49
v_mov_b32 v114, v50
v_mov_b32 v115, v51
v_mov_b32 v116, v52
v_mov_b32 v117, v53
v_mov_b32 v118, v54
v_mov_b32 v119, v55
v_mov_b32 v120, v56
v_mov_b32 v121, v57
v_mov_b32 v122, v58
v_mov_b32 v123, v59
v_mov_b32 v124, v60
v_mov_b32 v125, v61
v_mov_b32 v126, v62
v_mov_b32 v127, v63
main_kernel_b1_nx0:
s_cmp_eq_u32 s3, 1
s_cbranch_scc1 main_kernel_b1_own1
ds_write_b128 v5, v[64:67] offset:0
ds_write_b128 v5, v[68:71] offset:1024
ds_write_b128 v5, v[72:75] offset:2048
ds_write_b128 v5, v[76:79] offset:3072
s_branch main_kernel_b1_nx1
main_kernel_b1_own1:
v_mov_b32 v112, v64
v_mov_b32 v113, v65
v_mov_b32 v114, v66
v_mov_b32 v115, v67
v_mov_b32 v116, v68
v_mov_b32 v117, v69
v_mov_b32 v118, v70
v_mov_b32 v119, v71
v_mov_b32 v120, v72
v_mov_b32 v121, v73
v_mov_b32 v122, v74
v_mov_b32 v123, v75
v_mov_b32 v124, v76
v_mov_b32 v125, v77
v_mov_b32 v126, v78
v_mov_b32 v127, v79
main_kernel_b1_nx1:
s_cmp_eq_u32 s3, 2
s_cbranch_scc1 main_kernel_b1_own2
ds_write_b128 v6, v[80:83] offset:0
ds_write_b128 v6, v[84:87] offset:1024
ds_write_b128 v6, v[88:91] offset:2048
ds_write_b128 v6, v[92:95] offset:3072
s_branch main_kernel_b1_nx2
main_kernel_b1_own2:
v_mov_b32 v112, v80
v_mov_b32 v113, v81
v_mov_b32 v114, v82
v_mov_b32 v115, v83
v_mov_b32 v116, v84
v_mov_b32 v117, v85
v_mov_b32 v118, v86
v_mov_b32 v119, v87
v_mov_b32 v120, v88
v_mov_b32 v121, v89
v_mov_b32 v122, v90
v_mov_b32 v123, v91
v_mov_b32 v124, v92
v_mov_b32 v125, v93
v_mov_b32 v126, v94
v_mov_b32 v127, v95
main_kernel_b1_nx2:
s_nop 3
s_cmp_eq_u32 s3, 3
s_cbranch_scc1 main_kernel_b1_own3
ds_write_b128 v7, v[96:99] offset:0
ds_write_b128 v7, v[100:103] offset:1024
ds_write_b128 v7, v[104:107] offset:2048
ds_write_b128 v7, v[108:111] offset:3072
s_branch main_kernel_b1_nx3
main_kernel_b1_own3:
v_mov_b32 v112, v96
v_mov_b32 v113, v97
v_mov_b32 v114, v98
v_mov_b32 v115, v99
v_mov_b32 v116, v100
v_mov_b32 v117, v101
v_mov_b32 v118, v102
v_mov_b32 v119, v103
v_mov_b32 v120, v104
v_mov_b32 v121, v105
v_mov_b32 v122, v106
v_mov_b32 v123, v107
v_mov_b32 v124, v108
v_mov_b32 v125, v109
v_mov_b32 v126, v110
v_mov_b32 v127, v111
main_kernel_b1_nx3:
s_mov_b64 s[30:31], 0
v_cmp_nge_f32 vcc, 0x5d800000, v60
v_cmp_nge_f32 s[28:29], v60, v8
s_or_b32 s31, s31, vcc_hi
s_or_b32 s31, s31, s29
v_cmp_nge_f32 vcc, 0x5d800000, v76
v_cmp_nge_f32 s[28:29], v76, v8
s_or_b32 s31, s31, vcc_hi
s_or_b32 s31, s31, s29
v_cmp_nge_f32 vcc, 0x5d800000, v92
v_cmp_nge_f32 s[28:29], v92, v8
s_or_b32 s31, s31, vcc_hi
s_or_b32 s31, s31, s29
v_cmp_nge_f32 vcc, 0x5d800000, v108
v_cmp_nge_f32 s[28:29], v108, v8
s_or_b32 s31, s31, vcc_hi
s_or_b32 s31, s31, s29
s_cmp_lg_u32 s31, 0
s_cselect_b32 s27, 1, 0
v_mov_b32 v8, s27
ds_write_b32 v9, v8
s_waitcnt lgkmcnt(0)
s_barrier
ds_read_b128 v[4:7], v10
ds_read_b128 v[152:155], v12 offset:0
ds_read_b128 v[156:159], v12 offset:1024
ds_read_b128 v[160:163], v12 offset:2048
ds_read_b128 v[164:167], v12 offset:3072
ds_read_b128 v[168:171], v12 offset:4096
ds_read_b128 v[172:175], v12 offset:5120
ds_read_b128 v[176:179], v12 offset:6144
ds_read_b128 v[180:183], v12 offset:7168
ds_read_b128 v[184:187], v12 offset:8192
ds_read_b128 v[188:191], v12 offset:9216
ds_read_b128 v[192:195], v12 offset:10240
ds_read_b128 v[196:199], v12 offset:11264
s_cmp_lg_u32 s19, 0
s_cbranch_scc1 main_kernel_b1_fin
s_waitcnt lgkmcnt(12)
v_or3_b32 v8, v4, v5, v6
v_or_b32 v8, v8, v7
s_nop 0
v_readfirstlane_b32 s27, v8
s_cmp_lg_u32 s27, 0
s_cbranch_scc1 main_kernel_b1_slow
main_kernel_b1_fin:
s_waitcnt lgkmcnt(8)
v_add_f32 v112, v112, v152
v_add_f32 v113, v113, v153
v_add_f32 v114, v114, v154
v_add_f32 v115, v115, v155
v_add_f32 v116, v116, v156
v_add_f32 v117, v117, v157
v_add_f32 v118, v118, v158
v_add_f32 v119, v119, v159
v_add_f32 v120, v120, v160
v_add_f32 v121, v121, v161
v_add_f32 v122, v122, v162
v_add_f32 v123, v123, v163
v_add_f32 v124, v124, v164
v_add_f32 v125, v125, v165
v_add_f32 v126, v126, v166
v_add_f32 v127, v127, v167
s_waitcnt lgkmcnt(4)
v_add_f32 v112, v112, v168
v_add_f32 v113, v113, v169
v_add_f32 v114, v114, v170
v_add_f32 v115, v115, v171
v_add_f32 v116, v116, v172
v_add_f32 v117, v117, v173
v_add_f32 v118, v118, v174
v_add_f32 v119, v119, v175
v_add_f32 v120, v120, v176
v_add_f32 v121, v121, v177
v_add_f32 v122, v122, v178
v_add_f32 v123, v123, v179
v_add_f32 v124, v124, v180
v_add_f32 v125, v125, v181
v_add_f32 v126, v126, v182
v_add_f32 v127, v127, v183
s_waitcnt lgkmcnt(0)
v_add_f32 v112, v112, v184
v_add_f32 v113, v113, v185
v_add_f32 v114, v114, v186
v_add_f32 v115, v115, v187
v_add_f32 v116, v116, v188
v_add_f32 v117, v117, v189
v_add_f32 v118, v118, v190
v_add_f32 v119, v119, v191
v_add_f32 v120, v120, v192
v_add_f32 v121, v121, v193
v_add_f32 v122, v122, v194
v_add_f32 v123, v123, v195
v_add_f32 v124, v124, v196
v_add_f32 v125, v125, v197
v_add_f32 v126, v126, v198
v_add_f32 v127, v127, v199
v_mov_b32 v8, v124
v_mov_b32 v9, v124
s_nop 1
v_permlane32_swap_b32 v8, v9
s_nop 1
v_rcp_f32 v9, v9
s_nop 0
v_mul_f32 v112, v112, v9
v_mul_f32 v113, v113, v9
v_mul_f32 v114, v114, v9
v_mul_f32 v115, v115, v9
v_mul_f32 v116, v116, v9
v_mul_f32 v117, v117, v9
v_mul_f32 v118, v118, v9
v_mul_f32 v119, v119, v9
v_mul_f32 v120, v120, v9
v_mul_f32 v121, v121, v9
v_mul_f32 v122, v122, v9
v_mul_f32 v123, v123, v9
v_mul_f32 v124, v124, v9
v_mul_f32 v125, v125, v9
v_mul_f32 v126, v126, v9
v_mul_f32 v127, v127, v9
v_cvt_pk_bf16_f32 v144, v112, v113
v_cvt_pk_bf16_f32 v145, v114, v115
v_cvt_pk_bf16_f32 v146, v116, v117
v_cvt_pk_bf16_f32 v147, v118, v119
v_cvt_pk_bf16_f32 v148, v120, v121
v_cvt_pk_bf16_f32 v149, v122, v123
v_cvt_pk_bf16_f32 v150, v124, v125
v_cvt_pk_bf16_f32 v151, v126, v127
buffer_store_dwordx4 v[144:147], v1, s[8:11], s25 offen offset:0 sc1
buffer_store_dwordx4 v[148:151], v1, s[8:11], s25 offen offset:1024 sc1
s_lshl_b32 s13, s43, 7
s_add_u32 s13, s13, 30027776
s_waitcnt vmcnt(0)
s_barrier
s_cmp_lg_u32 s3, 0
s_cbranch_scc1 main_kernel_sg14
v_mov_b32 v4, 1
v_mov_b32 v5, 0
s_mov_b64 exec, 1
buffer_atomic_add v4, v5, s[8:11], s13 offen sc1
s_mov_b64 exec, -1
main_kernel_sg14:
s_add_u32 s24, s53, 86016
s_mov_b32 m0, s24
s_add_u32 s25, s54, 86016
buffer_load_dwordx4 v1, s[8:11], s25 offen offset:0 lds
buffer_load_dwordx4 v1, s[8:11], s25 offen offset:1024 lds
buffer_load_dwordx4 v1, s[8:11], s25 offen offset:2048 lds
buffer_load_dwordx4 v1, s[8:11], s25 offen offset:3072 lds
s_add_u32 s24, s53, 90112
s_mov_b32 m0, s24
s_add_u32 s25, s54, 90112
buffer_load_dwordx4 v1, s[8:11], s25 offen offset:0 lds
buffer_load_dwordx4 v1, s[8:11], s25 offen offset:1024 lds
buffer_load_dwordx4 v1, s[8:11], s25 offen offset:2048 lds
s_cmp_ge_u32 s2, 224
s_cbranch_scc1 main_kernel_ce10
s_mul_i32 s18, s3, 8192
s_mul_i32 s20, s44, 32768
s_add_u32 s20, s20, s18
s_add_u32 s20, s20, 53477376
s_mul_i32 s21, s45, 32768
s_add_u32 s21, s21, s18
s_add_u32 s21, s21, 53477376
s_mul_i32 s24, s44, 28
s_lshl_b32 s25, s46, 1
s_add_u32 s24, s24, s25
s_lshl_b32 s24, s24, 10
s_add_u32 s25, s24, 33554432
s_lshr_b32 s12, s44, 2
s_lshl_b32 s13, s12, 7
s_add_u32 s13, s13, 30027776
s_cmp_lg_u32 s3, 0
s_cbranch_scc1 main_kernel_wt15x
s_mov_b32 s60, 0
v_mov_b32 v5, 0
main_kernel_wt15:
buffer_load_dword v4, v5, s[8:11], s13 offen sc1
s_add_u32 s60, s60, 1
s_waitcnt vmcnt(0)
v_readfirstlane_b32 s61, v4
s_cmp_ge_u32 s61, 16
s_cbranch_scc1 main_kernel_wt15x
s_cmp_gt_u32 s60, 40000
s_cbranch_scc1 main_kernel_end
s_sleep 1
s_branch main_kernel_wt15
main_kernel_wt15x:
s_waitcnt vmcnt(0)
s_barrier
buffer_load_dwordx4 v[80:83], v1, s[8:11], s20 offen offset:0 sc1
buffer_load_dwordx4 v[84:87], v1, s[8:11], s21 offen offset:0 sc1
buffer_load_dwordx4 v[88:91], v1, s[8:11], s20 offen offset:1024 sc1
buffer_load_dwordx4 v[92:95], v1, s[8:11], s21 offen offset:1024 sc1
buffer_load_dwordx4 v[96:99], v1, s[8:11], s20 offen offset:2048 sc1
buffer_load_dwordx4 v[100:103], v1, s[8:11], s21 offen offset:2048 sc1
buffer_load_dwordx4 v[104:107], v1, s[8:11], s20 offen offset:3072 sc1
buffer_load_dwordx4 v[108:111], v1, s[8:11], s21 offen offset:3072 sc1
s_add_u32 s20, s20, 4096
s_add_u32 s21, s21, 4096
buffer_load_dwordx4 v[112:115], v1, s[8:11], s20 offen offset:0 sc1
buffer_load_dwordx4 v[116:119], v1, s[8:11], s21 offen offset:0 sc1
buffer_load_dwordx4 v[120:123], v1, s[8:11], s20 offen offset:1024 sc1
buffer_load_dwordx4 v[124:127], v1, s[8:11], s21 offen offset:1024 sc1
buffer_load_dwordx4 v[128:131], v1, s[8:11], s20 offen offset:2048 sc1
buffer_load_dwordx4 v[132:135], v1, s[8:11], s21 offen offset:2048 sc1
buffer_load_dwordx4 v[136:139], v1, s[8:11], s20 offen offset:3072 sc1
buffer_load_dwordx4 v[140:143], v1, s[8:11], s21 offen offset:3072 sc1
s_waitcnt vmcnt(14)
v_mfma_f32_32x32x16_bf16 v[16:31], a[0:3], v[80:83], 0
v_mfma_f32_32x32x16_bf16 v[32:47], a[4:7], v[80:83], 0
v_mfma_f32_32x32x16_bf16 v[48:63], a[0:3], v[84:87], 0
v_mfma_f32_32x32x16_bf16 v[64:79], a[4:7], v[84:87], 0
s_waitcnt vmcnt(12)
v_mfma_f32_32x32x16_bf16 v[16:31], a[8:11], v[88:91], v[16:31]
v_mfma_f32_32x32x16_bf16 v[32:47], a[12:15], v[88:91], v[32:47]
v_mfma_f32_32x32x16_bf16 v[48:63], a[8:11], v[92:95], v[48:63]
v_mfma_f32_32x32x16_bf16 v[64:79], a[12:15], v[92:95], v[64:79]
s_waitcnt vmcnt(10)
v_mfma_f32_32x32x16_bf16 v[16:31], a[16:19], v[96:99], v[16:31]
v_mfma_f32_32x32x16_bf16 v[32:47], a[20:23], v[96:99], v[32:47]
v_mfma_f32_32x32x16_bf16 v[48:63], a[16:19], v[100:103], v[48:63]
v_mfma_f32_32x32x16_bf16 v[64:79], a[20:23], v[100:103], v[64:79]
buffer_load_dwordx4 v[208:211], v1, s[8:11], s25 offen offset:0 sc1
buffer_load_dwordx4 v[212:215], v1, s[8:11], s25 offen offset:1024 sc1
s_waitcnt vmcnt(10)
v_mfma_f32_32x32x16_bf16 v[16:31], a[24:27], v[104:107], v[16:31]
v_mfma_f32_32x32x16_bf16 v[32:47], a[28:31], v[104:107], v[32:47]
v_mfma_f32_32x32x16_bf16 v[48:63], a[24:27], v[108:111], v[48:63]
v_mfma_f32_32x32x16_bf16 v[64:79], a[28:31], v[108:111], v[64:79]
s_waitcnt vmcnt(8)
v_mfma_f32_32x32x16_bf16 v[16:31], a[32:35], v[112:115], v[16:31]
v_mfma_f32_32x32x16_bf16 v[32:47], a[36:39], v[112:115], v[32:47]
v_mfma_f32_32x32x16_bf16 v[48:63], a[32:35], v[116:119], v[48:63]
v_mfma_f32_32x32x16_bf16 v[64:79], a[36:39], v[116:119], v[64:79]
s_waitcnt vmcnt(6)
v_mfma_f32_32x32x16_bf16 v[16:31], a[40:43], v[120:123], v[16:31]
v_mfma_f32_32x32x16_bf16 v[32:47], a[44:47], v[120:123], v[32:47]
v_mfma_f32_32x32x16_bf16 v[48:63], a[40:43], v[124:127], v[48:63]
v_mfma_f32_32x32x16_bf16 v[64:79], a[44:47], v[124:127], v[64:79]
s_waitcnt vmcnt(4)
v_mfma_f32_32x32x16_bf16 v[16:31], a[48:51], v[128:131], v[16:31]
v_mfma_f32_32x32x16_bf16 v[32:47], a[52:55], v[128:131], v[32:47]
v_mfma_f32_32x32x16_bf16 v[48:63], a[48:51], v[132:135], v[48:63]
v_mfma_f32_32x32x16_bf16 v[64:79], a[52:55], v[132:135], v[64:79]
s_waitcnt vmcnt(2)
v_mfma_f32_32x32x16_bf16 v[16:31], a[56:59], v[136:139], v[16:31]
v_mfma_f32_32x32x16_bf16 v[32:47], a[60:63], v[136:139], v[32:47]
v_mfma_f32_32x32x16_bf16 v[48:63], a[56:59], v[140:143], v[48:63]
v_mfma_f32_32x32x16_bf16 v[64:79], a[60:63], v[140:143], v[64:79]
s_xor_b32 s26, s3, 1
s_mul_i32 s26, s26, 12288
s_add_u32 s26, s26, 114688
v_add_u32 v12, s26, v1
s_xor_b32 s26, s3, 2
s_mul_i32 s26, s26, 12288
s_add_u32 s26, s26, 118784
v_add_u32 v13, s26, v1
s_xor_b32 s26, s3, 3
s_mul_i32 s26, s26, 12288
s_add_u32 s26, s26, 122880
v_add_u32 v14, s26, v1
s_mul_i32 s26, s3, 12288
s_add_u32 s26, s26, 114688
v_add_u32 v5, s26, v1
ds_write_b128 v12, v[32:35] offset:0
ds_write_b128 v12, v[36:39] offset:1024
ds_write_b128 v12, v[40:43] offset:2048
ds_write_b128 v12, v[44:47] offset:3072
ds_write_b128 v13, v[48:51] offset:0
ds_write_b128 v13, v[52:55] offset:1024
ds_write_b128 v13, v[56:59] offset:2048
ds_write_b128 v13, v[60:63] offset:3072
ds_write_b128 v14, v[64:67] offset:0
ds_write_b128 v14, v[68:71] offset:1024
ds_write_b128 v14, v[72:75] offset:2048
ds_write_b128 v14, v[76:79] offset:3072
v_and_b32 v6, 31, v0
v_lshrrev_b32 v7, 5, v0
s_waitcnt vmcnt(0)
v_lshlrev_b32 v8, 16, v208
v_and_b32 v9, 0xffff0000, v208
v_add_f32 v16, v16, v8
v_add_f32 v17, v17, v9
v_lshlrev_b32 v8, 16, v209
v_and_b32 v9, 0xffff0000, v209
v_add_f32 v18, v18, v8
v_add_f32 v19, v19, v9
v_lshlrev_b32 v8, 16, v210
v_and_b32 v9, 0xffff0000, v210
v_add_f32 v20, v20, v8
v_add_f32 v21, v21, v9
v_lshlrev_b32 v8, 16, v211
v_and_b32 v9, 0xffff0000, v211
v_add_f32 v22, v22, v8
v_add_f32 v23, v23, v9
v_lshlrev_b32 v8, 16, v212
v_and_b32 v9, 0xffff0000, v212
v_add_f32 v24, v24, v8
v_add_f32 v25, v25, v9
v_lshlrev_b32 v8, 16, v213
v_and_b32 v9, 0xffff0000, v213
v_add_f32 v26, v26, v8
v_add_f32 v27, v27, v9
v_lshlrev_b32 v8, 16, v214
v_and_b32 v9, 0xffff0000, v214
v_add_f32 v28, v28, v8
v_add_f32 v29, v29, v9
v_lshlrev_b32 v8, 16, v215
v_and_b32 v9, 0xffff0000, v215
v_add_f32 v30, v30, v8
v_add_f32 v31, v31, v9
s_waitcnt lgkmcnt(0)
s_barrier
ds_read_b128 v[80:83], v5 offset:0
ds_read_b128 v[84:87], v5 offset:1024
ds_read_b128 v[88:91], v5 offset:2048
ds_read_b128 v[92:95], v5 offset:3072
ds_read_b128 v[96:99], v5 offset:4096
ds_read_b128 v[100:103], v5 offset:5120
ds_read_b128 v[104:107], v5 offset:6144
ds_read_b128 v[108:111], v5 offset:7168
ds_read_b128 v[112:115], v5 offset:8192
ds_read_b128 v[116:119], v5 offset:9216
ds_read_b128 v[120:123], v5 offset:10240
ds_read_b128 v[124:127], v5 offset:11264
s_waitcnt lgkmcnt(8)
v_add_f32 v16, v16, v80
v_add_f32 v17, v17, v81
v_add_f32 v18, v18, v82
v_add_f32 v19, v19, v83
v_add_f32 v20, v20, v84
v_add_f32 v21, v21, v85
v_add_f32 v22, v22, v86
v_add_f32 v23, v23, v87
v_add_f32 v24, v24, v88
v_add_f32 v25, v25, v89
v_add_f32 v26, v26, v90
v_add_f32 v27, v27, v91
v_add_f32 v28, v28, v92
v_add_f32 v29, v29, v93
v_add_f32 v30, v30, v94
v_add_f32 v31, v31, v95
s_waitcnt lgkmcnt(4)
v_add_f32 v16, v16, v96
v_add_f32 v17, v17, v97
v_add_f32 v18, v18, v98
v_add_f32 v19, v19, v99
v_add_f32 v20, v20, v100
v_add_f32 v21, v21, v101
v_add_f32 v22, v22, v102
v_add_f32 v23, v23, v103
v_add_f32 v24, v24, v104
v_add_f32 v25, v25, v105
v_add_f32 v26, v26, v106
v_add_f32 v27, v27, v107
v_add_f32 v28, v28, v108
v_add_f32 v29, v29, v109
v_add_f32 v30, v30, v110
v_add_f32 v31, v31, v111
s_waitcnt lgkmcnt(0)
v_add_f32 v16, v16, v112
v_add_f32 v17, v17, v113
v_add_f32 v18, v18, v114
v_add_f32 v19, v19, v115
v_add_f32 v20, v20, v116
v_add_f32 v21, v21, v117
v_add_f32 v22, v22, v118
v_add_f32 v23, v23, v119
v_add_f32 v24, v24, v120
v_add_f32 v25, v25, v121
v_add_f32 v26, v26, v122
v_add_f32 v27, v27, v123
v_add_f32 v28, v28, v124
v_add_f32 v29, v29, v125
v_add_f32 v30, v30, v126
v_add_f32 v31, v31, v127
v_cvt_pk_bf16_f32 v208, v16, v17
v_cvt_pk_bf16_f32 v209, v18, v19
v_cvt_pk_bf16_f32 v210, v20, v21
v_cvt_pk_bf16_f32 v211, v22, v23
v_cvt_pk_bf16_f32 v212, v24, v25
v_cvt_pk_bf16_f32 v213, v26, v27
v_cvt_pk_bf16_f32 v214, v28, v29
v_cvt_pk_bf16_f32 v215, v30, v31
s_add_u32 s25, s24, 35651584
buffer_store_dwordx4 v[208:211], v1, s[8:11], s25 offen offset:0 sc1
buffer_store_dwordx4 v[212:215], v1, s[8:11], s25 offen offset:1024 sc1
v_lshlrev_b32 v6, 3, v6
v_lshl_add_u32 v6, v7, 2, v6
s_mul_i32 s25, s44, 3584
s_lshl_b32 s26, s46, 8
s_add_u32 s25, s25, s26
s_add_u32 s25, s25, 63307776
s_mov_b32 s27, 0x3f803f80
v_mov_b32 v10, 0
v_mov_b32 v11, 0
v_dot2_f32_bf16 v10, v208, s27, v10
v_dot2_f32_bf16 v11, v208, v208, v11
v_dot2_f32_bf16 v10, v209, s27, v10
v_dot2_f32_bf16 v11, v209, v209, v11
v_dot2_f32_bf16 v10, v210, s27, v10
v_dot2_f32_bf16 v11, v210, v210, v11
v_dot2_f32_bf16 v10, v211, s27, v10
v_dot2_f32_bf16 v11, v211, v211, v11
v_dot2_f32_bf16 v10, v212, s27, v10
v_dot2_f32_bf16 v11, v212, v212, v11
v_dot2_f32_bf16 v10, v213, s27, v10
v_dot2_f32_bf16 v11, v213, v213, v11
v_dot2_f32_bf16 v10, v214, s27, v10
v_dot2_f32_bf16 v11, v214, v214, v11
v_dot2_f32_bf16 v10, v215, s27, v10
v_dot2_f32_bf16 v11, v215, v215, v11
s_nop 3
v_permlane32_swap_b32 v10, v11
s_nop 1
v_add_f32 v10, v10, v11
buffer_store_dword v10, v6, s[8:11], s25 offen sc1
s_lshl_b32 s13, s12, 7
s_add_u32 s13, s13, 30029824
s_waitcnt vmcnt(0)
s_barrier
s_cmp_lg_u32 s3, 0
s_cbranch_scc1 main_kernel_sg16
v_mov_b32 v4, 1
v_mov_b32 v5, 0
s_mov_b64 exec, 1
buffer_atomic_add v4, v5, s[8:11], s13 offen sc1
s_mov_b64 exec, -1
main_kernel_sg16:
main_kernel_ce10:
s_add_u32 s24, s53, 114688
s_mov_b32 m0, s24
s_add_u32 s25, s54, 114688
buffer_load_dwordx4 v1, s[8:11], s25 offen offset:0 lds
buffer_load_dwordx4 v1, s[8:11], s25 offen offset:1024 lds
buffer_load_dwordx4 v1, s[8:11], s25 offen offset:2048 lds
buffer_load_dwordx4 v1, s[8:11], s25 offen offset:3072 lds
s_add_u32 s24, s53, 118784
s_mov_b32 m0, s24
s_add_u32 s25, s54, 118784
buffer_load_dwordx4 v1, s[8:11], s25 offen offset:0 lds
buffer_load_dwordx4 v1, s[8:11], s25 offen offset:1024 lds
buffer_load_dwordx4 v1, s[8:11], s25 offen offset:2048 lds
s_mul_i32 s30, s49, 896
s_add_u32 s30, s30, 29425664
s_mov_b32 m0, 143360
s_nop 0
buffer_load_dwordx4 v1, s[8:11], s30 offen offset:0 lds
s_mul_i32 s21, s48, 28672
s_add_u32 s21, s21, 35651584
s_mul_i32 s27, s48, 3584
s_add_u32 s27, s27, 63307776
s_mul_i32 s28, s48, 112
s_mul_i32 s29, s49, 7
s_add_u32 s28, s28, s29
s_lshl_b32 s28, s28, 10
s_add_u32 s28, s28, 55574528
s_add_u32 s29, s28, 4096
v_lshrrev_b32 v13, 5, v0
v_lshlrev_b32 v13, 6, v13
v_add_u32 v13, 143360, v13
s_lshr_b32 s12, s48, 2
s_lshl_b32 s13, s12, 7
s_add_u32 s13, s13, 30029824
s_cmp_lg_u32 s3, 0
s_cbranch_scc1 main_kernel_wt17x
s_mov_b32 s60, 0
v_mov_b32 v5, 0
main_kernel_wt17:
buffer_load_dword v4, v5, s[8:11], s13 offen sc1
s_add_u32 s60, s60, 1
s_waitcnt vmcnt(0)
v_readfirstlane_b32 s61, v4
s_cmp_ge_u32 s61, 14
s_cbranch_scc1 main_kernel_wt17x
s_cmp_gt_u32 s60, 40000
s_cbranch_scc1 main_kernel_end
s_sleep 1
s_branch main_kernel_wt17
main_kernel_wt17x:
s_waitcnt vmcnt(0)
s_barrier
s_add_u32 s26, s21, 0
buffer_load_dwordx4 a[0:3], v1, s[8:11], s26 offen offset:0 sc1
buffer_load_dwordx4 a[4:7], v1, s[8:11], s26 offen offset:1024 sc1
buffer_load_dwordx4 a[8:11], v1, s[8:11], s26 offen offset:2048 sc1
buffer_load_dwordx4 a[12:15], v1, s[8:11], s26 offen offset:3072 sc1
s_add_u32 s26, s21, 4096
buffer_load_dwordx4 a[16:19], v1, s[8:11], s26 offen offset:0 sc1
buffer_load_dwordx4 a[20:23], v1, s[8:11], s26 offen offset:1024 sc1
buffer_load_dwordx4 a[24:27], v1, s[8:11], s26 offen offset:2048 sc1
buffer_load_dwordx4 a[28:31], v1, s[8:11], s26 offen offset:3072 sc1
s_add_u32 s26, s21, 8192
buffer_load_dwordx4 a[32:35], v1, s[8:11], s26 offen offset:0 sc1
buffer_load_dwordx4 a[36:39], v1, s[8:11], s26 offen offset:1024 sc1
buffer_load_dwordx4 a[40:43], v1, s[8:11], s26 offen offset:2048 sc1
buffer_load_dwordx4 a[44:47], v1, s[8:11], s26 offen offset:3072 sc1
s_add_u32 s26, s21, 12288
buffer_load_dwordx4 a[48:51], v1, s[8:11], s26 offen offset:0 sc1
buffer_load_dwordx4 a[52:55], v1, s[8:11], s26 offen offset:1024 sc1
buffer_load_dwordx4 a[56:59], v1, s[8:11], s26 offen offset:2048 sc1
buffer_load_dwordx4 a[60:63], v1, s[8:11], s26 offen offset:3072 sc1
ds_read_b128 v[128:131], v1 offset:0
ds_read_b128 v[132:135], v1 offset:1024
ds_read_b128 v[136:139], v1 offset:2048
ds_read_b128 v[140:143], v1 offset:3072
ds_read_b128 v[144:147], v1 offset:4096
ds_read_b128 v[148:151], v1 offset:5120
s_waitcnt vmcnt(12)
s_waitcnt lgkmcnt(3)
v_mfma_f32_32x32x16_bf16 v[16:31], v[128:131], a[0:3], 0
ds_read_b128 v[152:155], v1 offset:6144
ds_read_b128 v[156:159], v1 offset:7168
ds_read_b128 v[160:163], v1 offset:8192
s_add_u32 s26, s21, 16384
buffer_load_dwordx4 a[64:67], v1, s[8:11], s26 offen offset:0 sc1
v_mfma_f32_32x32x16_bf16 v[32:47], v[132:135], a[0:3], 0
v_mfma_f32_32x32x16_bf16 v[48:63], v[136:139], a[0:3], 0
buffer_load_dwordx4 a[68:71], v1, s[8:11], s26 offen offset:1024 sc1
s_waitcnt lgkmcnt(3)
v_mfma_f32_32x32x16_bf16 v[16:31], v[140:143], a[4:7], v[16:31]
ds_read_b128 v[128:131], v1 offset:9216
ds_read_b128 v[132:135], v1 offset:10240
ds_read_b128 v[136:139], v1 offset:11264
v_mfma_f32_32x32x16_bf16 v[32:47], v[144:147], a[4:7], v[32:47]
v_mfma_f32_32x32x16_bf16 v[48:63], v[148:151], a[4:7], v[48:63]
buffer_load_dwordx4 a[72:75], v1, s[8:11], s26 offen offset:2048 sc1
s_waitcnt lgkmcnt(3)
v_mfma_f32_32x32x16_bf16 v[16:31], v[152:155], a[8:11], v[16:31]
ds_read_b128 v[140:143], v1 offset:12288
ds_read_b128 v[144:147], v1 offset:13312
ds_read_b128 v[148:151], v1 offset:14336
v_mfma_f32_32x32x16_bf16 v[32:47], v[156:159], a[8:11], v[32:47]
v_mfma_f32_32x32x16_bf16 v[48:63], v[160:163], a[8:11], v[48:63]
buffer_load_dwordx4 a[76:79], v1, s[8:11], s26 offen offset:3072 sc1
s_waitcnt lgkmcnt(3)
v_mfma_f32_32x32x16_bf16 v[16:31], v[128:131], a[12:15], v[16:31]
ds_read_b128 v[152:155], v1 offset:15360
ds_read_b128 v[156:159], v1 offset:16384
ds_read_b128 v[160:163], v1 offset:17408
v_mfma_f32_32x32x16_bf16 v[32:47], v[132:135], a[12:15], v[32:47]
v_mfma_f32_32x32x16_bf16 v[48:63], v[136:139], a[12:15], v[48:63]
s_waitcnt vmcnt(12)
s_waitcnt lgkmcnt(3)
v_mfma_f32_32x32x16_bf16 v[16:31], v[140:143], a[16:19], v[16:31]
ds_read_b128 v[128:131], v1 offset:18432
ds_read_b128 v[132:135], v1 offset:19456
ds_read_b128 v[136:139], v1 offset:20480
s_add_u32 s26, s21, 20480
buffer_load_dwordx4 a[80:83], v1, s[8:11], s26 offen offset:0 sc1
v_mfma_f32_32x32x16_bf16 v[32:47], v[144:147], a[16:19], v[32:47]
v_mfma_f32_32x32x16_bf16 v[48:63], v[148:151], a[16:19], v[48:63]
buffer_load_dwordx4 a[84:87], v1, s[8:11], s26 offen offset:1024 sc1
s_waitcnt lgkmcnt(3)
v_mfma_f32_32x32x16_bf16 v[16:31], v[152:155], a[20:23], v[16:31]
ds_read_b128 v[140:143], v1 offset:21504
ds_read_b128 v[144:147], v1 offset:22528
ds_read_b128 v[148:151], v1 offset:23552
v_mfma_f32_32x32x16_bf16 v[32:47], v[156:159], a[20:23], v[32:47]
v_mfma_f32_32x32x16_bf16 v[48:63], v[160:163], a[20:23], v[48:63]
buffer_load_dwordx4 a[88:91], v1, s[8:11], s26 offen offset:2048 sc1
s_waitcnt lgkmcnt(3)
v_mfma_f32_32x32x16_bf16 v[16:31], v[128:131], a[24:27], v[16:31]
ds_read_b128 v[152:155], v1 offset:24576
ds_read_b128 v[156:159], v1 offset:25600
ds_read_b128 v[160:163], v1 offset:26624
v_mfma_f32_32x32x16_bf16 v[32:47], v[132:135], a[24:27], v[32:47]
v_mfma_f32_32x32x16_bf16 v[48:63], v[136:139], a[24:27], v[48:63]
buffer_load_dwordx4 a[92:95], v1, s[8:11], s26 offen offset:3072 sc1
s_waitcnt lgkmcnt(3)
v_mfma_f32_32x32x16_bf16 v[16:31], v[140:143], a[28:31], v[16:31]
ds_read_b128 v[128:131], v1 offset:27648
ds_read_b128 v[132:135], v1 offset:28672
ds_read_b128 v[136:139], v1 offset:29696
v_mfma_f32_32x32x16_bf16 v[32:47], v[144:147], a[28:31], v[32:47]
v_mfma_f32_32x32x16_bf16 v[48:63], v[148:151], a[28:31], v[48:63]
s_waitcnt vmcnt(12)
s_waitcnt lgkmcnt(3)
v_mfma_f32_32x32x16_bf16 v[16:31], v[152:155], a[32:35], v[16:31]
ds_read_b128 v[140:143], v1 offset:30720
ds_read_b128 v[144:147], v1 offset:31744
ds_read_b128 v[148:151], v1 offset:32768
s_add_u32 s26, s21, 24576
buffer_load_dwordx4 a[96:99], v1, s[8:11], s26 offen offset:0 sc1
v_mfma_f32_32x32x16_bf16 v[32:47], v[156:159], a[32:35], v[32:47]
v_mfma_f32_32x32x16_bf16 v[48:63], v[160:163], a[32:35], v[48:63]
buffer_load_dwordx4 a[100:103], v1, s[8:11], s26 offen offset:1024 sc1
s_waitcnt lgkmcnt(3)
v_mfma_f32_32x32x16_bf16 v[16:31], v[128:131], a[36:39], v[16:31]
ds_read_b128 v[152:155], v1 offset:33792
ds_read_b128 v[156:159], v1 offset:34816
ds_read_b128 v[160:163], v1 offset:35840
v_mfma_f32_32x32x16_bf16 v[32:47], v[132:135], a[36:39], v[32:47]
v_mfma_f32_32x32x16_bf16 v[48:63], v[136:139], a[36:39], v[48:63]
buffer_load_dwordx4 a[104:107], v1, s[8:11], s26 offen offset:2048 sc1
s_waitcnt lgkmcnt(3)
v_mfma_f32_32x32x16_bf16 v[16:31], v[140:143], a[40:43], v[16:31]
ds_read_b128 v[128:131], v1 offset:36864
ds_read_b128 v[132:135], v1 offset:37888
ds_read_b128 v[136:139], v1 offset:38912
v_mfma_f32_32x32x16_bf16 v[32:47], v[144:147], a[40:43], v[32:47]
v_mfma_f32_32x32x16_bf16 v[48:63], v[148:151], a[40:43], v[48:63]
buffer_load_dwordx4 a[108:111], v1, s[8:11], s26 offen offset:3072 sc1
s_waitcnt lgkmcnt(3)
v_mfma_f32_32x32x16_bf16 v[16:31], v[152:155], a[44:47], v[16:31]
ds_read_b128 v[140:143], v1 offset:39936
ds_read_b128 v[144:147], v1 offset:40960
ds_read_b128 v[148:151], v1 offset:41984
v_mfma_f32_32x32x16_bf16 v[32:47], v[156:159], a[44:47], v[32:47]
v_mfma_f32_32x32x16_bf16 v[48:63], v[160:163], a[44:47], v[48:63]
s_waitcnt vmcnt(12)
s_waitcnt lgkmcnt(3)
v_mfma_f32_32x32x16_bf16 v[16:31], v[128:131], a[48:51], v[16:31]
ds_read_b128 v[152:155], v1 offset:43008
ds_read_b128 v[156:159], v1 offset:44032
ds_read_b128 v[160:163], v1 offset:45056
v_and_b32 v4, 31, v0
v_lshlrev_b32 v4, 3, v4
v_lshrrev_b32 v5, 5, v0
v_mul_u32_u24 v5, 1792, v5
v_add_u32 v4, v4, v5
buffer_load_dwordx2 v[164:165], v4, s[8:11], s27 offen offset:0 sc1
buffer_load_dwordx2 v[166:167], v4, s[8:11], s27 offen offset:256 sc1
buffer_load_dwordx2 v[168:169], v4, s[8:11], s27 offen offset:512 sc1
buffer_load_dwordx2 v[170:171], v4, s[8:11], s27 offen offset:768 sc1
buffer_load_dwordx2 v[172:173], v4, s[8:11], s27 offen offset:1024 sc1
buffer_load_dwordx2 v[174:175], v4, s[8:11], s27 offen offset:1280 sc1
buffer_load_dwordx2 v[176:177], v4, s[8:11], s27 offen offset:1536 sc1
v_mfma_f32_32x32x16_bf16 v[32:47], v[132:135], a[48:51], v[32:47]
v_mfma_f32_32x32x16_bf16 v[48:63], v[136:139], a[48:51], v[48:63]
s_waitcnt lgkmcnt(3)
v_mfma_f32_32x32x16_bf16 v[16:31], v[140:143], a[52:55], v[16:31]
ds_read_b128 v[128:131], v1 offset:46080
ds_read_b128 v[132:135], v1 offset:47104
ds_read_b128 v[136:139], v1 offset:48128
v_mfma_f32_32x32x16_bf16 v[32:47], v[144:147], a[52:55], v[32:47]
v_mfma_f32_32x32x16_bf16 v[48:63], v[148:151], a[52:55], v[48:63]
s_waitcnt lgkmcnt(3)
v_mfma_f32_32x32x16_bf16 v[16:31], v[152:155], a[56:59], v[16:31]
ds_read_b128 v[140:143], v1 offset:49152
ds_read_b128 v[144:147], v1 offset:50176
ds_read_b128 v[148:151], v1 offset:51200
v_mfma_f32_32x32x16_bf16 v[32:47], v[156:159], a[56:59], v[32:47]
v_mfma_f32_32x32x16_bf16 v[48:63], v[160:163], a[56:59], v[48:63]
s_waitcnt lgkmcnt(3)
v_mfma_f32_32x32x16_bf16 v[16:31], v[128:131], a[60:63], v[16:31]
ds_read_b128 v[152:155], v1 offset:52224
ds_read_b128 v[156:159], v1 offset:53248
ds_read_b128 v[160:163], v1 offset:54272
v_mfma_f32_32x32x16_bf16 v[32:47], v[132:135], a[60:63], v[32:47]
v_mfma_f32_32x32x16_bf16 v[48:63], v[136:139], a[60:63], v[48:63]
s_waitcnt vmcnt(15)
s_waitcnt lgkmcnt(3)
v_mfma_f32_32x32x16_bf16 v[16:31], v[140:143], a[64:67], v[16:31]
ds_read_b128 v[128:131], v1 offset:55296
ds_read_b128 v[132:135], v1 offset:56320
ds_read_b128 v[136:139], v1 offset:57344
v_mfma_f32_32x32x16_bf16 v[32:47], v[144:147], a[64:67], v[32:47]
v_mfma_f32_32x32x16_bf16 v[48:63], v[148:151], a[64:67], v[48:63]
s_waitcnt lgkmcnt(3)
v_mfma_f32_32x32x16_bf16 v[16:31], v[152:155], a[68:71], v[16:31]
ds_read_b128 v[140:143], v1 offset:58368
ds_read_b128 v[144:147], v1 offset:59392
ds_read_b128 v[148:151], v1 offset:60416
v_mfma_f32_32x32x16_bf16 v[32:47], v[156:159], a[68:71], v[32:47]
v_mfma_f32_32x32x16_bf16 v[48:63], v[160:163], a[68:71], v[48:63]
s_waitcnt lgkmcnt(3)
v_mfma_f32_32x32x16_bf16 v[16:31], v[128:131], a[72:75], v[16:31]
ds_read_b128 v[152:155], v1 offset:61440
ds_read_b128 v[156:159], v1 offset:62464
ds_read_b128 v[160:163], v1 offset:63488
v_mfma_f32_32x32x16_bf16 v[32:47], v[132:135], a[72:75], v[32:47]
v_mfma_f32_32x32x16_bf16 v[48:63], v[136:139], a[72:75], v[48:63]
s_waitcnt lgkmcnt(3)
v_mfma_f32_32x32x16_bf16 v[16:31], v[140:143], a[76:79], v[16:31]
ds_read_b128 v[128:131], v1 offset:64512
ds_read_b128 v[132:135], v2 offset:0
ds_read_b128 v[136:139], v2 offset:1024
v_mfma_f32_32x32x16_bf16 v[32:47], v[144:147], a[76:79], v[32:47]
v_mfma_f32_32x32x16_bf16 v[48:63], v[148:151], a[76:79], v[48:63]
s_waitcnt vmcnt(11)
s_waitcnt lgkmcnt(3)
v_mfma_f32_32x32x16_bf16 v[16:31], v[152:155], a[80:83], v[16:31]
ds_read_b128 v[140:143], v2 offset:2048
ds_read_b128 v[144:147], v2 offset:3072
ds_read_b128 v[148:151], v2 offset:4096
v_mfma_f32_32x32x16_bf16 v[32:47], v[156:159], a[80:83], v[32:47]
v_mfma_f32_32x32x16_bf16 v[48:63], v[160:163], a[80:83], v[48:63]
s_waitcnt lgkmcnt(3)
v_mfma_f32_32x32x16_bf16 v[16:31], v[128:131], a[84:87], v[16:31]
ds_read_b128 v[152:155], v2 offset:5120
ds_read_b128 v[156:159], v2 offset:6144
ds_read_b128 v[160:163], v2 offset:7168
v_mfma_f32_32x32x16_bf16 v[32:47], v[132:135], a[84:87], v[32:47]
v_mfma_f32_32x32x16_bf16 v[48:63], v[136:139], a[84:87], v[48:63]
s_waitcnt lgkmcnt(3)
v_mfma_f32_32x32x16_bf16 v[16:31], v[140:143], a[88:91], v[16:31]
ds_read_b128 v[128:131], v2 offset:8192
ds_read_b128 v[132:135], v2 offset:9216
ds_read_b128 v[136:139], v2 offset:10240
v_mfma_f32_32x32x16_bf16 v[32:47], v[144:147], a[88:91], v[32:47]
v_mfma_f32_32x32x16_bf16 v[48:63], v[148:151], a[88:91], v[48:63]
s_waitcnt lgkmcnt(3)
v_mfma_f32_32x32x16_bf16 v[16:31], v[152:155], a[92:95], v[16:31]
ds_read_b128 v[140:143], v2 offset:11264
ds_read_b128 v[144:147], v2 offset:12288
ds_read_b128 v[148:151], v2 offset:13312
v_mfma_f32_32x32x16_bf16 v[32:47], v[156:159], a[92:95], v[32:47]
v_mfma_f32_32x32x16_bf16 v[48:63], v[160:163], a[92:95], v[48:63]
s_waitcnt vmcnt(7)
s_waitcnt lgkmcnt(3)
v_mfma_f32_32x32x16_bf16 v[16:31], v[128:131], a[96:99], v[16:31]
ds_read_b128 v[152:155], v2 offset:14336
ds_read_b128 v[156:159], v2 offset:15360
ds_read_b128 v[160:163], v2 offset:16384
v_mfma_f32_32x32x16_bf16 v[32:47], v[132:135], a[96:99], v[32:47]
v_mfma_f32_32x32x16_bf16 v[48:63], v[136:139], a[96:99], v[48:63]
s_waitcnt lgkmcnt(3)
v_mfma_f32_32x32x16_bf16 v[16:31], v[140:143], a[100:103], v[16:31]
ds_read_b128 v[128:131], v2 offset:17408
ds_read_b128 v[132:135], v2 offset:18432
ds_read_b128 v[136:139], v2 offset:19456
v_mfma_f32_32x32x16_bf16 v[32:47], v[144:147], a[100:103], v[32:47]
v_mfma_f32_32x32x16_bf16 v[48:63], v[148:151], a[100:103], v[48:63]
s_waitcnt lgkmcnt(3)
v_mfma_f32_32x32x16_bf16 v[16:31], v[152:155], a[104:107], v[16:31]
v_mfma_f32_32x32x16_bf16 v[32:47], v[156:159], a[104:107], v[32:47]
v_mfma_f32_32x32x16_bf16 v[48:63], v[160:163], a[104:107], v[48:63]
s_waitcnt lgkmcnt(0)
v_mfma_f32_32x32x16_bf16 v[16:31], v[128:131], a[108:111], v[16:31]
s_barrier
ds_read_b128 v[140:143], v2 offset:20480
ds_read_b128 v[144:147], v2 offset:21504
ds_read_b128 v[148:151], v2 offset:22528
ds_read_b128 v[152:155], v2 offset:23552
v_mfma_f32_32x32x16_bf16 v[32:47], v[132:135], a[108:111], v[32:47]
v_mfma_f32_32x32x16_bf16 v[48:63], v[136:139], a[108:111], v[48:63]
s_waitcnt vmcnt(0)
s_waitcnt lgkmcnt(3)
v_mfma_f32_32x32x16_bf16 v[64:79], v[140:143], a[0:3], 0
ds_read_b128 v[156:159], v2 offset:24576
v_add_f32 v164, v164, v166
v_add_f32 v165, v165, v167
v_add_f32 v164, v164, v168
v_add_f32 v165, v165, v169
v_add_f32 v164, v164, v170
s_waitcnt lgkmcnt(3)
v_mfma_f32_32x32x16_bf16 v[64:79], v[144:147], a[4:7], v[64:79]
ds_read_b128 v[160:163], v2 offset:25600
s_add_u32 s24, s53, 0
s_mov_b32 m0, s24
s_add_u32 s25, s54, 143360
buffer_load_dwordx4 v1, s[8:11], s25 offen offset:0 lds
s_waitcnt lgkmcnt(3)
v_mfma_f32_32x32x16_bf16 v[64:79], v[148:151], a[8:11], v[64:79]
ds_read_b128 v[128:131], v2 offset:26624
v_add_f32 v165, v165, v171
v_add_f32 v164, v164, v172
v_add_f32 v165, v165, v173
v_add_f32 v164, v164, v174
v_add_f32 v165, v165, v175
v_add_f32 v164, v164, v176
s_waitcnt lgkmcnt(3)
v_mfma_f32_32x32x16_bf16 v[64:79], v[152:155], a[12:15], v[64:79]
ds_read_b128 v[132:135], v2 offset:27648
v_add_f32 v165, v165, v177
v_mov_b32 v166, v164
v_mov_b32 v167, v165
s_nop 1
v_permlane32_swap_b32 v164, v166
s_waitcnt lgkmcnt(3)
v_mfma_f32_32x32x16_bf16 v[64:79], v[156:159], a[16:19], v[64:79]
ds_read_b128 v[136:139], v2 offset:28672
buffer_load_dwordx4 v1, s[8:11], s25 offen offset:1024 lds
s_waitcnt lgkmcnt(3)
v_mfma_f32_32x32x16_bf16 v[64:79], v[160:163], a[20:23], v[64:79]
ds_read_b128 v[140:143], v2 offset:29696
v_permlane32_swap_b32 v165, v167
s_nop 1
v_add_f32 v164, v164, v166
v_add_f32 v165, v165, v167
v_mul_f32 v10, 0x3b124925, v164
v_mul_f32 v165, 0x3b124925, v165
s_waitcnt lgkmcnt(3)
v_mfma_f32_32x32x16_bf16 v[64:79], v[128:131], a[24:27], v[64:79]
ds_read_b128 v[144:147], v2 offset:30720
v_fma_f32 v165, -v10, v10, v165
v_max_f32 v165, 0, v165
v_add_f32 v165, 0x3727c5ac, v165
v_rsq_f32 v9, v165
s_nop 0
s_waitcnt lgkmcnt(3)
v_mfma_f32_32x32x16_bf16 v[64:79], v[132:135], a[28:31], v[64:79]
ds_read_b128 v[148:151], v2 offset:31744
buffer_load_dwordx4 v1, s[8:11], s25 offen offset:2048 lds
s_waitcnt lgkmcnt(3)
v_mfma_f32_32x32x16_bf16 v[64:79], v[136:139], a[32:35], v[64:79]
ds_read_b128 v[152:155], v2 offset:32768
v_sqrt_f32 v12, v165
v_mul_f32 v11, 0xbfb8aa3b, v9
ds_read_b128 v[180:183], v13 offset:0
ds_read_b128 v[184:187], v13 offset:16
ds_read_b128 v[188:191], v13 offset:32
ds_read_b128 v[192:195], v13 offset:48
s_waitcnt lgkmcnt(0)
v_mfma_f32_32x32x16_bf16 v[64:79], v[140:143], a[36:39], v[64:79]
ds_read_b128 v[156:159], v2 offset:33792
v_fma_f32 v16, -v10, v180, v16
v_fma_f32 v17, -v10, v181, v17
v_fma_f32 v18, -v10, v182, v18
v_fma_f32 v19, -v10, v183, v19
v_mul_f32 v16, v16, v11
v_mfma_f32_32x32x16_bf16 v[64:79], v[144:147], a[40:43], v[64:79]
ds_read_b128 v[160:163], v2 offset:34816
buffer_load_dwordx4 v1, s[8:11], s25 offen offset:3072 lds
v_mfma_f32_32x32x16_bf16 v[64:79], v[148:151], a[44:47], v[64:79]
ds_read_b128 v[128:131], v2 offset:35840
v_mul_f32 v17, v17, v11
v_mul_f32 v18, v18, v11
v_mul_f32 v19, v19, v11
ds_read_b128 v[196:199], v13 offset:128
ds_read_b128 v[200:203], v13 offset:144
ds_read_b128 v[204:207], v13 offset:160
v_mfma_f32_32x32x16_bf16 v[64:79], v[152:155], a[48:51], v[64:79]
ds_read_b128 v[132:135], v2 offset:36864
ds_read_b128 v[208:211], v13 offset:176
v_exp_f32 v16, v16
v_fma_f32 v24, -v10, v188, v24
s_waitcnt lgkmcnt(7)
v_mfma_f32_32x32x16_bf16 v[64:79], v[156:159], a[52:55], v[64:79]
ds_read_b128 v[136:139], v2 offset:37888
s_add_u32 s24, s53, 4096
s_mov_b32 m0, s24
s_add_u32 s25, s54, 147456
buffer_load_dwordx4 v1, s[8:11], s25 offen offset:0 lds
s_waitcnt lgkmcnt(7)
v_mfma_f32_32x32x16_bf16 v[64:79], v[160:163], a[56:59], v[64:79]
ds_read_b128 v[140:143], v2 offset:38912
v_exp_f32 v17, v17
v_fma_f32 v25, -v10, v189, v25
v_exp_f32 v18, v18
v_fma_f32 v26, -v10, v190, v26
s_waitcnt lgkmcnt(7)
v_mfma_f32_32x32x16_bf16 v[64:79], v[128:131], a[60:63], v[64:79]
ds_read_b128 v[144:147], v2 offset:39936
v_exp_f32 v19, v19
v_fma_f32 v27, -v10, v191, v27
v_fma_f32 v16, v16, v12, v12
v_fma_f32 v17, v17, v12, v12
v_fma_f32 v18, v18, v12, v12
s_waitcnt lgkmcnt(4)
v_mfma_f32_32x32x16_bf16 v[64:79], v[132:135], a[64:67], v[64:79]
ds_read_b128 v[148:151], v2 offset:40960
buffer_load_dwordx4 v1, s[8:11], s25 offen offset:1024 lds
s_waitcnt lgkmcnt(3)
v_mfma_f32_32x32x16_bf16 v[64:79], v[136:139], a[68:71], v[64:79]
ds_read_b128 v[152:155], v2 offset:41984
v_fma_f32 v19, v19, v12, v12
v_rcp_f32 v16, v16
v_rcp_f32 v17, v17
s_waitcnt lgkmcnt(3)
v_mfma_f32_32x32x16_bf16 v[64:79], v[140:143], a[72:75], v[64:79]
ds_read_b128 v[156:159], v2 offset:43008
v_rcp_f32 v18, v18
v_rcp_f32 v19, v19
v_mul_f32 v16, v16, v24
v_mul_f32 v17, v17, v25
s_waitcnt lgkmcnt(3)
v_mfma_f32_32x32x16_bf16 v[64:79], v[144:147], a[76:79], v[64:79]
ds_read_b128 v[160:163], v2 offset:44032
buffer_load_dwordx4 v1, s[8:11], s25 offen offset:2048 lds
s_waitcnt lgkmcnt(3)
v_mfma_f32_32x32x16_bf16 v[64:79], v[148:151], a[80:83], v[64:79]
ds_read_b128 v[128:131], v2 offset:45056
v_mul_f32 v18, v18, v26
v_mul_f32 v19, v19, v27
v_fma_f32 v20, -v10, v184, v20
v_fma_f32 v21, -v10, v185, v21
v_fma_f32 v22, -v10, v186, v22
s_waitcnt lgkmcnt(3)
v_mfma_f32_32x32x16_bf16 v[64:79], v[152:155], a[84:87], v[64:79]
ds_read_b128 v[132:135], v2 offset:46080
v_fma_f32 v23, -v10, v187, v23
v_mul_f32 v20, v20, v11
v_mul_f32 v21, v21, v11
v_mul_f32 v22, v22, v11
v_mul_f32 v23, v23, v11
s_waitcnt lgkmcnt(3)
v_mfma_f32_32x32x16_bf16 v[64:79], v[156:159], a[88:91], v[64:79]
ds_read_b128 v[136:139], v2 offset:47104
v_exp_f32 v20, v20
v_fma_f32 v28, -v10, v192, v28
v_exp_f32 v21, v21
v_fma_f32 v29, -v10, v193, v29
s_waitcnt lgkmcnt(3)
v_mfma_f32_32x32x16_bf16 v[64:79], v[160:163], a[92:95], v[64:79]
ds_read_b128 v[140:143], v2 offset:48128
v_exp_f32 v22, v22
v_fma_f32 v30, -v10, v194, v30
v_exp_f32 v23, v23
v_fma_f32 v31, -v10, v195, v31
s_waitcnt lgkmcnt(3)
v_mfma_f32_32x32x16_bf16 v[64:79], v[128:131], a[96:99], v[64:79]
ds_read_b128 v[144:147], v2 offset:49152
v_fma_f32 v20, v20, v12, v12
v_fma_f32 v21, v21, v12, v12
v_fma_f32 v22, v22, v12, v12
v_fma_f32 v23, v23, v12, v12
s_waitcnt lgkmcnt(3)
v_mfma_f32_32x32x16_bf16 v[64:79], v[132:135], a[100:103], v[64:79]
ds_read_b128 v[148:151], v2 offset:50176
v_rcp_f32 v20, v20
v_rcp_f32 v21, v21
v_rcp_f32 v22, v22
s_waitcnt lgkmcnt(3)
v_mfma_f32_32x32x16_bf16 v[64:79], v[136:139], a[104:107], v[64:79]
ds_read_b128 v[152:155], v2 offset:51200
v_rcp_f32 v23, v23
v_mul_f32 v20, v20, v28
v_mul_f32 v21, v21, v29
v_mul_f32 v22, v22, v30
v_mul_f32 v23, v23, v31
s_waitcnt lgkmcnt(3)
v_mfma_f32_32x32x16_bf16 v[64:79], v[140:143], a[108:111], v[64:79]
ds_read_b128 v[156:159], v2 offset:52224
v_cvt_pk_bf16_f32 v212, v16, v17
v_cvt_pk_bf16_f32 v213, v18, v19
v_cvt_pk_bf16_f32 v214, v20, v21
v_cvt_pk_bf16_f32 v215, v22, v23
s_waitcnt lgkmcnt(3)
v_mfma_f32_32x32x16_bf16 v[80:95], v[144:147], a[0:3], 0
ds_read_b128 v[160:163], v2 offset:53248
buffer_store_dwordx4 v[212:215], v1, s[8:11], s28 offen offset:0 sc1
v_fma_f32 v32, -v10, v196, v32
v_fma_f32 v33, -v10, v197, v33
v_fma_f32 v34, -v10, v198, v34
v_fma_f32 v35, -v10, v199, v35
s_waitcnt lgkmcnt(3)
v_mfma_f32_32x32x16_bf16 v[80:95], v[148:151], a[4:7], v[80:95]
ds_read_b128 v[128:131], v2 offset:54272
s_add_u32 s24, s53, 28672
s_mov_b32 m0, s24
s_add_u32 s25, s54, 172032
buffer_load_dwordx4 v1, s[8:11], s25 offen offset:0 lds
s_waitcnt lgkmcnt(3)
v_mfma_f32_32x32x16_bf16 v[80:95], v[152:155], a[8:11], v[80:95]
ds_read_b128 v[132:135], v2 offset:55296
v_mul_f32 v32, v32, v11
v_mul_f32 v33, v33, v11
v_mul_f32 v34, v34, v11
v_mul_f32 v35, v35, v11
ds_read_b128 v[180:183], v13 offset:256
ds_read_b128 v[184:187], v13 offset:272
s_waitcnt lgkmcnt(5)
v_mfma_f32_32x32x16_bf16 v[80:95], v[156:159], a[12:15], v[80:95]
ds_read_b128 v[136:139], v2 offset:56320
ds_read_b128 v[188:191], v13 offset:288
ds_read_b128 v[192:195], v13 offset:304
v_exp_f32 v32, v32
v_fma_f32 v40, -v10, v204, v40
s_waitcnt lgkmcnt(7)
v_mfma_f32_32x32x16_bf16 v[80:95], v[160:163], a[16:19], v[80:95]
ds_read_b128 v[140:143], v2 offset:57344
buffer_load_dwordx4 v1, s[8:11], s25 offen offset:1024 lds
s_waitcnt lgkmcnt(7)
v_mfma_f32_32x32x16_bf16 v[80:95], v[128:131], a[20:23], v[80:95]
ds_read_b128 v[144:147], v2 offset:58368
v_exp_f32 v33, v33
v_fma_f32 v41, -v10, v205, v41
v_exp_f32 v34, v34
v_fma_f32 v42, -v10, v206, v42
s_waitcnt lgkmcnt(7)
v_mfma_f32_32x32x16_bf16 v[80:95], v[132:135], a[24:27], v[80:95]
ds_read_b128 v[148:151], v2 offset:59392
v_exp_f32 v35, v35
v_fma_f32 v43, -v10, v207, v43
v_fma_f32 v32, v32, v12, v12
v_fma_f32 v33, v33, v12, v12
s_waitcnt lgkmcnt(5)
v_mfma_f32_32x32x16_bf16 v[80:95], v[136:139], a[28:31], v[80:95]
ds_read_b128 v[152:155], v2 offset:60416
buffer_load_dwordx4 v1, s[8:11], s25 offen offset:2048 lds
s_waitcnt lgkmcnt(3)
v_mfma_f32_32x32x16_bf16 v[80:95], v[140:143], a[32:35], v[80:95]
ds_read_b128 v[156:159], v2 offset:61440
v_fma_f32 v34, v34, v12, v12
v_fma_f32 v35, v35, v12, v12
v_rcp_f32 v32, v32
v_rcp_f32 v33, v33
s_waitcnt lgkmcnt(3)
v_mfma_f32_32x32x16_bf16 v[80:95], v[144:147], a[36:39], v[80:95]
ds_read_b128 v[160:163], v2 offset:62464
v_rcp_f32 v34, v34
v_rcp_f32 v35, v35
v_mul_f32 v32, v32, v40
s_waitcnt lgkmcnt(3)
v_mfma_f32_32x32x16_bf16 v[80:95], v[148:151], a[40:43], v[80:95]
ds_read_b128 v[128:131], v2 offset:63488
buffer_load_dwordx4 v1, s[8:11], s25 offen offset:3072 lds
s_waitcnt lgkmcnt(3)
v_mfma_f32_32x32x16_bf16 v[80:95], v[152:155], a[44:47], v[80:95]
ds_read_b128 v[132:135], v2 offset:64512
v_mul_f32 v33, v33, v41
v_mul_f32 v34, v34, v42
v_mul_f32 v35, v35, v43
v_fma_f32 v36, -v10, v200, v36
v_fma_f32 v37, -v10, v201, v37
v_fma_f32 v38, -v10, v202, v38
s_waitcnt lgkmcnt(3)
v_mfma_f32_32x32x16_bf16 v[80:95], v[156:159], a[48:51], v[80:95]
ds_read_b128 v[136:139], v3 offset:0
v_fma_f32 v39, -v10, v203, v39
v_mul_f32 v36, v36, v11
v_mul_f32 v37, v37, v11
v_mul_f32 v38, v38, v11
v_mul_f32 v39, v39, v11
s_waitcnt lgkmcnt(3)
v_mfma_f32_32x32x16_bf16 v[80:95], v[160:163], a[52:55], v[80:95]
ds_read_b128 v[140:143], v3 offset:1024
s_add_u32 s24, s53, 32768
s_mov_b32 m0, s24
s_add_u32 s25, s54, 176128
buffer_load_dwordx4 v1, s[8:11], s25 offen offset:0 lds
s_waitcnt lgkmcnt(3)
v_mfma_f32_32x32x16_bf16 v[80:95], v[128:131], a[56:59], v[80:95]
ds_read_b128 v[144:147], v3 offset:2048
v_exp_f32 v36, v36
v_fma_f32 v44, -v10, v208, v44
v_exp_f32 v37, v37
v_fma_f32 v45, -v10, v209, v45
s_waitcnt lgkmcnt(3)
v_mfma_f32_32x32x16_bf16 v[80:95], v[132:135], a[60:63], v[80:95]
ds_read_b128 v[148:151], v3 offset:3072
v_exp_f32 v38, v38
v_fma_f32 v46, -v10, v210, v46
v_exp_f32 v39, v39
s_waitcnt lgkmcnt(3)
v_mfma_f32_32x32x16_bf16 v[80:95], v[136:139], a[64:67], v[80:95]
ds_read_b128 v[152:155], v3 offset:4096
buffer_load_dwordx4 v1, s[8:11], s25 offen offset:1024 lds
s_waitcnt lgkmcnt(3)
v_mfma_f32_32x32x16_bf16 v[80:95], v[140:143], a[68:71], v[80:95]
ds_read_b128 v[156:159], v3 offset:5120
v_fma_f32 v47, -v10, v211, v47
v_fma_f32 v36, v36, v12, v12
v_fma_f32 v37, v37, v12, v12
v_fma_f32 v38, v38, v12, v12
v_fma_f32 v39, v39, v12, v12
s_waitcnt lgkmcnt(3)
v_mfma_f32_32x32x16_bf16 v[80:95], v[144:147], a[72:75], v[80:95]
ds_read_b128 v[160:163], v3 offset:6144
v_rcp_f32 v36, v36
v_rcp_f32 v37, v37
v_rcp_f32 v38, v38
s_waitcnt lgkmcnt(3)
v_mfma_f32_32x32x16_bf16 v[80:95], v[148:151], a[76:79], v[80:95]
ds_read_b128 v[128:131], v3 offset:7168
buffer_load_dwordx4 v1, s[8:11], s25 offen offset:2048 lds
s_waitcnt lgkmcnt(3)
v_mfma_f32_32x32x16_bf16 v[80:95], v[152:155], a[80:83], v[80:95]
ds_read_b128 v[132:135], v3 offset:8192
v_rcp_f32 v39, v39
v_mul_f32 v36, v36, v44
v_mul_f32 v37, v37, v45
v_mul_f32 v38, v38, v46
v_mul_f32 v39, v39, v47
s_waitcnt lgkmcnt(3)
v_mfma_f32_32x32x16_bf16 v[80:95], v[156:159], a[84:87], v[80:95]
ds_read_b128 v[136:139], v3 offset:9216
v_cvt_pk_bf16_f32 v216, v32, v33
v_cvt_pk_bf16_f32 v217, v34, v35
v_cvt_pk_bf16_f32 v218, v36, v37
v_cvt_pk_bf16_f32 v219, v38, v39
s_waitcnt lgkmcnt(3)
v_mfma_f32_32x32x16_bf16 v[80:95], v[160:163], a[88:91], v[80:95]
ds_read_b128 v[140:143], v3 offset:10240
buffer_store_dwordx4 v[216:219], v1, s[8:11], s28 offen offset:1024 sc1
v_fma_f32 v48, -v10, v180, v48
v_fma_f32 v49, -v10, v181, v49
v_fma_f32 v50, -v10, v182, v50
v_fma_f32 v51, -v10, v183, v51
s_waitcnt lgkmcnt(3)
v_mfma_f32_32x32x16_bf16 v[80:95], v[128:131], a[92:95], v[80:95]
ds_read_b128 v[144:147], v3 offset:11264
v_mul_f32 v48, v48, v11
v_mul_f32 v49, v49, v11
v_mul_f32 v50, v50, v11
v_mul_f32 v51, v51, v11
ds_read_b128 v[196:199], v13 offset:384
ds_read_b128 v[200:203], v13 offset:400
s_waitcnt lgkmcnt(5)
v_mfma_f32_32x32x16_bf16 v[80:95], v[132:135], a[96:99], v[80:95]
s_waitcnt vmcnt(9)
s_barrier
ds_read_b128 v[148:151], v1 offset:0
ds_read_b128 v[204:207], v13 offset:416
ds_read_b128 v[208:211], v13 offset:432
v_exp_f32 v48, v48
v_fma_f32 v56, -v10, v188, v56
s_waitcnt lgkmcnt(7)
v_mfma_f32_32x32x16_bf16 v[80:95], v[136:139], a[100:103], v[80:95]
ds_read_b128 v[152:155], v1 offset:1024
v_exp_f32 v49, v49
v_fma_f32 v57, -v10, v189, v57
v_exp_f32 v50, v50
v_fma_f32 v58, -v10, v190, v58
s_waitcnt lgkmcnt(7)
v_mfma_f32_32x32x16_bf16 v[80:95], v[140:143], a[104:107], v[80:95]
ds_read_b128 v[156:159], v1 offset:2048
v_exp_f32 v51, v51
v_fma_f32 v59, -v10, v191, v59
v_fma_f32 v48, v48, v12, v12
v_fma_f32 v49, v49, v12, v12
s_waitcnt lgkmcnt(7)
v_mfma_f32_32x32x16_bf16 v[80:95], v[144:147], a[108:111], v[80:95]
ds_read_b128 v[160:163], v1 offset:3072
v_fma_f32 v50, v50, v12, v12
v_fma_f32 v51, v51, v12, v12
v_rcp_f32 v48, v48
v_rcp_f32 v49, v49
s_waitcnt lgkmcnt(5)
v_mfma_f32_32x32x16_bf16 v[96:111], v[148:151], a[0:3], 0
ds_read_b128 v[128:131], v1 offset:4096
v_rcp_f32 v50, v50
v_rcp_f32 v51, v51
v_mul_f32 v48, v48, v56
s_waitcnt lgkmcnt(3)
v_mfma_f32_32x32x16_bf16 v[96:111], v[152:155], a[4:7], v[96:111]
ds_read_b128 v[132:135], v1 offset:5120
v_mul_f32 v49, v49, v57
v_mul_f32 v50, v50, v58
v_mul_f32 v51, v51, v59
v_fma_f32 v52, -v10, v184, v52
v_fma_f32 v53, -v10, v185, v53
v_fma_f32 v54, -v10, v186, v54
s_waitcnt lgkmcnt(3)
v_mfma_f32_32x32x16_bf16 v[96:111], v[156:159], a[8:11], v[96:111]
ds_read_b128 v[136:139], v1 offset:6144
v_fma_f32 v55, -v10, v187, v55
v_mul_f32 v52, v52, v11
v_mul_f32 v53, v53, v11
v_mul_f32 v54, v54, v11
v_mul_f32 v55, v55, v11
s_waitcnt lgkmcnt(3)
v_mfma_f32_32x32x16_bf16 v[96:111], v[160:163], a[12:15], v[96:111]
ds_read_b128 v[140:143], v1 offset:7168
v_exp_f32 v52, v52
v_fma_f32 v60, -v10, v192, v60
v_exp_f32 v53, v53
v_fma_f32 v61, -v10, v193, v61
s_waitcnt lgkmcnt(3)
v_mfma_f32_32x32x16_bf16 v[96:111], v[128:131], a[16:19], v[96:111]
ds_read_b128 v[144:147], v1 offset:8192
v_exp_f32 v54, v54
v_fma_f32 v62, -v10, v194, v62
v_exp_f32 v55, v55
s_waitcnt lgkmcnt(3)
v_mfma_f32_32x32x16_bf16 v[96:111], v[132:135], a[20:23], v[96:111]
ds_read_b128 v[148:151], v1 offset:9216
v_fma_f32 v63, -v10, v195, v63
v_fma_f32 v52, v52, v12, v12
v_fma_f32 v53, v53, v12, v12
v_fma_f32 v54, v54, v12, v12
v_fma_f32 v55, v55, v12, v12
s_waitcnt lgkmcnt(3)
v_mfma_f32_32x32x16_bf16 v[96:111], v[136:139], a[24:27], v[96:111]
ds_read_b128 v[152:155], v1 offset:10240
v_rcp_f32 v52, v52
v_rcp_f32 v53, v53
v_rcp_f32 v54, v54
s_waitcnt lgkmcnt(3)
v_mfma_f32_32x32x16_bf16 v[96:111], v[140:143], a[28:31], v[96:111]
ds_read_b128 v[156:159], v1 offset:11264
v_rcp_f32 v55, v55
v_mul_f32 v52, v52, v60
v_mul_f32 v53, v53, v61
v_mul_f32 v54, v54, v62
v_mul_f32 v55, v55, v63
s_waitcnt lgkmcnt(3)
v_mfma_f32_32x32x16_bf16 v[96:111], v[144:147], a[32:35], v[96:111]
ds_read_b128 v[160:163], v1 offset:12288
v_cvt_pk_bf16_f32 v212, v48, v49
v_cvt_pk_bf16_f32 v213, v50, v51
v_cvt_pk_bf16_f32 v214, v52, v53
v_cvt_pk_bf16_f32 v215, v54, v55
s_waitcnt lgkmcnt(3)
v_mfma_f32_32x32x16_bf16 v[96:111], v[148:151], a[36:39], v[96:111]
ds_read_b128 v[128:131], v1 offset:13312
buffer_store_dwordx4 v[212:215], v1, s[8:11], s28 offen offset:2048 sc1
v_fma_f32 v64, -v10, v196, v64
v_fma_f32 v65, -v10, v197, v65
v_fma_f32 v66, -v10, v198, v66
v_fma_f32 v67, -v10, v199, v67
s_waitcnt lgkmcnt(3)
v_mfma_f32_32x32x16_bf16 v[96:111], v[152:155], a[40:43], v[96:111]
ds_read_b128 v[132:135], v1 offset:14336
v_mul_f32 v64, v64, v11
v_mul_f32 v65, v65, v11
v_mul_f32 v66, v66, v11
v_mul_f32 v67, v67, v11
ds_read_b128 v[180:183], v13 offset:512
ds_read_b128 v[184:187], v13 offset:528
s_waitcnt lgkmcnt(5)
v_mfma_f32_32x32x16_bf16 v[96:111], v[156:159], a[44:47], v[96:111]
ds_read_b128 v[136:139], v1 offset:15360
ds_read_b128 v[188:191], v13 offset:544
ds_read_b128 v[192:195], v13 offset:560
v_exp_f32 v64, v64
v_fma_f32 v72, -v10, v204, v72
s_waitcnt lgkmcnt(7)
v_mfma_f32_32x32x16_bf16 v[96:111], v[160:163], a[48:51], v[96:111]
ds_read_b128 v[140:143], v1 offset:16384
v_exp_f32 v65, v65
v_fma_f32 v73, -v10, v205, v73
v_exp_f32 v66, v66
v_fma_f32 v74, -v10, v206, v74
s_waitcnt lgkmcnt(7)
v_mfma_f32_32x32x16_bf16 v[96:111], v[128:131], a[52:55], v[96:111]
ds_read_b128 v[144:147], v1 offset:17408
v_exp_f32 v67, v67
v_fma_f32 v75, -v10, v207, v75
v_fma_f32 v64, v64, v12, v12
v_fma_f32 v65, v65, v12, v12
s_waitcnt lgkmcnt(7)
v_mfma_f32_32x32x16_bf16 v[96:111], v[132:135], a[56:59], v[96:111]
ds_read_b128 v[148:151], v1 offset:18432
v_fma_f32 v66, v66, v12, v12
v_fma_f32 v67, v67, v12, v12
v_rcp_f32 v64, v64
v_rcp_f32 v65, v65
s_waitcnt lgkmcnt(5)
v_mfma_f32_32x32x16_bf16 v[96:111], v[136:139], a[60:63], v[96:111]
ds_read_b128 v[152:155], v1 offset:19456
v_rcp_f32 v66, v66
v_rcp_f32 v67, v67
v_mul_f32 v64, v64, v72
s_waitcnt lgkmcnt(3)
v_mfma_f32_32x32x16_bf16 v[96:111], v[140:143], a[64:67], v[96:111]
ds_read_b128 v[156:159], v1 offset:20480
v_mul_f32 v65, v65, v73
v_mul_f32 v66, v66, v74
v_mul_f32 v67, v67, v75
v_fma_f32 v68, -v10, v200, v68
v_fma_f32 v69, -v10, v201, v69
v_fma_f32 v70, -v10, v202, v70
s_waitcnt lgkmcnt(3)
v_mfma_f32_32x32x16_bf16 v[96:111], v[144:147], a[68:71], v[96:111]
ds_read_b128 v[160:163], v1 offset:21504
v_fma_f32 v71, -v10, v203, v71
v_mul_f32 v68, v68, v11
v_mul_f32 v69, v69, v11
v_mul_f32 v70, v70, v11
v_mul_f32 v71, v71, v11
s_waitcnt lgkmcnt(3)
v_mfma_f32_32x32x16_bf16 v[96:111], v[148:151], a[72:75], v[96:111]
ds_read_b128 v[128:131], v1 offset:22528
v_exp_f32 v68, v68
v_fma_f32 v76, -v10, v208, v76
v_exp_f32 v69, v69
v_fma_f32 v77, -v10, v209, v77
s_waitcnt lgkmcnt(3)
v_mfma_f32_32x32x16_bf16 v[96:111], v[152:155], a[76:79], v[96:111]
ds_read_b128 v[132:135], v1 offset:23552
v_exp_f32 v70, v70
v_fma_f32 v78, -v10, v210, v78
v_exp_f32 v71, v71
s_waitcnt lgkmcnt(3)
v_mfma_f32_32x32x16_bf16 v[96:111], v[156:159], a[80:83], v[96:111]
ds_read_b128 v[136:139], v1 offset:24576
v_fma_f32 v79, -v10, v211, v79
v_fma_f32 v68, v68, v12, v12
v_fma_f32 v69, v69, v12, v12
v_fma_f32 v70, v70, v12, v12
v_fma_f32 v71, v71, v12, v12
s_waitcnt lgkmcnt(3)
v_mfma_f32_32x32x16_bf16 v[96:111], v[160:163], a[84:87], v[96:111]
ds_read_b128 v[140:143], v1 offset:25600
v_rcp_f32 v68, v68
v_rcp_f32 v69, v69
v_rcp_f32 v70, v70
s_waitcnt lgkmcnt(3)
v_mfma_f32_32x32x16_bf16 v[96:111], v[128:131], a[88:91], v[96:111]
ds_read_b128 v[144:147], v1 offset:26624
v_rcp_f32 v71, v71
v_mul_f32 v68, v68, v76
v_mul_f32 v69, v69, v77
v_mul_f32 v70, v70, v78
v_mul_f32 v71, v71, v79
s_waitcnt lgkmcnt(3)
v_mfma_f32_32x32x16_bf16 v[96:111], v[132:135], a[92:95], v[96:111]
ds_read_b128 v[148:151], v1 offset:27648
v_cvt_pk_bf16_f32 v216, v64, v65
v_cvt_pk_bf16_f32 v217, v66, v67
v_cvt_pk_bf16_f32 v218, v68, v69
v_cvt_pk_bf16_f32 v219, v70, v71
s_waitcnt lgkmcnt(3)
v_mfma_f32_32x32x16_bf16 v[96:111], v[136:139], a[96:99], v[96:111]
s_waitcnt vmcnt(2)
s_barrier
ds_read_b128 v[152:155], v1 offset:28672
buffer_store_dwordx4 v[216:219], v1, s[8:11], s28 offen offset:3072 sc1
v_fma_f32 v80, -v10, v180, v80
v_fma_f32 v81, -v10, v181, v81
v_fma_f32 v82, -v10, v182, v82
v_fma_f32 v83, -v10, v183, v83
s_waitcnt lgkmcnt(3)
v_mfma_f32_32x32x16_bf16 v[96:111], v[140:143], a[100:103], v[96:111]
ds_read_b128 v[156:159], v1 offset:29696
v_mul_f32 v80, v80, v11
v_mul_f32 v81, v81, v11
v_mul_f32 v82, v82, v11
v_mul_f32 v83, v83, v11
ds_read_b128 v[196:199], v13 offset:640
ds_read_b128 v[200:203], v13 offset:656
s_waitcnt lgkmcnt(5)
v_mfma_f32_32x32x16_bf16 v[96:111], v[144:147], a[104:107], v[96:111]
ds_read_b128 v[160:163], v1 offset:30720
ds_read_b128 v[204:207], v13 offset:672
ds_read_b128 v[208:211], v13 offset:688
v_exp_f32 v80, v80
v_fma_f32 v88, -v10, v188, v88
s_waitcnt lgkmcnt(7)
v_mfma_f32_32x32x16_bf16 v[96:111], v[148:151], a[108:111], v[96:111]
ds_read_b128 v[128:131], v1 offset:31744
v_exp_f32 v81, v81
v_fma_f32 v89, -v10, v189, v89
v_exp_f32 v82, v82
v_fma_f32 v90, -v10, v190, v90
s_waitcnt lgkmcnt(7)
v_mfma_f32_32x32x16_bf16 v[112:127], v[152:155], a[0:3], 0
ds_read_b128 v[132:135], v1 offset:32768
v_exp_f32 v83, v83
v_fma_f32 v91, -v10, v191, v91
v_fma_f32 v80, v80, v12, v12
v_fma_f32 v81, v81, v12, v12
s_waitcnt lgkmcnt(7)
v_mfma_f32_32x32x16_bf16 v[112:127], v[156:159], a[4:7], v[112:127]
ds_read_b128 v[136:139], v1 offset:33792
v_fma_f32 v82, v82, v12, v12
v_fma_f32 v83, v83, v12, v12
v_rcp_f32 v80, v80
v_rcp_f32 v81, v81
s_waitcnt lgkmcnt(5)
v_mfma_f32_32x32x16_bf16 v[112:127], v[160:163], a[8:11], v[112:127]
ds_read_b128 v[140:143], v1 offset:34816
v_rcp_f32 v82, v82
v_rcp_f32 v83, v83
v_mul_f32 v80, v80, v88
s_waitcnt lgkmcnt(3)
v_mfma_f32_32x32x16_bf16 v[112:127], v[128:131], a[12:15], v[112:127]
ds_read_b128 v[144:147], v1 offset:35840
v_mul_f32 v81, v81, v89
v_mul_f32 v82, v82, v90
v_mul_f32 v83, v83, v91
v_fma_f32 v84, -v10, v184, v84
v_fma_f32 v85, -v10, v185, v85
v_fma_f32 v86, -v10, v186, v86
s_waitcnt lgkmcnt(3)
v_mfma_f32_32x32x16_bf16 v[112:127], v[132:135], a[16:19], v[112:127]
ds_read_b128 v[148:151], v1 offset:36864
v_fma_f32 v87, -v10, v187, v87
v_mul_f32 v84, v84, v11
v_mul_f32 v85, v85, v11
v_mul_f32 v86, v86, v11
v_mul_f32 v87, v87, v11
s_waitcnt lgkmcnt(3)
v_mfma_f32_32x32x16_bf16 v[112:127], v[136:139], a[20:23], v[112:127]
ds_read_b128 v[152:155], v1 offset:37888
v_exp_f32 v84, v84
v_fma_f32 v92, -v10, v192, v92
v_exp_f32 v85, v85
v_fma_f32 v93, -v10, v193, v93
s_waitcnt lgkmcnt(3)
v_mfma_f32_32x32x16_bf16 v[112:127], v[140:143], a[24:27], v[112:127]
ds_read_b128 v[156:159], v1 offset:38912
v_exp_f32 v86, v86
v_fma_f32 v94, -v10, v194, v94
v_exp_f32 v87, v87
s_waitcnt lgkmcnt(3)
v_mfma_f32_32x32x16_bf16 v[112:127], v[144:147], a[28:31], v[112:127]
ds_read_b128 v[160:163], v1 offset:39936
v_fma_f32 v95, -v10, v195, v95
v_fma_f32 v84, v84, v12, v12
v_fma_f32 v85, v85, v12, v12
v_fma_f32 v86, v86, v12, v12
v_fma_f32 v87, v87, v12, v12
s_waitcnt lgkmcnt(3)
v_mfma_f32_32x32x16_bf16 v[112:127], v[148:151], a[32:35], v[112:127]
ds_read_b128 v[128:131], v1 offset:40960
v_rcp_f32 v84, v84
v_rcp_f32 v85, v85
v_rcp_f32 v86, v86
s_waitcnt lgkmcnt(3)
v_mfma_f32_32x32x16_bf16 v[112:127], v[152:155], a[36:39], v[112:127]
ds_read_b128 v[132:135], v1 offset:41984
v_rcp_f32 v87, v87
v_mul_f32 v84, v84, v92
v_mul_f32 v85, v85, v93
v_mul_f32 v86, v86, v94
v_mul_f32 v87, v87, v95
s_waitcnt lgkmcnt(3)
v_mfma_f32_32x32x16_bf16 v[112:127], v[156:159], a[40:43], v[112:127]
ds_read_b128 v[136:139], v1 offset:43008
v_cvt_pk_bf16_f32 v212, v80, v81
v_cvt_pk_bf16_f32 v213, v82, v83
v_cvt_pk_bf16_f32 v214, v84, v85
v_cvt_pk_bf16_f32 v215, v86, v87
s_waitcnt lgkmcnt(3)
v_mfma_f32_32x32x16_bf16 v[112:127], v[160:163], a[44:47], v[112:127]
ds_read_b128 v[140:143], v1 offset:44032
buffer_store_dwordx4 v[212:215], v1, s[8:11], s29 offen offset:0 sc1
v_fma_f32 v96, -v10, v196, v96
v_fma_f32 v97, -v10, v197, v97
v_fma_f32 v98, -v10, v198, v98
v_fma_f32 v99, -v10, v199, v99
s_waitcnt lgkmcnt(3)
v_mfma_f32_32x32x16_bf16 v[112:127], v[128:131], a[48:51], v[112:127]
ds_read_b128 v[144:147], v1 offset:45056
v_mul_f32 v96, v96, v11
v_mul_f32 v97, v97, v11
v_mul_f32 v98, v98, v11
v_mul_f32 v99, v99, v11
ds_read_b128 v[180:183], v13 offset:768
ds_read_b128 v[184:187], v13 offset:784
s_waitcnt lgkmcnt(5)
v_mfma_f32_32x32x16_bf16 v[112:127], v[132:135], a[52:55], v[112:127]
ds_read_b128 v[148:151], v1 offset:46080
ds_read_b128 v[188:191], v13 offset:800
ds_read_b128 v[192:195], v13 offset:816
v_exp_f32 v96, v96
v_fma_f32 v104, -v10, v204, v104
s_waitcnt lgkmcnt(7)
v_mfma_f32_32x32x16_bf16 v[112:127], v[136:139], a[56:59], v[112:127]
ds_read_b128 v[152:155], v1 offset:47104
v_exp_f32 v97, v97
v_fma_f32 v105, -v10, v205, v105
v_exp_f32 v98, v98
v_fma_f32 v106, -v10, v206, v106
s_waitcnt lgkmcnt(7)
v_mfma_f32_32x32x16_bf16 v[112:127], v[140:143], a[60:63], v[112:127]
ds_read_b128 v[156:159], v1 offset:48128
v_exp_f32 v99, v99
v_fma_f32 v107, -v10, v207, v107
v_fma_f32 v96, v96, v12, v12
v_fma_f32 v97, v97, v12, v12
s_waitcnt lgkmcnt(7)
v_mfma_f32_32x32x16_bf16 v[112:127], v[144:147], a[64:67], v[112:127]
ds_read_b128 v[160:163], v1 offset:49152
v_fma_f32 v98, v98, v12, v12
v_fma_f32 v99, v99, v12, v12
v_rcp_f32 v96, v96
v_rcp_f32 v97, v97
s_waitcnt lgkmcnt(5)
v_mfma_f32_32x32x16_bf16 v[112:127], v[148:151], a[68:71], v[112:127]
ds_read_b128 v[128:131], v1 offset:50176
v_rcp_f32 v98, v98
v_rcp_f32 v99, v99
v_mul_f32 v96, v96, v104
s_waitcnt lgkmcnt(3)
v_mfma_f32_32x32x16_bf16 v[112:127], v[152:155], a[72:75], v[112:127]
ds_read_b128 v[132:135], v1 offset:51200
v_mul_f32 v97, v97, v105
v_mul_f32 v98, v98, v106
v_mul_f32 v99, v99, v107
v_fma_f32 v100, -v10, v200, v100
v_fma_f32 v101, -v10, v201, v101
v_fma_f32 v102, -v10, v202, v102
s_waitcnt lgkmcnt(3)
v_mfma_f32_32x32x16_bf16 v[112:127], v[156:159], a[76:79], v[112:127]
ds_read_b128 v[136:139], v1 offset:52224
v_fma_f32 v103, -v10, v203, v103
v_mul_f32 v100, v100, v11
v_mul_f32 v101, v101, v11
v_mul_f32 v102, v102, v11
v_mul_f32 v103, v103, v11
s_waitcnt lgkmcnt(3)
v_mfma_f32_32x32x16_bf16 v[112:127], v[160:163], a[80:83], v[112:127]
ds_read_b128 v[140:143], v1 offset:53248
v_exp_f32 v100, v100
v_fma_f32 v108, -v10, v208, v108
v_exp_f32 v101, v101
v_fma_f32 v109, -v10, v209, v109
s_waitcnt lgkmcnt(3)
v_mfma_f32_32x32x16_bf16 v[112:127], v[128:131], a[84:87], v[112:127]
ds_read_b128 v[144:147], v1 offset:54272
v_exp_f32 v102, v102
v_fma_f32 v110, -v10, v210, v110
v_exp_f32 v103, v103
s_waitcnt lgkmcnt(3)
v_mfma_f32_32x32x16_bf16 v[112:127], v[132:135], a[88:91], v[112:127]
ds_read_b128 v[148:151], v1 offset:55296
v_fma_f32 v111, -v10, v211, v111
v_fma_f32 v100, v100, v12, v12
v_fma_f32 v101, v101, v12, v12
v_fma_f32 v102, v102, v12, v12
v_fma_f32 v103, v103, v12, v12
s_waitcnt lgkmcnt(3)
v_mfma_f32_32x32x16_bf16 v[112:127], v[136:139], a[92:95], v[112:127]
ds_read_b128 v[152:155], v1 offset:56320
v_rcp_f32 v100, v100
v_rcp_f32 v101, v101
v_rcp_f32 v102, v102
s_waitcnt lgkmcnt(3)
v_mfma_f32_32x32x16_bf16 v[112:127], v[140:143], a[96:99], v[112:127]
v_rcp_f32 v103, v103
v_mul_f32 v100, v100, v108
v_mul_f32 v101, v101, v109
v_mul_f32 v102, v102, v110
v_mul_f32 v103, v103, v111
s_waitcnt lgkmcnt(2)
v_mfma_f32_32x32x16_bf16 v[112:127], v[144:147], a[100:103], v[112:127]
v_cvt_pk_bf16_f32 v216, v96, v97
v_cvt_pk_bf16_f32 v217, v98, v99
v_cvt_pk_bf16_f32 v218, v100, v101
v_cvt_pk_bf16_f32 v219, v102, v103
s_waitcnt lgkmcnt(1)
v_mfma_f32_32x32x16_bf16 v[112:127], v[148:151], a[104:107], v[112:127]
buffer_store_dwordx4 v[216:219], v1, s[8:11], s29 offen offset:1024 sc1
s_waitcnt lgkmcnt(0)
v_mfma_f32_32x32x16_bf16 v[112:127], v[152:155], a[108:111], v[112:127]
s_nop 11
v_fma_f32 v112, -v10, v180, v112
v_fma_f32 v113, -v10, v181, v113
v_fma_f32 v114, -v10, v182, v114
v_fma_f32 v115, -v10, v183, v115
v_mul_f32 v112, v112, v11
v_mul_f32 v113, v113, v11
v_mul_f32 v114, v114, v11
v_mul_f32 v115, v115, v11
v_exp_f32 v112, v112
v_fma_f32 v120, -v10, v188, v120
v_exp_f32 v113, v113
v_fma_f32 v121, -v10, v189, v121
v_exp_f32 v114, v114
v_fma_f32 v122, -v10, v190, v122
v_exp_f32 v115, v115
v_fma_f32 v123, -v10, v191, v123
v_fma_f32 v112, v112, v12, v12
v_fma_f32 v113, v113, v12, v12
v_fma_f32 v114, v114, v12, v12
v_fma_f32 v115, v115, v12, v12
v_rcp_f32 v112, v112
v_rcp_f32 v113, v113
v_rcp_f32 v114, v114
v_rcp_f32 v115, v115
v_mul_f32 v112, v112, v120
v_mul_f32 v113, v113, v121
v_mul_f32 v114, v114, v122
v_mul_f32 v115, v115, v123
v_fma_f32 v116, -v10, v184, v116
v_fma_f32 v117, -v10, v185, v117
v_fma_f32 v118, -v10, v186, v118
v_fma_f32 v119, -v10, v187, v119
v_mul_f32 v116, v116, v11
v_mul_f32 v117, v117, v11
v_mul_f32 v118, v118, v11
v_mul_f32 v119, v119, v11
v_exp_f32 v116, v116
v_fma_f32 v124, -v10, v192, v124
v_exp_f32 v117, v117
v_fma_f32 v125, -v10, v193, v125
v_exp_f32 v118, v118
v_fma_f32 v126, -v10, v194, v126
v_exp_f32 v119, v119
v_fma_f32 v127, -v10, v195, v127
v_fma_f32 v116, v116, v12, v12
v_fma_f32 v117, v117, v12, v12
v_fma_f32 v118, v118, v12, v12
v_fma_f32 v119, v119, v12, v12
v_rcp_f32 v116, v116
v_rcp_f32 v117, v117
v_rcp_f32 v118, v118
v_rcp_f32 v119, v119
v_mul_f32 v116, v116, v124
v_mul_f32 v117, v117, v125
v_mul_f32 v118, v118, v126
v_mul_f32 v119, v119, v127
v_cvt_pk_bf16_f32 v212, v112, v113
v_cvt_pk_bf16_f32 v213, v114, v115
v_cvt_pk_bf16_f32 v214, v116, v117
v_cvt_pk_bf16_f32 v215, v118, v119
buffer_store_dwordx4 v[212:215], v1, s[8:11], s29 offen offset:2048 sc1
s_lshl_b32 s13, s12, 7
s_add_u32 s13, s13, 30031872
s_waitcnt vmcnt(0)
s_barrier
s_cmp_lg_u32 s3, 0
s_cbranch_scc1 main_kernel_sg18
v_mov_b32 v4, 1
v_mov_b32 v5, 0
s_mov_b64 exec, 1
buffer_atomic_add v4, v5, s[8:11], s13 offen sc1
s_mov_b64 exec, -1
main_kernel_sg18:
s_add_u32 s26, s57, 16384
buffer_load_dwordx4 a[0:3], v1, s[8:11], s26 offen offset:2048
s_add_u32 s26, s58, 16384
buffer_load_dwordx4 a[4:7], v1, s[8:11], s26 offen offset:2048
s_add_u32 s26, s57, 16384
buffer_load_dwordx4 a[8:11], v1, s[8:11], s26 offen offset:3072
s_add_u32 s26, s58, 16384
buffer_load_dwordx4 a[12:15], v1, s[8:11], s26 offen offset:3072
s_add_u32 s26, s57, 20480
buffer_load_dwordx4 a[16:19], v1, s[8:11], s26 offen offset:0
s_add_u32 s26, s58, 20480
buffer_load_dwordx4 a[20:23], v1, s[8:11], s26 offen offset:0
s_add_u32 s26, s57, 20480
buffer_load_dwordx4 a[24:27], v1, s[8:11], s26 offen offset:1024
s_add_u32 s26, s58, 20480
buffer_load_dwordx4 a[28:31], v1, s[8:11], s26 offen offset:1024
s_add_u32 s26, s57, 20480
buffer_load_dwordx4 a[32:35], v1, s[8:11], s26 offen offset:2048
s_add_u32 s26, s58, 20480
buffer_load_dwordx4 a[36:39], v1, s[8:11], s26 offen offset:2048
s_add_u32 s26, s57, 20480
buffer_load_dwordx4 a[40:43], v1, s[8:11], s26 offen offset:3072
s_add_u32 s26, s58, 20480
buffer_load_dwordx4 a[44:47], v1, s[8:11], s26 offen offset:3072
s_add_u32 s26, s57, 24576
buffer_load_dwordx4 a[48:51], v1, s[8:11], s26 offen offset:0
s_add_u32 s26, s58, 24576
buffer_load_dwordx4 a[52:55], v1, s[8:11], s26 offen offset:0
s_add_u32 s26, s57, 24576
buffer_load_dwordx4 a[56:59], v1, s[8:11], s26 offen offset:1024
s_add_u32 s26, s58, 24576
buffer_load_dwordx4 a[60:63], v1, s[8:11], s26 offen offset:1024
s_add_u32 s26, s57, 24576
buffer_load_dwordx4 a[64:67], v1, s[8:11], s26 offen offset:2048
s_add_u32 s26, s58, 24576
buffer_load_dwordx4 a[68:71], v1, s[8:11], s26 offen offset:2048
s_add_u32 s26, s57, 24576
buffer_load_dwordx4 a[72:75], v1, s[8:11], s26 offen offset:3072
s_add_u32 s26, s58, 24576
buffer_load_dwordx4 a[76:79], v1, s[8:11], s26 offen offset:3072
s_cmp_ge_u32 s2, 224
s_cbranch_scc1 main_kernel_ce11
s_mul_i32 s18, s3, 28672
s_mul_i32 s20, s44, 114688
s_add_u32 s20, s20, s18
s_add_u32 s20, s20, 55574528
s_mul_i32 s21, s45, 114688
s_add_u32 s21, s21, s18
s_add_u32 s21, s21, 55574528
s_mul_i32 s24, s44, 28
s_lshl_b32 s25, s46, 1
s_add_u32 s24, s24, s25
s_lshl_b32 s24, s24, 10
s_add_u32 s25, s24, 35651584
s_lshr_b32 s12, s44, 2
s_lshl_b32 s13, s12, 7
s_add_u32 s13, s13, 30031872
s_cmp_lg_u32 s3, 0
s_cbranch_scc1 main_kernel_wt19x
s_mov_b32 s60, 0
v_mov_b32 v5, 0
main_kernel_wt19:
buffer_load_dword v4, v5, s[8:11], s13 offen sc1
s_add_u32 s60, s60, 1
s_waitcnt vmcnt(0)
v_readfirstlane_b32 s61, v4
s_cmp_ge_u32 s61, 16
s_cbranch_scc1 main_kernel_wt19x
s_cmp_gt_u32 s60, 40000
s_cbranch_scc1 main_kernel_end
s_sleep 1
s_branch main_kernel_wt19
main_kernel_wt19x:
s_waitcnt vmcnt(0)
s_barrier
buffer_load_dwordx4 v[80:83], v1, s[8:11], s20 offen offset:0 sc1
buffer_load_dwordx4 v[84:87], v1, s[8:11], s21 offen offset:0 sc1
buffer_load_dwordx4 v[88:91], v1, s[8:11], s20 offen offset:1024 sc1
buffer_load_dwordx4 v[92:95], v1, s[8:11], s21 offen offset:1024 sc1
buffer_load_dwordx4 v[96:99], v1, s[8:11], s20 offen offset:2048 sc1
buffer_load_dwordx4 v[100:103], v1, s[8:11], s21 offen offset:2048 sc1
buffer_load_dwordx4 v[104:107], v1, s[8:11], s20 offen offset:3072 sc1
buffer_load_dwordx4 v[108:111], v1, s[8:11], s21 offen offset:3072 sc1
s_add_u32 s20, s20, 4096
s_add_u32 s21, s21, 4096
buffer_load_dwordx4 v[112:115], v1, s[8:11], s20 offen offset:0 sc1
buffer_load_dwordx4 v[116:119], v1, s[8:11], s21 offen offset:0 sc1
buffer_load_dwordx4 v[120:123], v1, s[8:11], s20 offen offset:1024 sc1
buffer_load_dwordx4 v[124:127], v1, s[8:11], s21 offen offset:1024 sc1
buffer_load_dwordx4 v[128:131], v1, s[8:11], s20 offen offset:2048 sc1
buffer_load_dwordx4 v[132:135], v1, s[8:11], s21 offen offset:2048 sc1
buffer_load_dwordx4 v[136:139], v1, s[8:11], s20 offen offset:3072 sc1
buffer_load_dwordx4 v[140:143], v1, s[8:11], s21 offen offset:3072 sc1
s_waitcnt vmcnt(14)
v_mfma_f32_32x32x16_bf16 v[16:31], a[112:115], v[80:83], 0
s_add_u32 s20, s20, 4096
s_add_u32 s21, s21, 4096
buffer_load_dwordx4 v[144:147], v1, s[8:11], s20 offen offset:0 sc1
buffer_load_dwordx4 v[148:151], v1, s[8:11], s21 offen offset:0 sc1
v_mfma_f32_32x32x16_bf16 v[32:47], a[116:119], v[80:83], 0
v_mfma_f32_32x32x16_bf16 v[48:63], a[112:115], v[84:87], 0
buffer_load_dwordx4 v[152:155], v1, s[8:11], s20 offen offset:1024 sc1
buffer_load_dwordx4 v[156:159], v1, s[8:11], s21 offen offset:1024 sc1
v_mfma_f32_32x32x16_bf16 v[64:79], a[116:119], v[84:87], 0
s_waitcnt vmcnt(16)
v_mfma_f32_32x32x16_bf16 v[16:31], a[120:123], v[88:91], v[16:31]
buffer_load_dwordx4 v[160:163], v1, s[8:11], s20 offen offset:2048 sc1
buffer_load_dwordx4 v[164:167], v1, s[8:11], s21 offen offset:2048 sc1
v_mfma_f32_32x32x16_bf16 v[32:47], a[124:127], v[88:91], v[32:47]
v_mfma_f32_32x32x16_bf16 v[48:63], a[120:123], v[92:95], v[48:63]
buffer_load_dwordx4 v[168:171], v1, s[8:11], s20 offen offset:3072 sc1
buffer_load_dwordx4 v[172:175], v1, s[8:11], s21 offen offset:3072 sc1
v_mfma_f32_32x32x16_bf16 v[64:79], a[124:127], v[92:95], v[64:79]
s_waitcnt vmcnt(18)
v_mfma_f32_32x32x16_bf16 v[16:31], a[128:131], v[96:99], v[16:31]
s_add_u32 s20, s20, 4096
s_add_u32 s21, s21, 4096
buffer_load_dwordx4 v[176:179], v1, s[8:11], s20 offen offset:0 sc1
buffer_load_dwordx4 v[180:183], v1, s[8:11], s21 offen offset:0 sc1
v_mfma_f32_32x32x16_bf16 v[32:47], a[132:135], v[96:99], v[32:47]
v_mfma_f32_32x32x16_bf16 v[48:63], a[128:131], v[100:103], v[48:63]
buffer_load_dwordx4 v[184:187], v1, s[8:11], s20 offen offset:1024 sc1
buffer_load_dwordx4 v[188:191], v1, s[8:11], s21 offen offset:1024 sc1
v_mfma_f32_32x32x16_bf16 v[64:79], a[132:135], v[100:103], v[64:79]
s_waitcnt vmcnt(20)
v_mfma_f32_32x32x16_bf16 v[16:31], a[136:139], v[104:107], v[16:31]
buffer_load_dwordx4 v[80:83], v1, s[8:11], s20 offen offset:2048 sc1
buffer_load_dwordx4 v[84:87], v1, s[8:11], s21 offen offset:2048 sc1
v_mfma_f32_32x32x16_bf16 v[32:47], a[140:143], v[104:107], v[32:47]
v_mfma_f32_32x32x16_bf16 v[48:63], a[136:139], v[108:111], v[48:63]
buffer_load_dwordx4 v[88:91], v1, s[8:11], s20 offen offset:3072 sc1
buffer_load_dwordx4 v[92:95], v1, s[8:11], s21 offen offset:3072 sc1
v_mfma_f32_32x32x16_bf16 v[64:79], a[140:143], v[108:111], v[64:79]
s_waitcnt vmcnt(22)
v_mfma_f32_32x32x16_bf16 v[16:31], a[144:147], v[112:115], v[16:31]
s_add_u32 s20, s20, 4096
s_add_u32 s21, s21, 4096
buffer_load_dwordx4 v[96:99], v1, s[8:11], s20 offen offset:0 sc1
buffer_load_dwordx4 v[100:103], v1, s[8:11], s21 offen offset:0 sc1
v_mfma_f32_32x32x16_bf16 v[32:47], a[148:151], v[112:115], v[32:47]
v_mfma_f32_32x32x16_bf16 v[48:63], a[144:147], v[116:119], v[48:63]
buffer_load_dwordx4 v[104:107], v1, s[8:11], s20 offen offset:1024 sc1
buffer_load_dwordx4 v[108:111], v1, s[8:11], s21 offen offset:1024 sc1
v_mfma_f32_32x32x16_bf16 v[64:79], a[148:151], v[116:119], v[64:79]
s_waitcnt vmcnt(24)
v_mfma_f32_32x32x16_bf16 v[16:31], a[152:155], v[120:123], v[16:31]
buffer_load_dwordx4 v[112:115], v1, s[8:11], s20 offen offset:2048 sc1
buffer_load_dwordx4 v[116:119], v1, s[8:11], s21 offen offset:2048 sc1
v_mfma_f32_32x32x16_bf16 v[32:47], a[156:159], v[120:123], v[32:47]
v_mfma_f32_32x32x16_bf16 v[48:63], a[152:155], v[124:127], v[48:63]
v_mfma_f32_32x32x16_bf16 v[64:79], a[156:159], v[124:127], v[64:79]
s_waitcnt vmcnt(24)
v_mfma_f32_32x32x16_bf16 v[16:31], a[160:163], v[128:131], v[16:31]
buffer_load_dwordx4 v[120:123], v1, s[8:11], s20 offen offset:3072 sc1
buffer_load_dwordx4 v[124:127], v1, s[8:11], s21 offen offset:3072 sc1
v_mfma_f32_32x32x16_bf16 v[32:47], a[164:167], v[128:131], v[32:47]
v_mfma_f32_32x32x16_bf16 v[48:63], a[160:163], v[132:135], v[48:63]
v_mfma_f32_32x32x16_bf16 v[64:79], a[164:167], v[132:135], v[64:79]
s_waitcnt vmcnt(24)
v_mfma_f32_32x32x16_bf16 v[16:31], a[168:171], v[136:139], v[16:31]
s_add_u32 s20, s20, 4096
s_add_u32 s21, s21, 4096
buffer_load_dwordx4 v[128:131], v1, s[8:11], s20 offen offset:0 sc1
buffer_load_dwordx4 v[132:135], v1, s[8:11], s21 offen offset:0 sc1
v_mfma_f32_32x32x16_bf16 v[32:47], a[172:175], v[136:139], v[32:47]
v_mfma_f32_32x32x16_bf16 v[48:63], a[168:171], v[140:143], v[48:63]
v_mfma_f32_32x32x16_bf16 v[64:79], a[172:175], v[140:143], v[64:79]
s_waitcnt vmcnt(24)
v_mfma_f32_32x32x16_bf16 v[16:31], a[176:179], v[144:147], v[16:31]
buffer_load_dwordx4 v[136:139], v1, s[8:11], s20 offen offset:1024 sc1
buffer_load_dwordx4 v[140:143], v1, s[8:11], s21 offen offset:1024 sc1
v_mfma_f32_32x32x16_bf16 v[32:47], a[180:183], v[144:147], v[32:47]
v_mfma_f32_32x32x16_bf16 v[48:63], a[176:179], v[148:151], v[48:63]
v_mfma_f32_32x32x16_bf16 v[64:79], a[180:183], v[148:151], v[64:79]
s_waitcnt vmcnt(24)
v_mfma_f32_32x32x16_bf16 v[16:31], a[184:187], v[152:155], v[16:31]
buffer_load_dwordx4 v[144:147], v1, s[8:11], s20 offen offset:2048 sc1
buffer_load_dwordx4 v[148:151], v1, s[8:11], s21 offen offset:2048 sc1
v_mfma_f32_32x32x16_bf16 v[32:47], a[188:191], v[152:155], v[32:47]
v_mfma_f32_32x32x16_bf16 v[48:63], a[184:187], v[156:159], v[48:63]
v_mfma_f32_32x32x16_bf16 v[64:79], a[188:191], v[156:159], v[64:79]
s_waitcnt vmcnt(24)
v_mfma_f32_32x32x16_bf16 v[16:31], a[192:195], v[160:163], v[16:31]
buffer_load_dwordx4 v[152:155], v1, s[8:11], s20 offen offset:3072 sc1
buffer_load_dwordx4 v[156:159], v1, s[8:11], s21 offen offset:3072 sc1
v_mfma_f32_32x32x16_bf16 v[32:47], a[196:199], v[160:163], v[32:47]
v_mfma_f32_32x32x16_bf16 v[48:63], a[192:195], v[164:167], v[48:63]
v_mfma_f32_32x32x16_bf16 v[64:79], a[196:199], v[164:167], v[64:79]
s_waitcnt vmcnt(24)
v_mfma_f32_32x32x16_bf16 v[16:31], a[200:203], v[168:171], v[16:31]
s_add_u32 s20, s20, 4096
s_add_u32 s21, s21, 4096
buffer_load_dwordx4 v[160:163], v1, s[8:11], s20 offen offset:0 sc1
buffer_load_dwordx4 v[164:167], v1, s[8:11], s21 offen offset:0 sc1
v_mfma_f32_32x32x16_bf16 v[32:47], a[204:207], v[168:171], v[32:47]
v_mfma_f32_32x32x16_bf16 v[48:63], a[200:203], v[172:175], v[48:63]
v_mfma_f32_32x32x16_bf16 v[64:79], a[204:207], v[172:175], v[64:79]
s_waitcnt vmcnt(24)
v_mfma_f32_32x32x16_bf16 v[16:31], a[208:211], v[176:179], v[16:31]
buffer_load_dwordx4 v[168:171], v1, s[8:11], s20 offen offset:1024 sc1
buffer_load_dwordx4 v[172:175], v1, s[8:11], s21 offen offset:1024 sc1
v_mfma_f32_32x32x16_bf16 v[32:47], a[212:215], v[176:179], v[32:47]
v_mfma_f32_32x32x16_bf16 v[48:63], a[208:211], v[180:183], v[48:63]
v_mfma_f32_32x32x16_bf16 v[64:79], a[212:215], v[180:183], v[64:79]
s_waitcnt vmcnt(24)
v_mfma_f32_32x32x16_bf16 v[16:31], a[216:219], v[184:187], v[16:31]
buffer_load_dwordx4 v[176:179], v1, s[8:11], s20 offen offset:2048 sc1
buffer_load_dwordx4 v[180:183], v1, s[8:11], s21 offen offset:2048 sc1
v_mfma_f32_32x32x16_bf16 v[32:47], a[220:223], v[184:187], v[32:47]
v_mfma_f32_32x32x16_bf16 v[48:63], a[216:219], v[188:191], v[48:63]
v_mfma_f32_32x32x16_bf16 v[64:79], a[220:223], v[188:191], v[64:79]
s_waitcnt vmcnt(24)
v_mfma_f32_32x32x16_bf16 v[16:31], a[224:227], v[80:83], v[16:31]
buffer_load_dwordx4 v[184:187], v1, s[8:11], s20 offen offset:3072 sc1
buffer_load_dwordx4 v[188:191], v1, s[8:11], s21 offen offset:3072 sc1
v_mfma_f32_32x32x16_bf16 v[32:47], a[228:231], v[80:83], v[32:47]
v_mfma_f32_32x32x16_bf16 v[48:63], a[224:227], v[84:87], v[48:63]
v_mfma_f32_32x32x16_bf16 v[64:79], a[228:231], v[84:87], v[64:79]
s_waitcnt vmcnt(24)
v_mfma_f32_32x32x16_bf16 v[16:31], a[232:235], v[88:91], v[16:31]
v_mfma_f32_32x32x16_bf16 v[32:47], a[236:239], v[88:91], v[32:47]
v_mfma_f32_32x32x16_bf16 v[48:63], a[232:235], v[92:95], v[48:63]
v_mfma_f32_32x32x16_bf16 v[64:79], a[236:239], v[92:95], v[64:79]
s_waitcnt vmcnt(22)
v_mfma_f32_32x32x16_bf16 v[16:31], a[240:243], v[96:99], v[16:31]
v_mfma_f32_32x32x16_bf16 v[32:47], a[244:247], v[96:99], v[32:47]
v_mfma_f32_32x32x16_bf16 v[48:63], a[240:243], v[100:103], v[48:63]
v_mfma_f32_32x32x16_bf16 v[64:79], a[244:247], v[100:103], v[64:79]
s_waitcnt vmcnt(20)
v_mfma_f32_32x32x16_bf16 v[16:31], a[248:251], v[104:107], v[16:31]
v_mfma_f32_32x32x16_bf16 v[32:47], a[252:255], v[104:107], v[32:47]
v_mfma_f32_32x32x16_bf16 v[48:63], a[248:251], v[108:111], v[48:63]
v_mfma_f32_32x32x16_bf16 v[64:79], a[252:255], v[108:111], v[64:79]
s_waitcnt vmcnt(18)
v_mfma_f32_32x32x16_bf16 v[16:31], a[0:3], v[112:115], v[16:31]
v_mfma_f32_32x32x16_bf16 v[32:47], a[4:7], v[112:115], v[32:47]
v_mfma_f32_32x32x16_bf16 v[48:63], a[0:3], v[116:119], v[48:63]
v_mfma_f32_32x32x16_bf16 v[64:79], a[4:7], v[116:119], v[64:79]
s_waitcnt vmcnt(16)
v_mfma_f32_32x32x16_bf16 v[16:31], a[8:11], v[120:123], v[16:31]
v_mfma_f32_32x32x16_bf16 v[32:47], a[12:15], v[120:123], v[32:47]
v_mfma_f32_32x32x16_bf16 v[48:63], a[8:11], v[124:127], v[48:63]
v_mfma_f32_32x32x16_bf16 v[64:79], a[12:15], v[124:127], v[64:79]
s_waitcnt vmcnt(14)
v_mfma_f32_32x32x16_bf16 v[16:31], a[16:19], v[128:131], v[16:31]
v_mfma_f32_32x32x16_bf16 v[32:47], a[20:23], v[128:131], v[32:47]
v_mfma_f32_32x32x16_bf16 v[48:63], a[16:19], v[132:135], v[48:63]
v_mfma_f32_32x32x16_bf16 v[64:79], a[20:23], v[132:135], v[64:79]
s_waitcnt vmcnt(12)
v_mfma_f32_32x32x16_bf16 v[16:31], a[24:27], v[136:139], v[16:31]
v_mfma_f32_32x32x16_bf16 v[32:47], a[28:31], v[136:139], v[32:47]
v_mfma_f32_32x32x16_bf16 v[48:63], a[24:27], v[140:143], v[48:63]
v_mfma_f32_32x32x16_bf16 v[64:79], a[28:31], v[140:143], v[64:79]
s_waitcnt vmcnt(10)
v_mfma_f32_32x32x16_bf16 v[16:31], a[32:35], v[144:147], v[16:31]
v_mfma_f32_32x32x16_bf16 v[32:47], a[36:39], v[144:147], v[32:47]
v_mfma_f32_32x32x16_bf16 v[48:63], a[32:35], v[148:151], v[48:63]
v_mfma_f32_32x32x16_bf16 v[64:79], a[36:39], v[148:151], v[64:79]
buffer_load_dwordx4 v[208:211], v1, s[8:11], s25 offen offset:0 sc1
buffer_load_dwordx4 v[212:215], v1, s[8:11], s25 offen offset:1024 sc1
s_waitcnt vmcnt(10)
v_mfma_f32_32x32x16_bf16 v[16:31], a[40:43], v[152:155], v[16:31]
v_mfma_f32_32x32x16_bf16 v[32:47], a[44:47], v[152:155], v[32:47]
v_mfma_f32_32x32x16_bf16 v[48:63], a[40:43], v[156:159], v[48:63]
v_mfma_f32_32x32x16_bf16 v[64:79], a[44:47], v[156:159], v[64:79]
s_waitcnt vmcnt(8)
v_mfma_f32_32x32x16_bf16 v[16:31], a[48:51], v[160:163], v[16:31]
v_mfma_f32_32x32x16_bf16 v[32:47], a[52:55], v[160:163], v[32:47]
v_mfma_f32_32x32x16_bf16 v[48:63], a[48:51], v[164:167], v[48:63]
v_mfma_f32_32x32x16_bf16 v[64:79], a[52:55], v[164:167], v[64:79]
s_waitcnt vmcnt(6)
v_mfma_f32_32x32x16_bf16 v[16:31], a[56:59], v[168:171], v[16:31]
v_mfma_f32_32x32x16_bf16 v[32:47], a[60:63], v[168:171], v[32:47]
v_mfma_f32_32x32x16_bf16 v[48:63], a[56:59], v[172:175], v[48:63]
v_mfma_f32_32x32x16_bf16 v[64:79], a[60:63], v[172:175], v[64:79]
s_waitcnt vmcnt(4)
v_mfma_f32_32x32x16_bf16 v[16:31], a[64:67], v[176:179], v[16:31]
v_mfma_f32_32x32x16_bf16 v[32:47], a[68:71], v[176:179], v[32:47]
v_mfma_f32_32x32x16_bf16 v[48:63], a[64:67], v[180:183], v[48:63]
v_mfma_f32_32x32x16_bf16 v[64:79], a[68:71], v[180:183], v[64:79]
s_waitcnt vmcnt(2)
v_mfma_f32_32x32x16_bf16 v[16:31], a[72:75], v[184:187], v[16:31]
v_mfma_f32_32x32x16_bf16 v[32:47], a[76:79], v[184:187], v[32:47]
v_mfma_f32_32x32x16_bf16 v[48:63], a[72:75], v[188:191], v[48:63]
v_mfma_f32_32x32x16_bf16 v[64:79], a[76:79], v[188:191], v[64:79]
s_xor_b32 s26, s3, 1
s_mul_i32 s26, s26, 12288
s_add_u32 s26, s26, 114688
v_add_u32 v12, s26, v1
s_xor_b32 s26, s3, 2
s_mul_i32 s26, s26, 12288
s_add_u32 s26, s26, 118784
v_add_u32 v13, s26, v1
s_xor_b32 s26, s3, 3
s_mul_i32 s26, s26, 12288
s_add_u32 s26, s26, 122880
v_add_u32 v14, s26, v1
s_mul_i32 s26, s3, 12288
s_add_u32 s26, s26, 114688
v_add_u32 v5, s26, v1
ds_write_b128 v12, v[32:35] offset:0
ds_write_b128 v12, v[36:39] offset:1024
ds_write_b128 v12, v[40:43] offset:2048
ds_write_b128 v12, v[44:47] offset:3072
ds_write_b128 v13, v[48:51] offset:0
ds_write_b128 v13, v[52:55] offset:1024
ds_write_b128 v13, v[56:59] offset:2048
ds_write_b128 v13, v[60:63] offset:3072
ds_write_b128 v14, v[64:67] offset:0
ds_write_b128 v14, v[68:71] offset:1024
ds_write_b128 v14, v[72:75] offset:2048
ds_write_b128 v14, v[76:79] offset:3072
v_and_b32 v6, 31, v0
v_lshrrev_b32 v7, 5, v0
s_waitcnt vmcnt(0)
v_lshlrev_b32 v8, 16, v208
v_and_b32 v9, 0xffff0000, v208
v_add_f32 v16, v16, v8
v_add_f32 v17, v17, v9
v_lshlrev_b32 v8, 16, v209
v_and_b32 v9, 0xffff0000, v209
v_add_f32 v18, v18, v8
v_add_f32 v19, v19, v9
v_lshlrev_b32 v8, 16, v210
v_and_b32 v9, 0xffff0000, v210
v_add_f32 v20, v20, v8
v_add_f32 v21, v21, v9
v_lshlrev_b32 v8, 16, v211
v_and_b32 v9, 0xffff0000, v211
v_add_f32 v22, v22, v8
v_add_f32 v23, v23, v9
v_lshlrev_b32 v8, 16, v212
v_and_b32 v9, 0xffff0000, v212
v_add_f32 v24, v24, v8
v_add_f32 v25, v25, v9
v_lshlrev_b32 v8, 16, v213
v_and_b32 v9, 0xffff0000, v213
v_add_f32 v26, v26, v8
v_add_f32 v27, v27, v9
v_lshlrev_b32 v8, 16, v214
v_and_b32 v9, 0xffff0000, v214
v_add_f32 v28, v28, v8
v_add_f32 v29, v29, v9
v_lshlrev_b32 v8, 16, v215
v_and_b32 v9, 0xffff0000, v215
v_add_f32 v30, v30, v8
v_add_f32 v31, v31, v9
s_waitcnt lgkmcnt(0)
s_barrier
ds_read_b128 v[80:83], v5 offset:0
ds_read_b128 v[84:87], v5 offset:1024
ds_read_b128 v[88:91], v5 offset:2048
ds_read_b128 v[92:95], v5 offset:3072
ds_read_b128 v[96:99], v5 offset:4096
ds_read_b128 v[100:103], v5 offset:5120
ds_read_b128 v[104:107], v5 offset:6144
ds_read_b128 v[108:111], v5 offset:7168
ds_read_b128 v[112:115], v5 offset:8192
ds_read_b128 v[116:119], v5 offset:9216
ds_read_b128 v[120:123], v5 offset:10240
ds_read_b128 v[124:127], v5 offset:11264
s_waitcnt lgkmcnt(8)
v_add_f32 v16, v16, v80
v_add_f32 v17, v17, v81
v_add_f32 v18, v18, v82
v_add_f32 v19, v19, v83
v_add_f32 v20, v20, v84
v_add_f32 v21, v21, v85
v_add_f32 v22, v22, v86
v_add_f32 v23, v23, v87
v_add_f32 v24, v24, v88
v_add_f32 v25, v25, v89
v_add_f32 v26, v26, v90
v_add_f32 v27, v27, v91
v_add_f32 v28, v28, v92
v_add_f32 v29, v29, v93
v_add_f32 v30, v30, v94
v_add_f32 v31, v31, v95
s_waitcnt lgkmcnt(4)
v_add_f32 v16, v16, v96
v_add_f32 v17, v17, v97
v_add_f32 v18, v18, v98
v_add_f32 v19, v19, v99
v_add_f32 v20, v20, v100
v_add_f32 v21, v21, v101
v_add_f32 v22, v22, v102
v_add_f32 v23, v23, v103
v_add_f32 v24, v24, v104
v_add_f32 v25, v25, v105
v_add_f32 v26, v26, v106
v_add_f32 v27, v27, v107
v_add_f32 v28, v28, v108
v_add_f32 v29, v29, v109
v_add_f32 v30, v30, v110
v_add_f32 v31, v31, v111
s_waitcnt lgkmcnt(0)
v_add_f32 v16, v16, v112
v_add_f32 v17, v17, v113
v_add_f32 v18, v18, v114
v_add_f32 v19, v19, v115
v_add_f32 v20, v20, v116
v_add_f32 v21, v21, v117
v_add_f32 v22, v22, v118
v_add_f32 v23, v23, v119
v_add_f32 v24, v24, v120
v_add_f32 v25, v25, v121
v_add_f32 v26, v26, v122
v_add_f32 v27, v27, v123
v_add_f32 v28, v28, v124
v_add_f32 v29, v29, v125
v_add_f32 v30, v30, v126
v_add_f32 v31, v31, v127
v_cvt_pk_bf16_f32 v208, v16, v17
v_cvt_pk_bf16_f32 v209, v18, v19
v_cvt_pk_bf16_f32 v210, v20, v21
v_cvt_pk_bf16_f32 v211, v22, v23
v_cvt_pk_bf16_f32 v212, v24, v25
v_cvt_pk_bf16_f32 v213, v26, v27
v_cvt_pk_bf16_f32 v214, v28, v29
v_cvt_pk_bf16_f32 v215, v30, v31
v_mul_u32_u24 v6, 896, v6
v_lshl_add_u32 v6, v7, 4, v6
s_mul_i32 s25, s44, 28672
s_lshl_b32 s26, s46, 6
s_add_u32 s25, s25, s26
s_mov_b32 s32, s6
s_mov_b32 s33, s7
s_mov_b32 s34, 1835008
s_mov_b32 s35, 0x00020000
buffer_store_dwordx4 v[208:211], v6, s[32:35], s25 offen offset:0
buffer_store_dwordx4 v[212:215], v6, s[32:35], s25 offen offset:32
main_kernel_ce11:
main_kernel_end:
s_endpgm
main_kernel_b0_slow:
s_waitcnt vmcnt(0) lgkmcnt(0)
s_barrier
v_mov_b32 v8, 0xff800000
v_mov_b32 v9, 0xff800000
v_mov_b32 v10, 0xff800000
v_mov_b32 v11, 0xff800000
s_mov_b32 s18, s17
s_mov_b32 s27, 16
main_kernel_b0_mx:
buffer_load_dwordx4 v[152:155], v1, s[8:11], s18 offen sc1
buffer_load_dwordx4 v[156:159], v1, s[8:11], s18 offen offset:1024 sc1
s_waitcnt vmcnt(0)
v_mfma_f32_32x32x16_bf16 v[112:127], v[152:155], v[16:19], 0
v_mfma_f32_32x32x16_bf16 v[112:127], v[156:159], v[20:23], v[112:127]
s_nop 12
v_max3_f32 v8, v8, v112, v113
v_max3_f32 v8, v8, v114, v115
v_max3_f32 v8, v8, v116, v117
v_max3_f32 v8, v8, v118, v119
v_max3_f32 v8, v8, v120, v121
v_max3_f32 v8, v8, v122, v123
v_max3_f32 v8, v8, v124, v125
v_max3_f32 v8, v8, v126, v127
s_nop 1
v_mfma_f32_32x32x16_bf16 v[112:127], v[152:155], v[24:27], 0
v_mfma_f32_32x32x16_bf16 v[112:127], v[156:159], v[28:31], v[112:127]
s_nop 12
v_max3_f32 v9, v9, v112, v113
v_max3_f32 v9, v9, v114, v115
v_max3_f32 v9, v9, v116, v117
v_max3_f32 v9, v9, v118, v119
v_max3_f32 v9, v9, v120, v121
v_max3_f32 v9, v9, v122, v123
v_max3_f32 v9, v9, v124, v125
v_max3_f32 v9, v9, v126, v127
s_nop 1
v_mfma_f32_32x32x16_bf16 v[112:127], v[152:155], v[32:35], 0
v_mfma_f32_32x32x16_bf16 v[112:127], v[156:159], v[36:39], v[112:127]
s_nop 12
v_max3_f32 v10, v10, v112, v113
v_max3_f32 v10, v10, v114, v115
v_max3_f32 v10, v10, v116, v117
v_max3_f32 v10, v10, v118, v119
v_max3_f32 v10, v10, v120, v121
v_max3_f32 v10, v10, v122, v123
v_max3_f32 v10, v10, v124, v125
v_max3_f32 v10, v10, v126, v127
s_nop 1
v_mfma_f32_32x32x16_bf16 v[112:127], v[152:155], v[40:43], 0
v_mfma_f32_32x32x16_bf16 v[112:127], v[156:159], v[44:47], v[112:127]
s_nop 12
v_max3_f32 v11, v11, v112, v113
v_max3_f32 v11, v11, v114, v115
v_max3_f32 v11, v11, v116, v117
v_max3_f32 v11, v11, v118, v119
v_max3_f32 v11, v11, v120, v121
v_max3_f32 v11, v11, v122, v123
v_max3_f32 v11, v11, v124, v125
v_max3_f32 v11, v11, v126, v127
s_nop 1
s_add_u32 s18, s18, 4096
s_sub_u32 s27, s27, 1
s_cmp_lg_u32 s27, 0
s_cbranch_scc1 main_kernel_b0_mx
s_lshl_b32 s20, s3, 10
s_add_u32 s20, s20, 114688
v_lshl_add_u32 v12, v0, 2, s20
v_and_b32 v13, 31, v0
v_lshlrev_b32 v13, 2, v13
v_add_u32 v13, 114688, v13
ds_write_b32 v12, v8 offset:0
ds_write_b32 v12, v9 offset:256
ds_write_b32 v12, v10 offset:512
ds_write_b32 v12, v11 offset:768
s_waitcnt lgkmcnt(0)
s_barrier
s_mov_b32 s28, 0
s_mov_b32 s29, -1
ds_read_b32 v112, v13 offset:0
ds_read_b32 v113, v13 offset:128
ds_read_b32 v114, v13 offset:1024
ds_read_b32 v115, v13 offset:1152
ds_read_b32 v116, v13 offset:2048
ds_read_b32 v117, v13 offset:2176
ds_read_b32 v118, v13 offset:3072
ds_read_b32 v119, v13 offset:3200
s_waitcnt lgkmcnt(0)
v_max3_f32 v8, v8, v112, v113
v_max3_f32 v8, v8, v114, v115
v_max3_f32 v8, v8, v116, v117
v_max3_f32 v8, v8, v118, v119
v_sub_f32 v8, 0, v8
v_cvt_pk_bf16_f32 v14, v8, v8
v_lshlrev_b32 v14, 16, v14
v_sub_f32 v15, v8, v14
v_cvt_pk_bf16_f32 v14, v14, v15
v_cndmask_b32 v22, v22, v14, s[28:29]
ds_read_b32 v112, v13 offset:256
ds_read_b32 v113, v13 offset:384
ds_read_b32 v114, v13 offset:1280
ds_read_b32 v115, v13 offset:1408
ds_read_b32 v116, v13 offset:2304
ds_read_b32 v117, v13 offset:2432
ds_read_b32 v118, v13 offset:3328
ds_read_b32 v119, v13 offset:3456
s_waitcnt lgkmcnt(0)
v_max3_f32 v9, v9, v112, v113
v_max3_f32 v9, v9, v114, v115
v_max3_f32 v9, v9, v116, v117
v_max3_f32 v9, v9, v118, v119
v_sub_f32 v9, 0, v9
v_cvt_pk_bf16_f32 v14, v9, v9
v_lshlrev_b32 v14, 16, v14
v_sub_f32 v15, v9, v14
v_cvt_pk_bf16_f32 v14, v14, v15
v_cndmask_b32 v30, v30, v14, s[28:29]
ds_read_b32 v112, v13 offset:512
ds_read_b32 v113, v13 offset:640
ds_read_b32 v114, v13 offset:1536
ds_read_b32 v115, v13 offset:1664
ds_read_b32 v116, v13 offset:2560
ds_read_b32 v117, v13 offset:2688
ds_read_b32 v118, v13 offset:3584
ds_read_b32 v119, v13 offset:3712
s_waitcnt lgkmcnt(0)
v_max3_f32 v10, v10, v112, v113
v_max3_f32 v10, v10, v114, v115
v_max3_f32 v10, v10, v116, v117
v_max3_f32 v10, v10, v118, v119
v_sub_f32 v10, 0, v10
v_cvt_pk_bf16_f32 v14, v10, v10
v_lshlrev_b32 v14, 16, v14
v_sub_f32 v15, v10, v14
v_cvt_pk_bf16_f32 v14, v14, v15
v_cndmask_b32 v38, v38, v14, s[28:29]
ds_read_b32 v112, v13 offset:768
ds_read_b32 v113, v13 offset:896
ds_read_b32 v114, v13 offset:1792
ds_read_b32 v115, v13 offset:1920
ds_read_b32 v116, v13 offset:2816
ds_read_b32 v117, v13 offset:2944
ds_read_b32 v118, v13 offset:3840
ds_read_b32 v119, v13 offset:3968
s_waitcnt lgkmcnt(0)
v_max3_f32 v11, v11, v112, v113
v_max3_f32 v11, v11, v114, v115
v_max3_f32 v11, v11, v116, v117
v_max3_f32 v11, v11, v118, v119
v_sub_f32 v11, 0, v11
v_cvt_pk_bf16_f32 v14, v11, v11
v_lshlrev_b32 v14, 16, v14
v_sub_f32 v15, v11, v14
v_cvt_pk_bf16_f32 v14, v14, v15
v_cndmask_b32 v46, v46, v14, s[28:29]
s_barrier
s_mov_b32 s19, 1
s_add_u32 s18, s17, 0
buffer_load_dwordx4 v[152:155], v1, s[8:11], s18 offen offset:0 sc1
buffer_load_dword v13, v1, s[8:11], s15 offen sc1
buffer_load_dwordx4 v[156:159], v1, s[8:11], s18 offen offset:1024 sc1
buffer_load_dword v13, v1, s[8:11], s15 offen sc1
buffer_load_dword v13, v1, s[8:11], s15 offen sc1
buffer_load_dword v13, v1, s[8:11], s15 offen sc1
buffer_load_dwordx4 v[160:163], v1, s[8:11], s18 offen offset:2048 sc1
buffer_load_dwordx4 v[164:167], v1, s[8:11], s18 offen offset:3072 sc1
buffer_load_dword v13, v1, s[8:11], s15 offen sc1
buffer_load_dword v13, v1, s[8:11], s15 offen sc1
buffer_load_dword v13, v1, s[8:11], s15 offen sc1
buffer_load_dword v13, v1, s[8:11], s15 offen sc1
s_branch main_kernel_b0_go
main_kernel_b1_slow:
s_waitcnt vmcnt(0) lgkmcnt(0)
s_barrier
v_mov_b32 v8, 0xff800000
v_mov_b32 v9, 0xff800000
v_mov_b32 v10, 0xff800000
v_mov_b32 v11, 0xff800000
s_mov_b32 s18, s17
s_mov_b32 s27, 16
main_kernel_b1_mx:
buffer_load_dwordx4 v[152:155], v1, s[8:11], s18 offen sc1
buffer_load_dwordx4 v[156:159], v1, s[8:11], s18 offen offset:1024 sc1
s_waitcnt vmcnt(0)
v_mfma_f32_32x32x16_bf16 v[112:127], v[152:155], v[16:19], 0
v_mfma_f32_32x32x16_bf16 v[112:127], v[156:159], v[20:23], v[112:127]
s_nop 12
v_max3_f32 v8, v8, v112, v113
v_max3_f32 v8, v8, v114, v115
v_max3_f32 v8, v8, v116, v117
v_max3_f32 v8, v8, v118, v119
v_max3_f32 v8, v8, v120, v121
v_max3_f32 v8, v8, v122, v123
v_max3_f32 v8, v8, v124, v125
v_max3_f32 v8, v8, v126, v127
s_nop 1
v_mfma_f32_32x32x16_bf16 v[112:127], v[152:155], v[24:27], 0
v_mfma_f32_32x32x16_bf16 v[112:127], v[156:159], v[28:31], v[112:127]
s_nop 12
v_max3_f32 v9, v9, v112, v113
v_max3_f32 v9, v9, v114, v115
v_max3_f32 v9, v9, v116, v117
v_max3_f32 v9, v9, v118, v119
v_max3_f32 v9, v9, v120, v121
v_max3_f32 v9, v9, v122, v123
v_max3_f32 v9, v9, v124, v125
v_max3_f32 v9, v9, v126, v127
s_nop 1
v_mfma_f32_32x32x16_bf16 v[112:127], v[152:155], v[32:35], 0
v_mfma_f32_32x32x16_bf16 v[112:127], v[156:159], v[36:39], v[112:127]
s_nop 12
v_max3_f32 v10, v10, v112, v113
v_max3_f32 v10, v10, v114, v115
v_max3_f32 v10, v10, v116, v117
v_max3_f32 v10, v10, v118, v119
v_max3_f32 v10, v10, v120, v121
v_max3_f32 v10, v10, v122, v123
v_max3_f32 v10, v10, v124, v125
v_max3_f32 v10, v10, v126, v127
s_nop 1
v_mfma_f32_32x32x16_bf16 v[112:127], v[152:155], v[40:43], 0
v_mfma_f32_32x32x16_bf16 v[112:127], v[156:159], v[44:47], v[112:127]
s_nop 12
v_max3_f32 v11, v11, v112, v113
v_max3_f32 v11, v11, v114, v115
v_max3_f32 v11, v11, v116, v117
v_max3_f32 v11, v11, v118, v119
v_max3_f32 v11, v11, v120, v121
v_max3_f32 v11, v11, v122, v123
v_max3_f32 v11, v11, v124, v125
v_max3_f32 v11, v11, v126, v127
s_nop 1
s_add_u32 s18, s18, 4096
s_sub_u32 s27, s27, 1
s_cmp_lg_u32 s27, 0
s_cbranch_scc1 main_kernel_b1_mx
s_lshl_b32 s20, s3, 10
s_add_u32 s20, s20, 114688
v_lshl_add_u32 v12, v0, 2, s20
v_and_b32 v13, 31, v0
v_lshlrev_b32 v13, 2, v13
v_add_u32 v13, 114688, v13
ds_write_b32 v12, v8 offset:0
ds_write_b32 v12, v9 offset:256
ds_write_b32 v12, v10 offset:512
ds_write_b32 v12, v11 offset:768
s_waitcnt lgkmcnt(0)
s_barrier
s_mov_b32 s28, 0
s_mov_b32 s29, -1
ds_read_b32 v112, v13 offset:0
ds_read_b32 v113, v13 offset:128
ds_read_b32 v114, v13 offset:1024
ds_read_b32 v115, v13 offset:1152
ds_read_b32 v116, v13 offset:2048
ds_read_b32 v117, v13 offset:2176
ds_read_b32 v118, v13 offset:3072
ds_read_b32 v119, v13 offset:3200
s_waitcnt lgkmcnt(0)
v_max3_f32 v8, v8, v112, v113
v_max3_f32 v8, v8, v114, v115
v_max3_f32 v8, v8, v116, v117
v_max3_f32 v8, v8, v118, v119
v_sub_f32 v8, 0, v8
v_cvt_pk_bf16_f32 v14, v8, v8
v_lshlrev_b32 v14, 16, v14
v_sub_f32 v15, v8, v14
v_cvt_pk_bf16_f32 v14, v14, v15
v_cndmask_b32 v22, v22, v14, s[28:29]
ds_read_b32 v112, v13 offset:256
ds_read_b32 v113, v13 offset:384
ds_read_b32 v114, v13 offset:1280
ds_read_b32 v115, v13 offset:1408
ds_read_b32 v116, v13 offset:2304
ds_read_b32 v117, v13 offset:2432
ds_read_b32 v118, v13 offset:3328
ds_read_b32 v119, v13 offset:3456
s_waitcnt lgkmcnt(0)
v_max3_f32 v9, v9, v112, v113
v_max3_f32 v9, v9, v114, v115
v_max3_f32 v9, v9, v116, v117
v_max3_f32 v9, v9, v118, v119
v_sub_f32 v9, 0, v9
v_cvt_pk_bf16_f32 v14, v9, v9
v_lshlrev_b32 v14, 16, v14
v_sub_f32 v15, v9, v14
v_cvt_pk_bf16_f32 v14, v14, v15
v_cndmask_b32 v30, v30, v14, s[28:29]
ds_read_b32 v112, v13 offset:512
ds_read_b32 v113, v13 offset:640
ds_read_b32 v114, v13 offset:1536
ds_read_b32 v115, v13 offset:1664
ds_read_b32 v116, v13 offset:2560
ds_read_b32 v117, v13 offset:2688
ds_read_b32 v118, v13 offset:3584
ds_read_b32 v119, v13 offset:3712
s_waitcnt lgkmcnt(0)
v_max3_f32 v10, v10, v112, v113
v_max3_f32 v10, v10, v114, v115
v_max3_f32 v10, v10, v116, v117
v_max3_f32 v10, v10, v118, v119
v_sub_f32 v10, 0, v10
v_cvt_pk_bf16_f32 v14, v10, v10
v_lshlrev_b32 v14, 16, v14
v_sub_f32 v15, v10, v14
v_cvt_pk_bf16_f32 v14, v14, v15
v_cndmask_b32 v38, v38, v14, s[28:29]
ds_read_b32 v112, v13 offset:768
ds_read_b32 v113, v13 offset:896
ds_read_b32 v114, v13 offset:1792
ds_read_b32 v115, v13 offset:1920
ds_read_b32 v116, v13 offset:2816
ds_read_b32 v117, v13 offset:2944
ds_read_b32 v118, v13 offset:3840
ds_read_b32 v119, v13 offset:3968
s_waitcnt lgkmcnt(0)
v_max3_f32 v11, v11, v112, v113
v_max3_f32 v11, v11, v114, v115
v_max3_f32 v11, v11, v116, v117
v_max3_f32 v11, v11, v118, v119
v_sub_f32 v11, 0, v11
v_cvt_pk_bf16_f32 v14, v11, v11
v_lshlrev_b32 v14, 16, v14
v_sub_f32 v15, v11, v14
v_cvt_pk_bf16_f32 v14, v14, v15
v_cndmask_b32 v46, v46, v14, s[28:29]
s_barrier
s_mov_b32 s19, 1
s_add_u32 s18, s17, 0
buffer_load_dwordx4 v[152:155], v1, s[8:11], s18 offen offset:0 sc1
buffer_load_dword v13, v1, s[8:11], s15 offen sc1
buffer_load_dwordx4 v[156:159], v1, s[8:11], s18 offen offset:1024 sc1
buffer_load_dword v13, v1, s[8:11], s15 offen sc1
buffer_load_dword v13, v1, s[8:11], s15 offen sc1
buffer_load_dword v13, v1, s[8:11], s15 offen sc1
buffer_load_dwordx4 v[160:163], v1, s[8:11], s18 offen offset:2048 sc1
buffer_load_dwordx4 v[164:167], v1, s[8:11], s18 offen offset:3072 sc1
buffer_load_dword v13, v1, s[8:11], s15 offen sc1
buffer_load_dword v13, v1, s[8:11], s15 offen sc1
buffer_load_dword v13, v1, s[8:11], s15 offen sc1
buffer_load_dword v13, v1, s[8:11], s15 offen sc1
s_branch main_kernel_b1_go
.section .rodata,"a"
.p2align 6
.amdhsa_kernel main_kernel
  .amdhsa_next_free_vgpr 512
  .amdhsa_next_free_sgpr 96
  .amdhsa_accum_offset 256
  .amdhsa_group_segment_fixed_size 0
  .amdhsa_kernarg_size 80
  .amdhsa_user_sgpr_count 2
  .amdhsa_user_sgpr_kernarg_segment_ptr 1
  .amdhsa_system_sgpr_workgroup_id_x 1
.end_amdhsa_kernel
```
